```python
import torch

def _softmax(x, axis=-1):
    return torch.softmax(x, dim=axis)
def _gelu(x):
    return torch.nn.functional.gelu(x, approximate="tanh")
def _silu(x):
    return torch.nn.functional.silu(x)
def _sigmoid(x):
    return torch.sigmoid(x)
def _layernorm(x, axis=-1, eps=1e-5):
    m = x.mean(dim=axis, keepdim=True)
    v = x.var(dim=axis, keepdim=True, unbiased=False)
    return (x - m) / torch.sqrt(v + eps)
def _scatter_add(tgt, idx, src, axis=0):
    return tgt.clone().index_add_(axis, idx, src)
def _segment_sum(src, seg, n):
    out = torch.zeros((n,) + src.shape[1:], dtype=src.dtype)
    return out.index_add_(0, seg, src)
def _pad(x, pw):
    flat = tuple(v for pair in reversed(pw) for v in pair)
    return torch.nn.functional.pad(x, flat)

kernel_name = 'standalone__gqa_block_cached__near_ridge'

def setup_inputs():

    _w = (lambda a: (lambda t: t.to(torch.bfloat16) if t.is_floating_point() else t)(torch.as_tensor(a)))
    B, Sq, D = 16, 64, 640
    Hq, Hkv, Sk, Dh = 32, 32, 512, 192
    assert Hq % Hkv == 0, (Hq, Hkv)
    return {
        "x": _w((lambda *s: torch.randn(*s, dtype=torch.bfloat16) * 0.8)(B, Sq, D)),
        "k_cache": _w((lambda *s: torch.randn(*s, dtype=torch.bfloat16) * 0.8)(B, Hkv, Sk, Dh)),
        "v_cache": _w((lambda *s: torch.randn(*s, dtype=torch.bfloat16) * 0.05)(B, Hkv, Sk, Dh)),
        "wq": _w((lambda *s: torch.randn(*s, dtype=torch.bfloat16) * 0.8)(D, Hq * Dh) * (D ** -0.5)),
        "wo": _w((lambda *s: torch.randn(*s, dtype=torch.bfloat16) * 0.05)(Hq * Dh, D) * ((Hq * Dh) ** -0.5)),
    }

def reference(x, k_cache, v_cache, wq, wo):
    B, Sq, D = x.shape
    Hq, Dh = 32, 192
    Hkv = k_cache.shape[1]
    rep = Hq // Hkv
    q = (lambda x, *d: x.permute(*d))((x @ wq).reshape(B, Sq, Hq, Dh), 0, 2, 1, 3)
    k = (lambda x, n, axis: torch.repeat_interleave(x, n, dim=axis))(k_cache, rep, axis=1)
    v = (lambda x, n, axis: torch.repeat_interleave(x, n, dim=axis))(v_cache, rep, axis=1)
    scores = torch.einsum("bhqd,bhkd->bhqk", q, k) * (Dh ** -0.5)
    p = _softmax(scores, axis=-1)
    o = torch.einsum("bhqk,bhkd->bhqd", p, v)
    return (lambda x, *d: x.permute(*d))(o, 0, 2, 1, 3).reshape(B, Sq, Hq * Dh) @ wo
```

```asm
; @launch grid=(256,1,1) block=(256,1,1) lds=163840
.amdgcn_target "amdgcn-amd-amdhsa--gfx950"
.text
.set CPF_LINES, ((L_codeend-standalone__gqa_block_cached__near_ridge_kernel)/128+32)/32
.globl standalone__gqa_block_cached__near_ridge_kernel
.p2align 8
.type standalone__gqa_block_cached__near_ridge_kernel,@function
standalone__gqa_block_cached__near_ridge_kernel:
s_cmp_ge_u32 s2, 256
s_cbranch_scc1 L_end
s_load_dwordx16 s[4:19], s[0:1], 0
s_getpc_b64 s[76:77]
L_pc:
s_sub_u32 s76, s76, L_pc-standalone__gqa_block_cached__near_ridge_kernel
s_subb_u32 s77, s77, 0
s_and_b32 s77, s77, 0xffff
s_mov_b32 s78, L_codeend-standalone__gqa_block_cached__near_ridge_kernel
s_mov_b32 s79, 0x20000
s_bfe_u32 s80, s2, 0x10003
s_lshl_b32 s80, s80, 15
v_lshlrev_b32 v32, 7, v0
buffer_load_dword v54, v32, s[76:79], s80 offen
s_lshr_b32 s56, s2, 4
s_and_b32 s62, s2, 7
s_lshl_b32 s62, s62, 1
s_bfe_u32 s63, s2, 0x10003
s_or_b32 s57, s62, s63
v_and_b32 v128, 63, v0
v_lshrrev_b32 v129, 6, v0
s_nop 0
v_readfirstlane_b32 s58, v129
v_lshlrev_b32 v48, 4, v128
v_add_u32 v139, 0, v128
v_mul_u32_u24 v140, 2731, v139
v_lshrrev_b32 v140, 16, v140
v_and_b32 v135, 2, v140
v_lshlrev_b32 v135, 5, v135
v_and_b32 v141, 4, v140
v_lshlrev_b32 v141, 3, v141
v_or_b32 v135, v135, v141
v_and_b32 v141, 8, v140
v_lshlrev_b32 v141, 1, v141
v_or_b32 v135, v135, v141
v_lshlrev_b32 v139, 4, v139
v_xor_b32 v139, v139, v135
v_subrev_u32 v1, 0, v139
v_mul_u32_u24 v141, 11904, v140
v_add_u32 v141, v141, v139
v_subrev_u32 v7, 0, v141
v_add_u32 v139, 64, v128
v_mul_u32_u24 v140, 2731, v139
v_lshrrev_b32 v140, 16, v140
v_and_b32 v135, 2, v140
v_lshlrev_b32 v135, 5, v135
v_and_b32 v141, 4, v140
v_lshlrev_b32 v141, 3, v141
v_or_b32 v135, v135, v141
v_and_b32 v141, 8, v140
v_lshlrev_b32 v141, 1, v141
v_or_b32 v135, v135, v141
v_lshlrev_b32 v139, 4, v139
v_xor_b32 v139, v139, v135
v_subrev_u32 v2, 1024, v139
v_mul_u32_u24 v141, 11904, v140
v_add_u32 v141, v141, v139
v_subrev_u32 v8, 1024, v141
v_add_u32 v139, 128, v128
v_mul_u32_u24 v140, 2731, v139
v_lshrrev_b32 v140, 16, v140
v_and_b32 v135, 2, v140
v_lshlrev_b32 v135, 5, v135
v_and_b32 v141, 4, v140
v_lshlrev_b32 v141, 3, v141
v_or_b32 v135, v135, v141
v_and_b32 v141, 8, v140
v_lshlrev_b32 v141, 1, v141
v_or_b32 v135, v135, v141
v_lshlrev_b32 v139, 4, v139
v_xor_b32 v139, v139, v135
v_subrev_u32 v3, 2048, v139
v_mul_u32_u24 v141, 11904, v140
v_add_u32 v141, v141, v139
v_subrev_u32 v9, 2048, v141
v_add_u32 v139, 192, v128
v_mul_u32_u24 v140, 2731, v139
v_lshrrev_b32 v140, 16, v140
v_and_b32 v135, 2, v140
v_lshlrev_b32 v135, 5, v135
v_and_b32 v141, 4, v140
v_lshlrev_b32 v141, 3, v141
v_or_b32 v135, v135, v141
v_and_b32 v141, 8, v140
v_lshlrev_b32 v141, 1, v141
v_or_b32 v135, v135, v141
v_lshlrev_b32 v139, 4, v139
v_xor_b32 v139, v139, v135
v_subrev_u32 v4, 3072, v139
v_mul_u32_u24 v141, 11904, v140
v_add_u32 v141, v141, v139
v_subrev_u32 v10, 3072, v141
v_add_u32 v139, 256, v128
v_mul_u32_u24 v140, 2731, v139
v_lshrrev_b32 v140, 16, v140
v_and_b32 v135, 2, v140
v_lshlrev_b32 v135, 5, v135
v_and_b32 v141, 4, v140
v_lshlrev_b32 v141, 3, v141
v_or_b32 v135, v135, v141
v_and_b32 v141, 8, v140
v_lshlrev_b32 v141, 1, v141
v_or_b32 v135, v135, v141
v_lshlrev_b32 v139, 4, v139
v_xor_b32 v139, v139, v135
v_subrev_u32 v5, 0, v139
v_mul_u32_u24 v141, 11904, v140
v_add_u32 v141, v141, v139
v_subrev_u32 v11, 0, v141
v_add_u32 v139, 320, v128
v_mul_u32_u24 v140, 2731, v139
v_lshrrev_b32 v140, 16, v140
v_and_b32 v135, 2, v140
v_lshlrev_b32 v135, 5, v135
v_and_b32 v141, 4, v140
v_lshlrev_b32 v141, 3, v141
v_or_b32 v135, v135, v141
v_and_b32 v141, 8, v140
v_lshlrev_b32 v141, 1, v141
v_or_b32 v135, v135, v141
v_lshlrev_b32 v139, 4, v139
v_xor_b32 v139, v139, v135
v_subrev_u32 v6, 1024, v139
v_mul_u32_u24 v141, 11904, v140
v_add_u32 v141, v141, v139
v_subrev_u32 v12, 1024, v141
v_lshrrev_b32 v140, 3, v128
v_and_b32 v135, 2, v140
v_lshlrev_b32 v135, 5, v135
v_and_b32 v141, 4, v140
v_lshlrev_b32 v141, 3, v141
v_or_b32 v135, v135, v141
v_and_b32 v141, 8, v140
v_lshlrev_b32 v141, 1, v141
v_or_b32 v135, v135, v141
v_and_b32 v139, 7, v128
v_lshlrev_b32 v139, 4, v139
v_xor_b32 v139, v139, v135
v_mul_u32_u24 v140, 1280, v140
v_add_u32 v13, v139, v140
v_lshrrev_b32 v140, 3, v128
v_add_u32 v140, 8, v140
v_and_b32 v135, 2, v140
v_lshlrev_b32 v135, 5, v135
v_and_b32 v141, 4, v140
v_lshlrev_b32 v141, 3, v141
v_or_b32 v135, v135, v141
v_and_b32 v141, 8, v140
v_lshlrev_b32 v141, 1, v141
v_or_b32 v135, v135, v141
v_and_b32 v139, 7, v128
v_lshlrev_b32 v139, 4, v139
v_xor_b32 v139, v139, v135
v_mul_u32_u24 v140, 1280, v140
v_add_u32 v14, v139, v140
v_subrev_u32 v14, 1024, v14
s_and_b32 s62, s58, 1
s_mul_i32 s82, s62, 12288
s_mul_i32 s83, s58, 6144
s_mul_i32 s85, s62, 393216
s_mul_i32 s86, s58, 196608
s_mul_i32 s87, s62, 122880
s_mul_i32 s88, s58, 61440
s_lshl_b32 s89, s58, 11
s_mul_i32 s90, s58, 20480
s_lshr_b32 s62, s58, 1
s_lshl_b32 s74, s62, 7
s_lshl_b32 s63, s62, 8
s_sub_u32 s75, 128, s63
s_mul_i32 s63, s62, 384
s_sub_u32 s81, 256, s63
s_cmp_ge_u32 s56, 10
s_cselect_b32 s62, 10, 0
s_sub_u32 s84, s56, s62
s_mov_b32 s59, s84
s_lshr_b32 s67, s2, 3
s_bfe_u32 s62, s2, 0x10003
s_mul_i32 s62, s62, 5
s_add_u32 s84, s56, s62
s_cmp_ge_u32 s84, 10
s_cselect_b32 s62, 10, 0
s_sub_u32 s84, s84, s62
s_cmp_ge_u32 s84, 10
s_cselect_b32 s62, 10, 0
s_sub_u32 s84, s84, s62
s_waitcnt lgkmcnt(0)
s_lshl_b32 s72, s56, 4
s_add_u32 s72, s72, s57
s_mul_i32 s62, s72, 393216
s_mul_hi_u32 s63, s72, 393216
s_add_u32 s20, s6, s62
s_addc_u32 s21, s7, s63
s_and_b32 s21, s21, 0xffff
s_mov_b32 s22, 393216
s_mov_b32 s23, 0x20000
s_add_u32 s24, s8, s62
s_addc_u32 s25, s9, s63
s_and_b32 s25, s25, 0xffff
s_mov_b32 s26, 393216
s_mov_b32 s27, 0x20000
s_mul_i32 s62, s57, 768
s_add_u32 s28, s10, s62
s_addc_u32 s29, s11, 0
s_and_b32 s29, s29, 0xffff
s_mov_b32 s30, 0
s_mov_b32 s31, 0x20000
s_sub_u32 s30, 7864320, s62
s_mul_i32 s62, s56, 81920
s_add_u32 s36, s4, s62
s_addc_u32 s37, s5, 0
s_and_b32 s37, s37, 0xffff
s_mov_b32 s38, 81920
s_mov_b32 s39, 0x20000
s_add_u32 s91, s84, 0
s_cmp_ge_u32 s91, 10
s_cselect_b32 s73, 10, 0
s_sub_u32 s91, s91, s73
s_lshl_b32 s91, s91, 7
s_add_u32 s91, s91, s90
s_add_u32 m0, s89, 151552
s_nop 0
buffer_load_dwordx4 v13, s[36:39], s91 offen lds
buffer_load_dwordx4 v14, s[36:39], s91 offen offset:1024 lds
s_add_u32 s61, s84, 0
s_cmp_ge_u32 s61, 10
s_cselect_b32 s73, 10, 0
s_sub_u32 s61, s61, s73
s_mul_i32 s61, s61, 786432
s_add_u32 s61, s61, s86
s_add_u32 m0, s83, 0
s_nop 0
buffer_load_dwordx4 v7, s[28:31], s61 offen lds
buffer_load_dwordx4 v8, s[28:31], s61 offen offset:1024 lds
buffer_load_dwordx4 v9, s[28:31], s61 offen offset:2048 lds
buffer_load_dwordx4 v10, s[28:31], s61 offen offset:3072 lds
s_add_u32 m0, s83, 4096
s_nop 0
buffer_load_dwordx4 v11, s[28:31], s61 offen lds
buffer_load_dwordx4 v12, s[28:31], s61 offen offset:1024 lds
s_add_u32 s91, s84, 1
s_cmp_ge_u32 s91, 10
s_cselect_b32 s73, 10, 0
s_sub_u32 s91, s91, s73
s_lshl_b32 s91, s91, 7
s_add_u32 s91, s91, s90
s_add_u32 m0, s89, 143360
s_nop 0
buffer_load_dwordx4 v13, s[36:39], s91 offen lds
buffer_load_dwordx4 v14, s[36:39], s91 offen offset:1024 lds
s_add_u32 s61, s84, 1
s_cmp_ge_u32 s61, 10
s_cselect_b32 s73, 10, 0
s_sub_u32 s61, s61, s73
s_mul_i32 s61, s61, 786432
s_add_u32 s61, s61, s86
s_add_u32 m0, s83, 24576
s_nop 0
buffer_load_dwordx4 v7, s[28:31], s61 offen lds
buffer_load_dwordx4 v8, s[28:31], s61 offen offset:1024 lds
buffer_load_dwordx4 v9, s[28:31], s61 offen offset:2048 lds
buffer_load_dwordx4 v10, s[28:31], s61 offen offset:3072 lds
s_add_u32 m0, s83, 28672
s_nop 0
buffer_load_dwordx4 v11, s[28:31], s61 offen lds
buffer_load_dwordx4 v12, s[28:31], s61 offen offset:1024 lds
v_and_b32 v130, 31, v128
v_lshrrev_b32 v131, 5, v128
v_bfe_u32 v132, v128, 4, 1
v_bfe_u32 v133, v128, 2, 2
v_and_b32 v134, 3, v128
v_and_b32 v137, 1, v129
v_lshrrev_b32 v138, 1, v129
v_lshlrev_b32 v136, 5, v132
v_lshlrev_b32 v139, 3, v134
v_add_u32 v136, v136, v139
v_and_b32 v135, 2, v130
v_lshlrev_b32 v135, 5, v135
v_and_b32 v141, 4, v130
v_lshlrev_b32 v141, 3, v141
v_or_b32 v135, v135, v141
v_and_b32 v141, 8, v130
v_lshlrev_b32 v141, 1, v141
v_or_b32 v135, v135, v141
v_lshlrev_b32 v139, 4, v131
v_xor_b32 v139, v139, v135
v_lshlrev_b32 v140, 5, v138
v_add_u32 v140, v140, v130
v_mul_u32_u24 v140, 384, v140
v_add_u32 v15, v139, v140
v_lshlrev_b32 v140, 5, v137
v_add_u32 v140, v140, v130
v_lshlrev_b32 v140, 7, v140
v_add_u32 v18, v139, v140
v_and_b32 v135, 2, v133
v_lshlrev_b32 v135, 5, v135
v_lshlrev_b32 v141, 5, v131
v_or_b32 v135, v135, v141
v_lshlrev_b32 v139, 6, v138
v_add_u32 v139, v139, v136
v_xor_b32 v139, v139, v135
v_lshlrev_b32 v140, 2, v131
v_add_u32 v140, v140, v133
v_lshlrev_b32 v141, 7, v140
v_add_u32 v19, v139, v141
v_lshlrev_b32 v141, 5, v138
v_add_u32 v140, v140, v141
v_mul_u32_u24 v140, 384, v140
v_add_u32 v140, v140, v139
v_lshlrev_b32 v141, 7, v138
v_add_u32 v16, v140, v141
v_and_b32 v135, 2, v133
v_lshlrev_b32 v135, 5, v135
v_lshlrev_b32 v141, 4, v131
v_or_b32 v135, v135, v141
v_lshlrev_b32 v139, 6, v138
v_add_u32 v139, v139, v136
v_xor_b32 v139, v139, v135
v_lshlrev_b32 v140, 3, v131
v_add_u32 v140, v140, v133
v_mul_u32_u24 v140, 384, v140
v_add_u32 v140, v140, v139
v_lshlrev_b32 v141, 7, v138
v_add_u32 v17, v140, v141
v_mul_u32_u24 v139, 12288, v137
v_add_u32 v50, v139, v48
v_mul_u32_u24 v140, 6144, v138
v_add_u32 v49, v50, v140
v_mul_u32_u24 v139, 12288, v129
v_add_u32 v51, v139, v48
v_xor_b32 v139, 2, v129
v_mul_u32_u24 v139, 12288, v139
v_add_u32 v55, v139, v48
s_mul_i32 s62, s57, 491520
s_add_u32 s32, s12, s62
s_addc_u32 s33, s13, 0
s_and_b32 s33, s33, 0xffff
s_mov_b32 s34, 491520
s_mov_b32 s35, 0x20000
s_mul_i32 s62, s56, 81920
s_add_u32 s48, s14, s62
s_addc_u32 s49, s15, 0
s_and_b32 s49, s49, 0xffff
s_mov_b32 s50, 81920
s_mov_b32 s51, 0x20000
s_mul_i32 s62, s56, 1310720
s_add_u32 s40, s18, s62
s_addc_u32 s41, s19, 0
s_and_b32 s41, s41, 0xffff
s_mov_b32 s42, 1310720
s_mov_b32 s43, 0x20000
s_lshl_b32 s62, s56, 11
s_add_u32 s62, s62, 33554432
s_add_u32 s44, s18, s62
s_addc_u32 s45, s19, 0
s_and_b32 s45, s45, 0xffff
s_mov_b32 s46, 2048
s_mov_b32 s47, 0x20000
s_mov_b32 s52, s16
s_and_b32 s53, s17, 0xffff
s_mov_b32 s54, 256
s_mov_b32 s55, 0x20000
s_mov_b32 s60, 0x3dd53b95
s_mul_i32 s66, s57, 81920
s_lshl_b32 s62, s58, 11
s_add_u32 s66, s66, s62
s_add_u32 s91, s84, 2
s_cmp_ge_u32 s91, 10
s_cselect_b32 s73, 10, 0
s_sub_u32 s91, s91, s73
s_lshl_b32 s91, s91, 7
s_add_u32 s91, s91, s90
s_add_u32 m0, s89, 135168
s_nop 0
buffer_load_dwordx4 v13, s[36:39], s91 offen lds
buffer_load_dwordx4 v14, s[36:39], s91 offen offset:1024 lds
s_add_u32 s91, s84, 3
s_cmp_ge_u32 s91, 10
s_cselect_b32 s73, 10, 0
s_sub_u32 s91, s91, s73
s_lshl_b32 s91, s91, 7
s_add_u32 s91, s91, s90
s_add_u32 m0, s89, 126976
s_nop 0
buffer_load_dwordx4 v13, s[36:39], s91 offen lds
buffer_load_dwordx4 v14, s[36:39], s91 offen offset:1024 lds
s_add_u32 s91, s84, 4
s_cmp_ge_u32 s91, 10
s_cselect_b32 s73, 10, 0
s_sub_u32 s91, s91, s73
s_lshl_b32 s91, s91, 7
s_add_u32 s91, s91, s90
s_add_u32 m0, s89, 118784
s_nop 0
buffer_load_dwordx4 v13, s[36:39], s91 offen lds
buffer_load_dwordx4 v14, s[36:39], s91 offen offset:1024 lds
s_add_u32 s91, s84, 5
s_cmp_ge_u32 s91, 10
s_cselect_b32 s73, 10, 0
s_sub_u32 s91, s91, s73
s_lshl_b32 s91, s91, 7
s_add_u32 s91, s91, s90
s_add_u32 m0, s89, 110592
s_nop 0
buffer_load_dwordx4 v13, s[36:39], s91 offen lds
buffer_load_dwordx4 v14, s[36:39], s91 offen offset:1024 lds
s_add_u32 s91, s84, 6
s_cmp_ge_u32 s91, 10
s_cselect_b32 s73, 10, 0
s_sub_u32 s91, s91, s73
s_lshl_b32 s91, s91, 7
s_add_u32 s91, s91, s90
s_add_u32 m0, s89, 102400
s_nop 0
buffer_load_dwordx4 v13, s[36:39], s91 offen lds
buffer_load_dwordx4 v14, s[36:39], s91 offen offset:1024 lds
s_add_u32 s91, s84, 7
s_cmp_ge_u32 s91, 10
s_cselect_b32 s73, 10, 0
s_sub_u32 s91, s91, s73
s_lshl_b32 s91, s91, 7
s_add_u32 s91, s91, s90
s_add_u32 m0, s89, 94208
s_nop 0
buffer_load_dwordx4 v13, s[36:39], s91 offen lds
buffer_load_dwordx4 v14, s[36:39], s91 offen offset:1024 lds
s_add_u32 s91, s84, 8
s_cmp_ge_u32 s91, 10
s_cselect_b32 s73, 10, 0
s_sub_u32 s91, s91, s73
s_lshl_b32 s91, s91, 7
s_add_u32 s91, s91, s90
s_add_u32 m0, s89, 86016
s_nop 0
buffer_load_dwordx4 v13, s[36:39], s91 offen lds
buffer_load_dwordx4 v14, s[36:39], s91 offen offset:1024 lds
s_add_u32 s91, s84, 9
s_cmp_ge_u32 s91, 10
s_cselect_b32 s73, 10, 0
s_sub_u32 s91, s91, s73
s_lshl_b32 s91, s91, 7
s_add_u32 s91, s91, s90
s_add_u32 m0, s89, 77824
s_nop 0
buffer_load_dwordx4 v13, s[36:39], s91 offen lds
buffer_load_dwordx4 v14, s[36:39], s91 offen offset:1024 lds
s_or_b32 s62, s2, s58
s_cmp_lg_u32 s62, 0
s_cbranch_scc1 L_nononce
s_memrealtime s[64:65]
s_waitcnt lgkmcnt(0)
s_or_b32 s64, s64, 1
v_mov_b32 v34, s64
v_mov_b32 v35, s65
v_mov_b32 v36, 0
buffer_store_dwordx2 v[34:35], v36, s[52:55], 0 offen sc1
L_nononce:
s_waitcnt vmcnt(24)
s_barrier
v_add_u32 v20, 0, v17
v_xad_u32 v21, v20, 64, s74
v_xor_b32 v22, 32, v20
v_xor_b32 v23, 32, v21
v_add_u32 v24, 151552, v18
v_xor_b32 v25, 32, v24
v_xor_b32 v26, 64, v24
v_xor_b32 v27, 96, v24
ds_read_b128 a[0:3], v24
ds_read_b64_tr_b16 v[56:57], v20
ds_read_b64_tr_b16 v[58:59], v22 offset:1536
ds_read_b64_tr_b16 v[60:61], v21
ds_read_b64_tr_b16 v[62:63], v23 offset:1536
ds_read_b64_tr_b16 v[64:65], v20 offset:128
ds_read_b64_tr_b16 v[66:67], v22 offset:1664
ds_read_b128 a[4:7], v25
ds_read_b64_tr_b16 v[68:69], v20 offset:6144
ds_read_b64_tr_b16 v[70:71], v22 offset:7680
ds_read_b64_tr_b16 v[72:73], v21 offset:6144
ds_read_b64_tr_b16 v[74:75], v23 offset:7680
s_waitcnt lgkmcnt(9)
v_mfma_f32_32x32x16_bf16 a[160:175], v[56:59], a[0:3], 0
s_add_u32 s61, s84, 2
s_cmp_ge_u32 s61, 10
s_cselect_b32 s73, 10, 0
s_sub_u32 s61, s61, s73
s_mul_i32 s61, s61, 786432
s_add_u32 s61, s61, s86
s_add_u32 m0, s83, 49152
s_nop 0
buffer_load_dwordx4 v7, s[28:31], s61 offen lds
ds_read_b64_tr_b16 v[76:77], v20 offset:6272
ds_read_b64_tr_b16 v[78:79], v22 offset:7808
s_waitcnt lgkmcnt(9)
v_mfma_f32_32x32x16_bf16 a[176:191], v[60:63], a[0:3], 0
buffer_load_dwordx4 v8, s[28:31], s61 offen offset:1024 lds
ds_read_b128 a[8:11], v26
ds_read_b64_tr_b16 v[56:57], v20 offset:12288
ds_read_b64_tr_b16 v[58:59], v22 offset:13824
s_waitcnt lgkmcnt(10)
v_mfma_f32_32x32x16_bf16 a[192:207], v[64:67], a[0:3], 0
buffer_load_dwordx4 v9, s[28:31], s61 offen offset:2048 lds
ds_read_b64_tr_b16 v[60:61], v21 offset:12288
ds_read_b64_tr_b16 v[62:63], v23 offset:13824
s_waitcnt lgkmcnt(9)
v_mfma_f32_32x32x16_bf16 a[160:175], v[68:71], a[4:7], a[160:175]
buffer_load_dwordx4 v10, s[28:31], s61 offen offset:3072 lds
ds_read_b64_tr_b16 v[64:65], v20 offset:12416
ds_read_b64_tr_b16 v[66:67], v22 offset:13952
s_waitcnt lgkmcnt(9)
v_mfma_f32_32x32x16_bf16 a[176:191], v[72:75], a[4:7], a[176:191]
s_add_u32 m0, s83, 53248
s_nop 0
buffer_load_dwordx4 v11, s[28:31], s61 offen lds
ds_read_b128 a[12:15], v27
ds_read_b64_tr_b16 v[68:69], v20 offset:18432
ds_read_b64_tr_b16 v[70:71], v22 offset:19968
s_waitcnt lgkmcnt(10)
v_mfma_f32_32x32x16_bf16 a[192:207], v[76:79], a[4:7], a[192:207]
buffer_load_dwordx4 v12, s[28:31], s61 offen offset:1024 lds
ds_read_b64_tr_b16 v[72:73], v21 offset:18432
ds_read_b64_tr_b16 v[74:75], v23 offset:19968
s_waitcnt lgkmcnt(9)
v_mfma_f32_32x32x16_bf16 a[160:175], v[56:59], a[8:11], a[160:175]
ds_read_b64_tr_b16 v[76:77], v20 offset:18560
ds_read_b64_tr_b16 v[78:79], v22 offset:20096
s_waitcnt lgkmcnt(9)
v_mfma_f32_32x32x16_bf16 a[176:191], v[60:63], a[8:11], a[176:191]
s_waitcnt lgkmcnt(7)
v_mfma_f32_32x32x16_bf16 a[192:207], v[64:67], a[8:11], a[192:207]
s_waitcnt lgkmcnt(4)
v_mfma_f32_32x32x16_bf16 a[160:175], v[68:71], a[12:15], a[160:175]
s_waitcnt lgkmcnt(2)
v_mfma_f32_32x32x16_bf16 a[176:191], v[72:75], a[12:15], a[176:191]
s_waitcnt lgkmcnt(0)
v_mfma_f32_32x32x16_bf16 a[192:207], v[76:79], a[12:15], a[192:207]
s_waitcnt vmcnt(22)
s_barrier
v_add_u32 v20, 24576, v17
v_xad_u32 v21, v20, 64, s74
v_xor_b32 v22, 32, v20
v_xor_b32 v23, 32, v21
v_add_u32 v24, 143360, v18
v_xor_b32 v25, 32, v24
v_xor_b32 v26, 64, v24
v_xor_b32 v27, 96, v24
ds_read_b128 a[16:19], v24
ds_read_b64_tr_b16 v[56:57], v20
ds_read_b64_tr_b16 v[58:59], v22 offset:1536
ds_read_b64_tr_b16 v[60:61], v21
ds_read_b64_tr_b16 v[62:63], v23 offset:1536
ds_read_b64_tr_b16 v[64:65], v20 offset:128
ds_read_b64_tr_b16 v[66:67], v22 offset:1664
ds_read_b128 a[20:23], v25
ds_read_b64_tr_b16 v[68:69], v20 offset:6144
ds_read_b64_tr_b16 v[70:71], v22 offset:7680
ds_read_b64_tr_b16 v[72:73], v21 offset:6144
ds_read_b64_tr_b16 v[74:75], v23 offset:7680
s_waitcnt lgkmcnt(9)
v_mfma_f32_32x32x16_bf16 a[160:175], v[56:59], a[16:19], a[160:175]
s_add_u32 s61, s84, 3
s_cmp_ge_u32 s61, 10
s_cselect_b32 s73, 10, 0
s_sub_u32 s61, s61, s73
s_mul_i32 s61, s61, 786432
s_add_u32 s61, s61, s86
s_add_u32 m0, s83, 0
s_nop 0
buffer_load_dwordx4 v7, s[28:31], s61 offen lds
ds_read_b64_tr_b16 v[76:77], v20 offset:6272
ds_read_b64_tr_b16 v[78:79], v22 offset:7808
s_waitcnt lgkmcnt(9)
v_mfma_f32_32x32x16_bf16 a[176:191], v[60:63], a[16:19], a[176:191]
buffer_load_dwordx4 v8, s[28:31], s61 offen offset:1024 lds
ds_read_b128 a[24:27], v26
ds_read_b64_tr_b16 v[56:57], v20 offset:12288
ds_read_b64_tr_b16 v[58:59], v22 offset:13824
s_waitcnt lgkmcnt(10)
v_mfma_f32_32x32x16_bf16 a[192:207], v[64:67], a[16:19], a[192:207]
buffer_load_dwordx4 v9, s[28:31], s61 offen offset:2048 lds
ds_read_b64_tr_b16 v[60:61], v21 offset:12288
ds_read_b64_tr_b16 v[62:63], v23 offset:13824
s_waitcnt lgkmcnt(9)
v_mfma_f32_32x32x16_bf16 a[160:175], v[68:71], a[20:23], a[160:175]
buffer_load_dwordx4 v10, s[28:31], s61 offen offset:3072 lds
ds_read_b64_tr_b16 v[64:65], v20 offset:12416
ds_read_b64_tr_b16 v[66:67], v22 offset:13952
s_waitcnt lgkmcnt(9)
v_mfma_f32_32x32x16_bf16 a[176:191], v[72:75], a[20:23], a[176:191]
s_add_u32 m0, s83, 4096
s_nop 0
buffer_load_dwordx4 v11, s[28:31], s61 offen lds
ds_read_b128 a[28:31], v27
ds_read_b64_tr_b16 v[68:69], v20 offset:18432
ds_read_b64_tr_b16 v[70:71], v22 offset:19968
s_waitcnt lgkmcnt(10)
v_mfma_f32_32x32x16_bf16 a[192:207], v[76:79], a[20:23], a[192:207]
buffer_load_dwordx4 v12, s[28:31], s61 offen offset:1024 lds
ds_read_b64_tr_b16 v[72:73], v21 offset:18432
ds_read_b64_tr_b16 v[74:75], v23 offset:19968
s_waitcnt lgkmcnt(9)
v_mfma_f32_32x32x16_bf16 a[160:175], v[56:59], a[24:27], a[160:175]
ds_read_b64_tr_b16 v[76:77], v20 offset:18560
ds_read_b64_tr_b16 v[78:79], v22 offset:20096
s_waitcnt lgkmcnt(9)
v_mfma_f32_32x32x16_bf16 a[176:191], v[60:63], a[24:27], a[176:191]
s_waitcnt lgkmcnt(7)
v_mfma_f32_32x32x16_bf16 a[192:207], v[64:67], a[24:27], a[192:207]
s_waitcnt lgkmcnt(4)
v_mfma_f32_32x32x16_bf16 a[160:175], v[68:71], a[28:31], a[160:175]
s_waitcnt lgkmcnt(2)
v_mfma_f32_32x32x16_bf16 a[176:191], v[72:75], a[28:31], a[176:191]
s_waitcnt lgkmcnt(0)
v_mfma_f32_32x32x16_bf16 a[192:207], v[76:79], a[28:31], a[192:207]
s_waitcnt vmcnt(6)
s_barrier
v_add_u32 v20, 49152, v17
v_xad_u32 v21, v20, 64, s74
v_xor_b32 v22, 32, v20
v_xor_b32 v23, 32, v21
v_add_u32 v24, 135168, v18
v_xor_b32 v25, 32, v24
v_xor_b32 v26, 64, v24
v_xor_b32 v27, 96, v24
ds_read_b128 a[32:35], v24
ds_read_b64_tr_b16 v[56:57], v20
ds_read_b64_tr_b16 v[58:59], v22 offset:1536
ds_read_b64_tr_b16 v[60:61], v21
ds_read_b64_tr_b16 v[62:63], v23 offset:1536
ds_read_b64_tr_b16 v[64:65], v20 offset:128
ds_read_b64_tr_b16 v[66:67], v22 offset:1664
ds_read_b128 a[36:39], v25
ds_read_b64_tr_b16 v[68:69], v20 offset:6144
ds_read_b64_tr_b16 v[70:71], v22 offset:7680
ds_read_b64_tr_b16 v[72:73], v21 offset:6144
ds_read_b64_tr_b16 v[74:75], v23 offset:7680
s_waitcnt lgkmcnt(9)
v_mfma_f32_32x32x16_bf16 a[160:175], v[56:59], a[32:35], a[160:175]
s_add_u32 s61, s84, 4
s_cmp_ge_u32 s61, 10
s_cselect_b32 s73, 10, 0
s_sub_u32 s61, s61, s73
s_mul_i32 s61, s61, 786432
s_add_u32 s61, s61, s86
s_add_u32 m0, s83, 24576
s_nop 0
buffer_load_dwordx4 v7, s[28:31], s61 offen lds
buffer_load_dwordx4 v8, s[28:31], s61 offen offset:1024 lds
ds_read_b64_tr_b16 v[76:77], v20 offset:6272
ds_read_b64_tr_b16 v[78:79], v22 offset:7808
s_waitcnt lgkmcnt(9)
v_mfma_f32_32x32x16_bf16 a[176:191], v[60:63], a[32:35], a[176:191]
buffer_load_dwordx4 v9, s[28:31], s61 offen offset:2048 lds
buffer_load_dwordx4 v10, s[28:31], s61 offen offset:3072 lds
ds_read_b128 a[40:43], v26
ds_read_b64_tr_b16 v[56:57], v20 offset:12288
ds_read_b64_tr_b16 v[58:59], v22 offset:13824
s_waitcnt lgkmcnt(10)
v_mfma_f32_32x32x16_bf16 a[192:207], v[64:67], a[32:35], a[192:207]
s_add_u32 m0, s83, 28672
s_nop 0
buffer_load_dwordx4 v11, s[28:31], s61 offen lds
buffer_load_dwordx4 v12, s[28:31], s61 offen offset:1024 lds
ds_read_b64_tr_b16 v[60:61], v21 offset:12288
ds_read_b64_tr_b16 v[62:63], v23 offset:13824
s_waitcnt lgkmcnt(9)
v_mfma_f32_32x32x16_bf16 a[160:175], v[68:71], a[36:39], a[160:175]
s_add_u32 s61, s67, 0
s_and_b32 s61, s61, 7
s_mul_i32 s61, s61, 24576
s_add_u32 s61, s61, s83
buffer_load_dwordx4 v[128:131], v1, s[20:23], s61 offen nt
ds_read_b64_tr_b16 v[64:65], v20 offset:12416
ds_read_b64_tr_b16 v[66:67], v22 offset:13952
s_waitcnt lgkmcnt(9)
v_mfma_f32_32x32x16_bf16 a[176:191], v[72:75], a[36:39], a[176:191]
buffer_load_dwordx4 v[132:135], v2, s[20:23], s61 offen offset:1024 nt
buffer_load_dwordx4 v[136:139], v3, s[20:23], s61 offen offset:2048 nt
ds_read_b128 a[44:47], v27
ds_read_b64_tr_b16 v[68:69], v20 offset:18432
ds_read_b64_tr_b16 v[70:71], v22 offset:19968
s_waitcnt lgkmcnt(10)
v_mfma_f32_32x32x16_bf16 a[192:207], v[76:79], a[36:39], a[192:207]
buffer_load_dwordx4 v[140:143], v4, s[20:23], s61 offen offset:3072 nt
buffer_load_dwordx4 v[144:147], v5, s[20:23], s61 offen nt
ds_read_b64_tr_b16 v[72:73], v21 offset:18432
ds_read_b64_tr_b16 v[74:75], v23 offset:19968
s_waitcnt lgkmcnt(9)
v_mfma_f32_32x32x16_bf16 a[160:175], v[56:59], a[40:43], a[160:175]
buffer_load_dwordx4 v[148:151], v6, s[20:23], s61 offen offset:1024 nt
ds_read_b64_tr_b16 v[76:77], v20 offset:18560
ds_read_b64_tr_b16 v[78:79], v22 offset:20096
s_waitcnt lgkmcnt(9)
v_mfma_f32_32x32x16_bf16 a[176:191], v[60:63], a[40:43], a[176:191]
s_waitcnt lgkmcnt(7)
v_mfma_f32_32x32x16_bf16 a[192:207], v[64:67], a[40:43], a[192:207]
s_waitcnt lgkmcnt(4)
v_mfma_f32_32x32x16_bf16 a[160:175], v[68:71], a[44:47], a[160:175]
s_waitcnt lgkmcnt(2)
v_mfma_f32_32x32x16_bf16 a[176:191], v[72:75], a[44:47], a[176:191]
s_waitcnt lgkmcnt(0)
v_mfma_f32_32x32x16_bf16 a[192:207], v[76:79], a[44:47], a[192:207]
s_waitcnt vmcnt(12)
s_barrier
v_add_u32 v20, 0, v17
v_xad_u32 v21, v20, 64, s74
v_xor_b32 v22, 32, v20
v_xor_b32 v23, 32, v21
v_add_u32 v24, 126976, v18
v_xor_b32 v25, 32, v24
v_xor_b32 v26, 64, v24
v_xor_b32 v27, 96, v24
ds_read_b128 a[48:51], v24
ds_read_b64_tr_b16 v[56:57], v20
ds_read_b64_tr_b16 v[58:59], v22 offset:1536
ds_read_b64_tr_b16 v[60:61], v21
ds_read_b64_tr_b16 v[62:63], v23 offset:1536
ds_read_b64_tr_b16 v[64:65], v20 offset:128
ds_read_b64_tr_b16 v[66:67], v22 offset:1664
ds_read_b128 a[52:55], v25
ds_read_b64_tr_b16 v[68:69], v20 offset:6144
ds_read_b64_tr_b16 v[70:71], v22 offset:7680
ds_read_b64_tr_b16 v[72:73], v21 offset:6144
ds_read_b64_tr_b16 v[74:75], v23 offset:7680
s_waitcnt lgkmcnt(9)
v_mfma_f32_32x32x16_bf16 a[160:175], v[56:59], a[48:51], a[160:175]
s_add_u32 s61, s84, 5
s_cmp_ge_u32 s61, 10
s_cselect_b32 s73, 10, 0
s_sub_u32 s61, s61, s73
s_mul_i32 s61, s61, 786432
s_add_u32 s61, s61, s86
s_add_u32 m0, s83, 49152
s_nop 0
buffer_load_dwordx4 v7, s[28:31], s61 offen lds
buffer_load_dwordx4 v8, s[28:31], s61 offen offset:1024 lds
ds_read_b64_tr_b16 v[76:77], v20 offset:6272
ds_read_b64_tr_b16 v[78:79], v22 offset:7808
s_waitcnt lgkmcnt(9)
v_mfma_f32_32x32x16_bf16 a[176:191], v[60:63], a[48:51], a[176:191]
buffer_load_dwordx4 v9, s[28:31], s61 offen offset:2048 lds
buffer_load_dwordx4 v10, s[28:31], s61 offen offset:3072 lds
ds_read_b128 a[56:59], v26
ds_read_b64_tr_b16 v[56:57], v20 offset:12288
ds_read_b64_tr_b16 v[58:59], v22 offset:13824
s_waitcnt lgkmcnt(10)
v_mfma_f32_32x32x16_bf16 a[192:207], v[64:67], a[48:51], a[192:207]
s_add_u32 m0, s83, 53248
s_nop 0
buffer_load_dwordx4 v11, s[28:31], s61 offen lds
buffer_load_dwordx4 v12, s[28:31], s61 offen offset:1024 lds
ds_read_b64_tr_b16 v[60:61], v21 offset:12288
ds_read_b64_tr_b16 v[62:63], v23 offset:13824
s_waitcnt lgkmcnt(9)
v_mfma_f32_32x32x16_bf16 a[160:175], v[68:71], a[52:55], a[160:175]
s_add_u32 s61, s84, 6
s_cmp_ge_u32 s61, 10
s_cselect_b32 s73, 10, 0
s_sub_u32 s61, s61, s73
s_mul_i32 s61, s61, 786432
s_add_u32 s61, s61, s86
s_add_u32 m0, s83, 135168
s_nop 0
buffer_load_dwordx4 v7, s[28:31], s61 offen lds
ds_read_b64_tr_b16 v[64:65], v20 offset:12416
ds_read_b64_tr_b16 v[66:67], v22 offset:13952
s_waitcnt lgkmcnt(9)
v_mfma_f32_32x32x16_bf16 a[176:191], v[72:75], a[52:55], a[176:191]
buffer_load_dwordx4 v8, s[28:31], s61 offen offset:1024 lds
buffer_load_dwordx4 v9, s[28:31], s61 offen offset:2048 lds
ds_read_b128 a[60:63], v27
ds_read_b64_tr_b16 v[68:69], v20 offset:18432
ds_read_b64_tr_b16 v[70:71], v22 offset:19968
s_waitcnt lgkmcnt(10)
v_mfma_f32_32x32x16_bf16 a[192:207], v[76:79], a[52:55], a[192:207]
buffer_load_dwordx4 v10, s[28:31], s61 offen offset:3072 lds
s_add_u32 m0, s83, 139264
s_nop 0
buffer_load_dwordx4 v11, s[28:31], s61 offen lds
ds_read_b64_tr_b16 v[72:73], v21 offset:18432
ds_read_b64_tr_b16 v[74:75], v23 offset:19968
s_waitcnt lgkmcnt(9)
v_mfma_f32_32x32x16_bf16 a[160:175], v[56:59], a[56:59], a[160:175]
buffer_load_dwordx4 v12, s[28:31], s61 offen offset:1024 lds
ds_read_b64_tr_b16 v[76:77], v20 offset:18560
ds_read_b64_tr_b16 v[78:79], v22 offset:20096
s_waitcnt lgkmcnt(9)
v_mfma_f32_32x32x16_bf16 a[176:191], v[60:63], a[56:59], a[176:191]
s_waitcnt lgkmcnt(7)
v_mfma_f32_32x32x16_bf16 a[192:207], v[64:67], a[56:59], a[192:207]
s_waitcnt lgkmcnt(4)
v_mfma_f32_32x32x16_bf16 a[160:175], v[68:71], a[60:63], a[160:175]
s_waitcnt lgkmcnt(2)
v_mfma_f32_32x32x16_bf16 a[176:191], v[72:75], a[60:63], a[176:191]
s_waitcnt lgkmcnt(0)
v_mfma_f32_32x32x16_bf16 a[192:207], v[76:79], a[60:63], a[192:207]
s_waitcnt vmcnt(18)
s_barrier
v_add_u32 v20, 24576, v17
v_xad_u32 v21, v20, 64, s74
v_xor_b32 v22, 32, v20
v_xor_b32 v23, 32, v21
v_add_u32 v24, 118784, v18
v_xor_b32 v25, 32, v24
v_xor_b32 v26, 64, v24
v_xor_b32 v27, 96, v24
ds_read_b128 a[64:67], v24
ds_read_b64_tr_b16 v[56:57], v20
ds_read_b64_tr_b16 v[58:59], v22 offset:1536
ds_read_b64_tr_b16 v[60:61], v21
ds_read_b64_tr_b16 v[62:63], v23 offset:1536
ds_read_b64_tr_b16 v[64:65], v20 offset:128
ds_read_b64_tr_b16 v[66:67], v22 offset:1664
ds_read_b128 a[68:71], v25
ds_read_b64_tr_b16 v[68:69], v20 offset:6144
ds_read_b64_tr_b16 v[70:71], v22 offset:7680
ds_read_b64_tr_b16 v[72:73], v21 offset:6144
ds_read_b64_tr_b16 v[74:75], v23 offset:7680
s_waitcnt lgkmcnt(9)
v_mfma_f32_32x32x16_bf16 a[160:175], v[56:59], a[64:67], a[160:175]
s_add_u32 s61, s84, 7
s_cmp_ge_u32 s61, 10
s_cselect_b32 s73, 10, 0
s_sub_u32 s61, s61, s73
s_mul_i32 s61, s61, 786432
s_add_u32 s61, s61, s86
s_add_u32 m0, s83, 0
s_nop 0
buffer_load_dwordx4 v7, s[28:31], s61 offen lds
buffer_load_dwordx4 v8, s[28:31], s61 offen offset:1024 lds
ds_read_b64_tr_b16 v[76:77], v20 offset:6272
ds_read_b64_tr_b16 v[78:79], v22 offset:7808
s_waitcnt lgkmcnt(9)
v_mfma_f32_32x32x16_bf16 a[176:191], v[60:63], a[64:67], a[176:191]
buffer_load_dwordx4 v9, s[28:31], s61 offen offset:2048 lds
buffer_load_dwordx4 v10, s[28:31], s61 offen offset:3072 lds
ds_read_b128 a[72:75], v26
ds_read_b64_tr_b16 v[56:57], v20 offset:12288
ds_read_b64_tr_b16 v[58:59], v22 offset:13824
s_waitcnt lgkmcnt(10)
v_mfma_f32_32x32x16_bf16 a[192:207], v[64:67], a[64:67], a[192:207]
s_add_u32 m0, s83, 4096
s_nop 0
buffer_load_dwordx4 v11, s[28:31], s61 offen lds
buffer_load_dwordx4 v12, s[28:31], s61 offen offset:1024 lds
ds_read_b64_tr_b16 v[60:61], v21 offset:12288
ds_read_b64_tr_b16 v[62:63], v23 offset:13824
s_waitcnt lgkmcnt(9)
v_mfma_f32_32x32x16_bf16 a[160:175], v[68:71], a[68:71], a[160:175]
s_add_u32 s61, s67, 1
s_and_b32 s61, s61, 7
s_mul_i32 s61, s61, 24576
s_add_u32 s61, s61, s83
buffer_load_dwordx4 v[152:155], v1, s[20:23], s61 offen nt
ds_read_b64_tr_b16 v[64:65], v20 offset:12416
ds_read_b64_tr_b16 v[66:67], v22 offset:13952
s_waitcnt lgkmcnt(9)
v_mfma_f32_32x32x16_bf16 a[176:191], v[72:75], a[68:71], a[176:191]
buffer_load_dwordx4 v[156:159], v2, s[20:23], s61 offen offset:1024 nt
buffer_load_dwordx4 v[160:163], v3, s[20:23], s61 offen offset:2048 nt
ds_read_b128 a[76:79], v27
ds_read_b64_tr_b16 v[68:69], v20 offset:18432
ds_read_b64_tr_b16 v[70:71], v22 offset:19968
s_waitcnt lgkmcnt(10)
v_mfma_f32_32x32x16_bf16 a[192:207], v[76:79], a[68:71], a[192:207]
buffer_load_dwordx4 v[164:167], v4, s[20:23], s61 offen offset:3072 nt
buffer_load_dwordx4 v[168:171], v5, s[20:23], s61 offen nt
ds_read_b64_tr_b16 v[72:73], v21 offset:18432
ds_read_b64_tr_b16 v[74:75], v23 offset:19968
s_waitcnt lgkmcnt(9)
v_mfma_f32_32x32x16_bf16 a[160:175], v[56:59], a[72:75], a[160:175]
buffer_load_dwordx4 v[172:175], v6, s[20:23], s61 offen offset:1024 nt
ds_read_b64_tr_b16 v[76:77], v20 offset:18560
ds_read_b64_tr_b16 v[78:79], v22 offset:20096
s_waitcnt lgkmcnt(9)
v_mfma_f32_32x32x16_bf16 a[176:191], v[60:63], a[72:75], a[176:191]
s_waitcnt lgkmcnt(7)
v_mfma_f32_32x32x16_bf16 a[192:207], v[64:67], a[72:75], a[192:207]
s_waitcnt lgkmcnt(4)
v_mfma_f32_32x32x16_bf16 a[160:175], v[68:71], a[76:79], a[160:175]
s_waitcnt lgkmcnt(2)
v_mfma_f32_32x32x16_bf16 a[176:191], v[72:75], a[76:79], a[176:191]
s_waitcnt lgkmcnt(0)
v_mfma_f32_32x32x16_bf16 a[192:207], v[76:79], a[76:79], a[192:207]
s_waitcnt vmcnt(18)
s_waitcnt vmcnt(12)
s_barrier
v_add_u32 v20, 49152, v17
v_xad_u32 v21, v20, 64, s74
v_xor_b32 v22, 32, v20
v_xor_b32 v23, 32, v21
v_add_u32 v24, 110592, v18
v_xor_b32 v25, 32, v24
v_xor_b32 v26, 64, v24
v_xor_b32 v27, 96, v24
ds_read_b128 a[80:83], v24
ds_read_b64_tr_b16 v[56:57], v20
ds_read_b64_tr_b16 v[58:59], v22 offset:1536
ds_read_b64_tr_b16 v[60:61], v21
ds_read_b64_tr_b16 v[62:63], v23 offset:1536
ds_read_b64_tr_b16 v[64:65], v20 offset:128
ds_read_b64_tr_b16 v[66:67], v22 offset:1664
ds_read_b128 a[84:87], v25
ds_read_b64_tr_b16 v[68:69], v20 offset:6144
ds_read_b64_tr_b16 v[70:71], v22 offset:7680
ds_read_b64_tr_b16 v[72:73], v21 offset:6144
ds_read_b64_tr_b16 v[74:75], v23 offset:7680
s_waitcnt lgkmcnt(9)
v_mfma_f32_32x32x16_bf16 a[160:175], v[56:59], a[80:83], a[160:175]
ds_read_b64_tr_b16 v[76:77], v20 offset:6272
ds_read_b64_tr_b16 v[78:79], v22 offset:7808
s_waitcnt lgkmcnt(9)
v_mfma_f32_32x32x16_bf16 a[176:191], v[60:63], a[80:83], a[176:191]
ds_read_b128 a[88:91], v26
ds_read_b64_tr_b16 v[56:57], v20 offset:12288
ds_read_b64_tr_b16 v[58:59], v22 offset:13824
s_waitcnt lgkmcnt(10)
v_mfma_f32_32x32x16_bf16 a[192:207], v[64:67], a[80:83], a[192:207]
ds_read_b64_tr_b16 v[60:61], v21 offset:12288
ds_read_b64_tr_b16 v[62:63], v23 offset:13824
s_waitcnt lgkmcnt(9)
v_mfma_f32_32x32x16_bf16 a[160:175], v[68:71], a[84:87], a[160:175]
ds_read_b64_tr_b16 v[64:65], v20 offset:12416
ds_read_b64_tr_b16 v[66:67], v22 offset:13952
s_waitcnt lgkmcnt(9)
v_mfma_f32_32x32x16_bf16 a[176:191], v[72:75], a[84:87], a[176:191]
ds_read_b128 a[92:95], v27
ds_read_b64_tr_b16 v[68:69], v20 offset:18432
ds_read_b64_tr_b16 v[70:71], v22 offset:19968
s_waitcnt lgkmcnt(10)
v_mfma_f32_32x32x16_bf16 a[192:207], v[76:79], a[84:87], a[192:207]
ds_read_b64_tr_b16 v[72:73], v21 offset:18432
ds_read_b64_tr_b16 v[74:75], v23 offset:19968
s_waitcnt lgkmcnt(9)
v_mfma_f32_32x32x16_bf16 a[160:175], v[56:59], a[88:91], a[160:175]
ds_read_b64_tr_b16 v[76:77], v20 offset:18560
ds_read_b64_tr_b16 v[78:79], v22 offset:20096
s_waitcnt lgkmcnt(9)
v_mfma_f32_32x32x16_bf16 a[176:191], v[60:63], a[88:91], a[176:191]
v_add_u32 v20, 135168, v17
v_xad_u32 v21, v20, 64, s74
v_xor_b32 v22, 32, v20
v_xor_b32 v23, 32, v21
v_add_u32 v24, 102400, v18
v_xor_b32 v25, 32, v24
v_xor_b32 v26, 64, v24
v_xor_b32 v27, 96, v24
ds_read_b128 a[96:99], v24
ds_read_b64_tr_b16 v[56:57], v20
ds_read_b64_tr_b16 v[58:59], v22 offset:1536
s_waitcnt lgkmcnt(10)
v_mfma_f32_32x32x16_bf16 a[192:207], v[64:67], a[88:91], a[192:207]
ds_read_b64_tr_b16 v[60:61], v21
ds_read_b64_tr_b16 v[62:63], v23 offset:1536
s_waitcnt lgkmcnt(9)
v_mfma_f32_32x32x16_bf16 a[160:175], v[68:71], a[92:95], a[160:175]
ds_read_b64_tr_b16 v[64:65], v20 offset:128
ds_read_b64_tr_b16 v[66:67], v22 offset:1664
s_waitcnt lgkmcnt(9)
v_mfma_f32_32x32x16_bf16 a[176:191], v[72:75], a[92:95], a[176:191]
ds_read_b128 a[100:103], v25
ds_read_b64_tr_b16 v[68:69], v20 offset:6144
ds_read_b64_tr_b16 v[70:71], v22 offset:7680
s_waitcnt lgkmcnt(10)
v_mfma_f32_32x32x16_bf16 a[192:207], v[76:79], a[92:95], a[192:207]
s_waitcnt vmcnt(6)
s_barrier
ds_read_b64_tr_b16 v[72:73], v21 offset:6144
ds_read_b64_tr_b16 v[74:75], v23 offset:7680
s_waitcnt lgkmcnt(9)
v_mfma_f32_32x32x16_bf16 a[160:175], v[56:59], a[96:99], a[160:175]
s_add_u32 s61, s84, 8
s_cmp_ge_u32 s61, 10
s_cselect_b32 s73, 10, 0
s_sub_u32 s61, s61, s73
s_mul_i32 s61, s61, 786432
s_add_u32 s61, s61, s86
s_add_u32 m0, s83, 49152
s_nop 0
buffer_load_dwordx4 v7, s[28:31], s61 offen lds
buffer_load_dwordx4 v8, s[28:31], s61 offen offset:1024 lds
buffer_load_dwordx4 v9, s[28:31], s61 offen offset:2048 lds
ds_read_b64_tr_b16 v[76:77], v20 offset:6272
ds_read_b64_tr_b16 v[78:79], v22 offset:7808
s_waitcnt lgkmcnt(9)
v_mfma_f32_32x32x16_bf16 a[176:191], v[60:63], a[96:99], a[176:191]
buffer_load_dwordx4 v10, s[28:31], s61 offen offset:3072 lds
s_add_u32 m0, s83, 53248
s_nop 0
buffer_load_dwordx4 v11, s[28:31], s61 offen lds
buffer_load_dwordx4 v12, s[28:31], s61 offen offset:1024 lds
ds_read_b128 a[104:107], v26
ds_read_b64_tr_b16 v[56:57], v20 offset:12288
ds_read_b64_tr_b16 v[58:59], v22 offset:13824
s_waitcnt lgkmcnt(10)
v_mfma_f32_32x32x16_bf16 a[192:207], v[64:67], a[96:99], a[192:207]
s_add_u32 s61, s84, 9
s_cmp_ge_u32 s61, 10
s_cselect_b32 s73, 10, 0
s_sub_u32 s61, s61, s73
s_mul_i32 s61, s61, 786432
s_add_u32 s61, s61, s86
s_add_u32 m0, s83, 110592
s_nop 0
buffer_load_dwordx4 v7, s[28:31], s61 offen lds
buffer_load_dwordx4 v8, s[28:31], s61 offen offset:1024 lds
ds_read_b64_tr_b16 v[60:61], v21 offset:12288
ds_read_b64_tr_b16 v[62:63], v23 offset:13824
s_waitcnt lgkmcnt(9)
v_mfma_f32_32x32x16_bf16 a[160:175], v[68:71], a[100:103], a[160:175]
buffer_load_dwordx4 v9, s[28:31], s61 offen offset:2048 lds
buffer_load_dwordx4 v10, s[28:31], s61 offen offset:3072 lds
s_add_u32 m0, s83, 114688
s_nop 0
buffer_load_dwordx4 v11, s[28:31], s61 offen lds
ds_read_b64_tr_b16 v[64:65], v20 offset:12416
ds_read_b64_tr_b16 v[66:67], v22 offset:13952
s_waitcnt lgkmcnt(9)
v_mfma_f32_32x32x16_bf16 a[176:191], v[72:75], a[100:103], a[176:191]
buffer_load_dwordx4 v12, s[28:31], s61 offen offset:1024 lds
s_add_u32 s61, s67, 2
s_and_b32 s61, s61, 7
s_mul_i32 s61, s61, 24576
s_add_u32 s61, s61, s83
buffer_load_dwordx4 v[176:179], v1, s[20:23], s61 offen nt
ds_read_b128 a[108:111], v27
ds_read_b64_tr_b16 v[68:69], v20 offset:18432
ds_read_b64_tr_b16 v[70:71], v22 offset:19968
s_waitcnt lgkmcnt(10)
v_mfma_f32_32x32x16_bf16 a[192:207], v[76:79], a[100:103], a[192:207]
buffer_load_dwordx4 v[180:183], v2, s[20:23], s61 offen offset:1024 nt
buffer_load_dwordx4 v[184:187], v3, s[20:23], s61 offen offset:2048 nt
buffer_load_dwordx4 v[188:191], v4, s[20:23], s61 offen offset:3072 nt
ds_read_b64_tr_b16 v[72:73], v21 offset:18432
ds_read_b64_tr_b16 v[74:75], v23 offset:19968
s_waitcnt lgkmcnt(9)
v_mfma_f32_32x32x16_bf16 a[160:175], v[56:59], a[104:107], a[160:175]
buffer_load_dwordx4 v[192:195], v5, s[20:23], s61 offen nt
buffer_load_dwordx4 v[196:199], v6, s[20:23], s61 offen offset:1024 nt
ds_read_b64_tr_b16 v[76:77], v20 offset:18560
ds_read_b64_tr_b16 v[78:79], v22 offset:20096
s_waitcnt lgkmcnt(9)
v_mfma_f32_32x32x16_bf16 a[176:191], v[60:63], a[104:107], a[176:191]
v_add_u32 v20, 0, v17
v_xad_u32 v21, v20, 64, s74
v_xor_b32 v22, 32, v20
v_xor_b32 v23, 32, v21
v_add_u32 v24, 94208, v18
v_xor_b32 v25, 32, v24
v_xor_b32 v26, 64, v24
v_xor_b32 v27, 96, v24
ds_read_b128 a[112:115], v24
ds_read_b64_tr_b16 v[56:57], v20
ds_read_b64_tr_b16 v[58:59], v22 offset:1536
s_waitcnt lgkmcnt(10)
v_mfma_f32_32x32x16_bf16 a[192:207], v[64:67], a[104:107], a[192:207]
ds_read_b64_tr_b16 v[60:61], v21
ds_read_b64_tr_b16 v[62:63], v23 offset:1536
s_waitcnt lgkmcnt(9)
v_mfma_f32_32x32x16_bf16 a[160:175], v[68:71], a[108:111], a[160:175]
ds_read_b64_tr_b16 v[64:65], v20 offset:128
ds_read_b64_tr_b16 v[66:67], v22 offset:1664
s_waitcnt lgkmcnt(9)
v_mfma_f32_32x32x16_bf16 a[176:191], v[72:75], a[108:111], a[176:191]
ds_read_b128 a[116:119], v25
ds_read_b64_tr_b16 v[68:69], v20 offset:6144
ds_read_b64_tr_b16 v[70:71], v22 offset:7680
s_waitcnt lgkmcnt(10)
v_mfma_f32_32x32x16_bf16 a[192:207], v[76:79], a[108:111], a[192:207]
s_barrier
ds_read_b64_tr_b16 v[72:73], v21 offset:6144
ds_read_b64_tr_b16 v[74:75], v23 offset:7680
s_waitcnt lgkmcnt(9)
v_mfma_f32_32x32x16_bf16 a[160:175], v[56:59], a[112:115], a[160:175]
s_add_u32 s61, s84, 0
s_cmp_ge_u32 s61, 10
s_cselect_b32 s73, 10, 0
s_sub_u32 s61, s61, s73
s_mul_i32 s61, s61, 786432
s_add_u32 s61, s61, s86
s_add_u32 s61, s61, 384
s_add_u32 m0, s83, 135168
s_nop 0
buffer_load_dwordx4 v7, s[28:31], s61 offen lds
ds_read_b64_tr_b16 v[76:77], v20 offset:6272
ds_read_b64_tr_b16 v[78:79], v22 offset:7808
s_waitcnt lgkmcnt(9)
v_mfma_f32_32x32x16_bf16 a[176:191], v[60:63], a[112:115], a[176:191]
buffer_load_dwordx4 v8, s[28:31], s61 offen offset:1024 lds
ds_read_b128 a[120:123], v26
ds_read_b64_tr_b16 v[56:57], v20 offset:12288
ds_read_b64_tr_b16 v[58:59], v22 offset:13824
s_waitcnt lgkmcnt(10)
v_mfma_f32_32x32x16_bf16 a[192:207], v[64:67], a[112:115], a[192:207]
buffer_load_dwordx4 v9, s[28:31], s61 offen offset:2048 lds
ds_read_b64_tr_b16 v[60:61], v21 offset:12288
ds_read_b64_tr_b16 v[62:63], v23 offset:13824
s_waitcnt lgkmcnt(9)
v_mfma_f32_32x32x16_bf16 a[160:175], v[68:71], a[116:119], a[160:175]
buffer_load_dwordx4 v10, s[28:31], s61 offen offset:3072 lds
ds_read_b64_tr_b16 v[64:65], v20 offset:12416
ds_read_b64_tr_b16 v[66:67], v22 offset:13952
s_waitcnt lgkmcnt(9)
v_mfma_f32_32x32x16_bf16 a[176:191], v[72:75], a[116:119], a[176:191]
s_add_u32 m0, s83, 139264
s_nop 0
buffer_load_dwordx4 v11, s[28:31], s61 offen lds
ds_read_b128 a[124:127], v27
ds_read_b64_tr_b16 v[68:69], v20 offset:18432
ds_read_b64_tr_b16 v[70:71], v22 offset:19968
s_waitcnt lgkmcnt(10)
v_mfma_f32_32x32x16_bf16 a[192:207], v[76:79], a[116:119], a[192:207]
buffer_load_dwordx4 v12, s[28:31], s61 offen offset:1024 lds
ds_read_b64_tr_b16 v[72:73], v21 offset:18432
ds_read_b64_tr_b16 v[74:75], v23 offset:19968
s_waitcnt lgkmcnt(9)
v_mfma_f32_32x32x16_bf16 a[160:175], v[56:59], a[120:123], a[160:175]
ds_read_b64_tr_b16 v[76:77], v20 offset:18560
ds_read_b64_tr_b16 v[78:79], v22 offset:20096
s_waitcnt lgkmcnt(9)
v_mfma_f32_32x32x16_bf16 a[176:191], v[60:63], a[120:123], a[176:191]
s_waitcnt lgkmcnt(7)
v_mfma_f32_32x32x16_bf16 a[192:207], v[64:67], a[120:123], a[192:207]
s_waitcnt lgkmcnt(4)
v_mfma_f32_32x32x16_bf16 a[160:175], v[68:71], a[124:127], a[160:175]
s_waitcnt lgkmcnt(2)
v_mfma_f32_32x32x16_bf16 a[176:191], v[72:75], a[124:127], a[176:191]
s_waitcnt lgkmcnt(0)
v_mfma_f32_32x32x16_bf16 a[192:207], v[76:79], a[124:127], a[192:207]
s_waitcnt vmcnt(18)
s_waitcnt vmcnt(12)
s_barrier
v_add_u32 v20, 49152, v17
v_xad_u32 v21, v20, 64, s74
v_xor_b32 v22, 32, v20
v_xor_b32 v23, 32, v21
v_add_u32 v24, 86016, v18
v_xor_b32 v25, 32, v24
v_xor_b32 v26, 64, v24
v_xor_b32 v27, 96, v24
ds_read_b128 a[128:131], v24
ds_read_b64_tr_b16 v[56:57], v20
ds_read_b64_tr_b16 v[58:59], v22 offset:1536
ds_read_b64_tr_b16 v[60:61], v21
ds_read_b64_tr_b16 v[62:63], v23 offset:1536
ds_read_b64_tr_b16 v[64:65], v20 offset:128
ds_read_b64_tr_b16 v[66:67], v22 offset:1664
ds_read_b128 a[132:135], v25
ds_read_b64_tr_b16 v[68:69], v20 offset:6144
ds_read_b64_tr_b16 v[70:71], v22 offset:7680
ds_read_b64_tr_b16 v[72:73], v21 offset:6144
ds_read_b64_tr_b16 v[74:75], v23 offset:7680
s_waitcnt lgkmcnt(9)
v_mfma_f32_32x32x16_bf16 a[160:175], v[56:59], a[128:131], a[160:175]
v_add_u32 v54, 24576, v48
v_add_u32 v54, s83, v54
ds_read_b64_tr_b16 v[76:77], v20 offset:6272
ds_read_b64_tr_b16 v[78:79], v22 offset:7808
s_waitcnt lgkmcnt(9)
v_mfma_f32_32x32x16_bf16 a[176:191], v[60:63], a[128:131], a[176:191]
ds_write_b128 v54, v[128:131]
ds_read_b128 a[136:139], v26
ds_read_b64_tr_b16 v[56:57], v20 offset:12288
ds_read_b64_tr_b16 v[58:59], v22 offset:13824
s_waitcnt lgkmcnt(11)
v_mfma_f32_32x32x16_bf16 a[192:207], v[64:67], a[128:131], a[192:207]
ds_read_b64_tr_b16 v[60:61], v21 offset:12288
ds_read_b64_tr_b16 v[62:63], v23 offset:13824
s_waitcnt lgkmcnt(10)
v_mfma_f32_32x32x16_bf16 a[160:175], v[68:71], a[132:135], a[160:175]
ds_write_b128 v54, v[132:135] offset:1024
ds_read_b64_tr_b16 v[64:65], v20 offset:12416
ds_read_b64_tr_b16 v[66:67], v22 offset:13952
s_waitcnt lgkmcnt(11)
v_mfma_f32_32x32x16_bf16 a[176:191], v[72:75], a[132:135], a[176:191]
ds_write_b128 v54, v[136:139] offset:2048
ds_read_b128 a[140:143], v27
ds_read_b64_tr_b16 v[68:69], v20 offset:18432
ds_read_b64_tr_b16 v[70:71], v22 offset:19968
s_waitcnt lgkmcnt(13)
v_mfma_f32_32x32x16_bf16 a[192:207], v[76:79], a[132:135], a[192:207]
ds_read_b64_tr_b16 v[72:73], v21 offset:18432
ds_read_b64_tr_b16 v[74:75], v23 offset:19968
s_waitcnt lgkmcnt(11)
v_mfma_f32_32x32x16_bf16 a[160:175], v[56:59], a[136:139], a[160:175]
ds_write_b128 v54, v[140:143] offset:3072
ds_read_b64_tr_b16 v[76:77], v20 offset:18560
ds_read_b64_tr_b16 v[78:79], v22 offset:20096
s_waitcnt lgkmcnt(12)
v_mfma_f32_32x32x16_bf16 a[176:191], v[60:63], a[136:139], a[176:191]
ds_write_b128 v54, v[144:147] offset:4096
v_add_u32 v20, 110592, v17
v_xad_u32 v21, v20, 64, s74
v_xor_b32 v22, 32, v20
v_xor_b32 v23, 32, v21
v_add_u32 v24, 77824, v18
v_xor_b32 v25, 32, v24
v_xor_b32 v26, 64, v24
v_xor_b32 v27, 96, v24
ds_read_b128 a[144:147], v24
ds_read_b64_tr_b16 v[56:57], v20
ds_read_b64_tr_b16 v[58:59], v22 offset:1536
s_waitcnt lgkmcnt(13)
v_mfma_f32_32x32x16_bf16 a[192:207], v[64:67], a[136:139], a[192:207]
ds_read_b64_tr_b16 v[60:61], v21
ds_read_b64_tr_b16 v[62:63], v23 offset:1536
s_waitcnt lgkmcnt(11)
v_mfma_f32_32x32x16_bf16 a[160:175], v[68:71], a[140:143], a[160:175]
ds_write_b128 v54, v[148:151] offset:5120
ds_read_b64_tr_b16 v[64:65], v20 offset:128
ds_read_b64_tr_b16 v[66:67], v22 offset:1664
s_waitcnt lgkmcnt(12)
v_mfma_f32_32x32x16_bf16 a[176:191], v[72:75], a[140:143], a[176:191]
s_waitcnt lgkmcnt(2)
ds_read_b128 a[148:151], v25
ds_read_b64_tr_b16 v[68:69], v20 offset:6144
ds_read_b64_tr_b16 v[70:71], v22 offset:7680
v_mfma_f32_32x32x16_bf16 a[192:207], v[76:79], a[140:143], a[192:207]
s_barrier
ds_read_b64_tr_b16 v[72:73], v21 offset:6144
ds_read_b64_tr_b16 v[74:75], v23 offset:7680
v_mfma_f32_32x32x16_bf16 a[160:175], v[56:59], a[144:147], a[160:175]
s_add_u32 s61, s84, 1
s_cmp_ge_u32 s61, 10
s_cselect_b32 s73, 10, 0
s_sub_u32 s61, s61, s73
s_mul_i32 s61, s61, 786432
s_add_u32 s61, s61, s86
s_add_u32 s61, s61, 384
s_add_u32 m0, s83, 49152
s_nop 0
buffer_load_dwordx4 v7, s[28:31], s61 offen lds
ds_read_b64_tr_b16 v[76:77], v20 offset:6272
ds_read_b64_tr_b16 v[78:79], v22 offset:7808
v_mfma_f32_32x32x16_bf16 a[176:191], v[60:63], a[144:147], a[176:191]
buffer_load_dwordx4 v8, s[28:31], s61 offen offset:1024 lds
ds_read_b128 a[152:155], v26
ds_read_b64_tr_b16 v[56:57], v20 offset:12288
ds_read_b64_tr_b16 v[58:59], v22 offset:13824
s_waitcnt lgkmcnt(10)
v_mfma_f32_32x32x16_bf16 a[192:207], v[64:67], a[144:147], a[192:207]
buffer_load_dwordx4 v9, s[28:31], s61 offen offset:2048 lds
ds_read_b64_tr_b16 v[60:61], v21 offset:12288
ds_read_b64_tr_b16 v[62:63], v23 offset:13824
s_waitcnt lgkmcnt(9)
v_mfma_f32_32x32x16_bf16 a[160:175], v[68:71], a[148:151], a[160:175]
buffer_load_dwordx4 v10, s[28:31], s61 offen offset:3072 lds
ds_read_b64_tr_b16 v[64:65], v20 offset:12416
ds_read_b64_tr_b16 v[66:67], v22 offset:13952
s_waitcnt lgkmcnt(9)
v_mfma_f32_32x32x16_bf16 a[176:191], v[72:75], a[148:151], a[176:191]
s_add_u32 m0, s83, 53248
s_nop 0
buffer_load_dwordx4 v11, s[28:31], s61 offen lds
ds_read_b128 a[156:159], v27
ds_read_b64_tr_b16 v[68:69], v20 offset:18432
ds_read_b64_tr_b16 v[70:71], v22 offset:19968
s_waitcnt lgkmcnt(10)
v_mfma_f32_32x32x16_bf16 a[192:207], v[76:79], a[148:151], a[192:207]
buffer_load_dwordx4 v12, s[28:31], s61 offen offset:1024 lds
ds_read_b64_tr_b16 v[72:73], v21 offset:18432
ds_read_b64_tr_b16 v[74:75], v23 offset:19968
s_waitcnt lgkmcnt(9)
v_mfma_f32_32x32x16_bf16 a[160:175], v[56:59], a[152:155], a[160:175]
ds_read_b64_tr_b16 v[76:77], v20 offset:18560
ds_read_b64_tr_b16 v[78:79], v22 offset:20096
s_waitcnt lgkmcnt(9)
v_mfma_f32_32x32x16_bf16 a[176:191], v[60:63], a[152:155], a[176:191]
s_waitcnt lgkmcnt(7)
v_mfma_f32_32x32x16_bf16 a[192:207], v[64:67], a[152:155], a[192:207]
s_waitcnt lgkmcnt(4)
v_mfma_f32_32x32x16_bf16 a[160:175], v[68:71], a[156:159], a[160:175]
s_waitcnt lgkmcnt(2)
v_mfma_f32_32x32x16_bf16 a[176:191], v[72:75], a[156:159], a[176:191]
s_waitcnt lgkmcnt(0)
v_mfma_f32_32x32x16_bf16 a[192:207], v[76:79], a[156:159], a[192:207]
s_barrier
s_nop 6
v_accvgpr_read_b32 v32, a160
v_accvgpr_read_b32 v33, a161
v_accvgpr_read_b32 v34, a162
v_accvgpr_read_b32 v35, a163
v_accvgpr_read_b32 v36, a164
v_accvgpr_read_b32 v37, a165
v_accvgpr_read_b32 v38, a166
v_accvgpr_read_b32 v39, a167
v_cvt_pk_bf16_f32 v40, v32, v33
v_cvt_pk_bf16_f32 v41, v34, v35
v_cvt_pk_bf16_f32 v42, v36, v37
v_cvt_pk_bf16_f32 v43, v38, v39
s_nop 0
v_permlane32_swap_b32 v40, v42
v_permlane32_swap_b32 v41, v43
v_add_u32 v32, 0, v49
ds_write_b128 v32, v[40:43]
s_nop 1
v_accvgpr_read_b32 v32, a168
v_accvgpr_read_b32 v33, a169
v_accvgpr_read_b32 v34, a170
v_accvgpr_read_b32 v35, a171
v_accvgpr_read_b32 v36, a172
v_accvgpr_read_b32 v37, a173
v_accvgpr_read_b32 v38, a174
v_accvgpr_read_b32 v39, a175
v_cvt_pk_bf16_f32 v40, v32, v33
v_cvt_pk_bf16_f32 v41, v34, v35
v_cvt_pk_bf16_f32 v42, v36, v37
v_cvt_pk_bf16_f32 v43, v38, v39
s_nop 0
v_permlane32_swap_b32 v40, v42
v_permlane32_swap_b32 v41, v43
v_add_u32 v32, 0, v49
ds_write_b128 v32, v[40:43] offset:1024
s_nop 1
v_accvgpr_read_b32 v32, a176
v_accvgpr_read_b32 v33, a177
v_accvgpr_read_b32 v34, a178
v_accvgpr_read_b32 v35, a179
v_accvgpr_read_b32 v36, a180
v_accvgpr_read_b32 v37, a181
v_accvgpr_read_b32 v38, a182
v_accvgpr_read_b32 v39, a183
v_cvt_pk_bf16_f32 v40, v32, v33
v_cvt_pk_bf16_f32 v41, v34, v35
v_cvt_pk_bf16_f32 v42, v36, v37
v_cvt_pk_bf16_f32 v43, v38, v39
s_nop 0
v_permlane32_swap_b32 v40, v42
v_permlane32_swap_b32 v41, v43
v_add_u32 v32, 0, v49
ds_write_b128 v32, v[40:43] offset:2048
s_nop 1
v_accvgpr_read_b32 v32, a184
v_accvgpr_read_b32 v33, a185
v_accvgpr_read_b32 v34, a186
v_accvgpr_read_b32 v35, a187
v_accvgpr_read_b32 v36, a188
v_accvgpr_read_b32 v37, a189
v_accvgpr_read_b32 v38, a190
v_accvgpr_read_b32 v39, a191
v_cvt_pk_bf16_f32 v40, v32, v33
v_cvt_pk_bf16_f32 v41, v34, v35
v_cvt_pk_bf16_f32 v42, v36, v37
v_cvt_pk_bf16_f32 v43, v38, v39
s_nop 0
v_permlane32_swap_b32 v40, v42
v_permlane32_swap_b32 v41, v43
v_add_u32 v32, 0, v49
ds_write_b128 v32, v[40:43] offset:3072
s_nop 1
v_accvgpr_read_b32 v32, a192
v_accvgpr_read_b32 v33, a193
v_accvgpr_read_b32 v34, a194
v_accvgpr_read_b32 v35, a195
v_accvgpr_read_b32 v36, a196
v_accvgpr_read_b32 v37, a197
v_accvgpr_read_b32 v38, a198
v_accvgpr_read_b32 v39, a199
v_cvt_pk_bf16_f32 v40, v32, v33
v_cvt_pk_bf16_f32 v41, v34, v35
v_cvt_pk_bf16_f32 v42, v36, v37
v_cvt_pk_bf16_f32 v43, v38, v39
s_nop 0
v_permlane32_swap_b32 v40, v42
v_permlane32_swap_b32 v41, v43
v_add_u32 v32, 0, v49
ds_write_b128 v32, v[40:43] offset:4096
s_nop 1
v_accvgpr_read_b32 v32, a200
v_accvgpr_read_b32 v33, a201
v_accvgpr_read_b32 v34, a202
v_accvgpr_read_b32 v35, a203
v_accvgpr_read_b32 v36, a204
v_accvgpr_read_b32 v37, a205
v_accvgpr_read_b32 v38, a206
v_accvgpr_read_b32 v39, a207
v_cvt_pk_bf16_f32 v40, v32, v33
v_cvt_pk_bf16_f32 v41, v34, v35
v_cvt_pk_bf16_f32 v42, v36, v37
v_cvt_pk_bf16_f32 v43, v38, v39
s_nop 0
v_permlane32_swap_b32 v40, v42
v_permlane32_swap_b32 v41, v43
v_add_u32 v32, 0, v49
ds_write_b128 v32, v[40:43] offset:5120
s_waitcnt lgkmcnt(0)
s_barrier
v_add_u32 v44, 0, v50
ds_read_b128 v[80:83], v44
ds_read_b128 v[84:87], v44 offset:1024
ds_read_b128 v[88:91], v44 offset:2048
ds_read_b128 v[92:95], v44 offset:3072
ds_read_b128 v[96:99], v44 offset:4096
ds_read_b128 v[100:103], v44 offset:5120
ds_read_b128 v[104:107], v44 offset:6144
ds_read_b128 v[108:111], v44 offset:7168
ds_read_b128 v[112:115], v44 offset:8192
ds_read_b128 v[116:119], v44 offset:9216
ds_read_b128 v[120:123], v44 offset:10240
ds_read_b128 v[124:127], v44 offset:11264
s_waitcnt lgkmcnt(0)
s_waitcnt vmcnt(6)
s_barrier
v_add_u32 v20, 24576, v15
v_xor_b32 v21, 32, v20
v_xor_b32 v22, 64, v20
v_xor_b32 v23, 96, v20
ds_read_b128 v[56:59], v20
ds_read_b128 v[60:63], v21
ds_read_b128 v[64:67], v22
ds_read_b128 v[68:71], v23
ds_read_b128 v[72:75], v20 offset:128
s_waitcnt lgkmcnt(4)
v_mfma_f32_32x32x16_bf16 v[128:143], v[56:59], v[80:83], 0
s_add_u32 s61, s84, 2
s_cmp_ge_u32 s61, 10
s_cselect_b32 s73, 10, 0
s_sub_u32 s61, s61, s73
s_mul_i32 s61, s61, 786432
s_add_u32 s61, s61, s86
s_add_u32 s61, s61, 384
s_add_u32 m0, s83, 73728
s_nop 0
buffer_load_dwordx4 v7, s[28:31], s61 offen lds
buffer_load_dwordx4 v8, s[28:31], s61 offen offset:1024 lds
ds_read_b128 v[76:79], v21 offset:128
s_waitcnt lgkmcnt(4)
v_mfma_f32_32x32x16_bf16 v[128:143], v[60:63], v[84:87], v[128:143]
buffer_load_dwordx4 v9, s[28:31], s61 offen offset:2048 lds
buffer_load_dwordx4 v10, s[28:31], s61 offen offset:3072 lds
ds_read_b128 v[56:59], v22 offset:128
s_waitcnt lgkmcnt(4)
v_mfma_f32_32x32x16_bf16 v[128:143], v[64:67], v[88:91], v[128:143]
s_add_u32 m0, s83, 77824
s_nop 0
buffer_load_dwordx4 v11, s[28:31], s61 offen lds
buffer_load_dwordx4 v12, s[28:31], s61 offen offset:1024 lds
ds_read_b128 v[60:63], v23 offset:128
s_waitcnt lgkmcnt(4)
v_mfma_f32_32x32x16_bf16 v[128:143], v[68:71], v[92:95], v[128:143]
s_add_u32 s61, s67, 3
s_and_b32 s61, s61, 7
s_mul_i32 s61, s61, 24576
s_add_u32 s61, s61, s83
s_add_u32 m0, s83, 98304
s_nop 0
buffer_load_dwordx4 v1, s[20:23], s61 offen nt lds
ds_read_b128 v[64:67], v20 offset:256
s_waitcnt lgkmcnt(4)
v_mfma_f32_32x32x16_bf16 v[128:143], v[72:75], v[96:99], v[128:143]
buffer_load_dwordx4 v2, s[20:23], s61 offen offset:1024 nt lds
buffer_load_dwordx4 v3, s[20:23], s61 offen offset:2048 nt lds
ds_read_b128 v[68:71], v21 offset:256
s_waitcnt lgkmcnt(4)
v_mfma_f32_32x32x16_bf16 v[128:143], v[76:79], v[100:103], v[128:143]
buffer_load_dwordx4 v4, s[20:23], s61 offen offset:3072 nt lds
s_add_u32 m0, s83, 102400
s_nop 0
buffer_load_dwordx4 v5, s[20:23], s61 offen nt lds
ds_read_b128 v[72:75], v22 offset:256
s_waitcnt lgkmcnt(4)
v_mfma_f32_32x32x16_bf16 v[128:143], v[56:59], v[104:107], v[128:143]
buffer_load_dwordx4 v6, s[20:23], s61 offen offset:1024 nt lds
ds_read_b128 v[76:79], v23 offset:256
s_waitcnt lgkmcnt(4)
v_mfma_f32_32x32x16_bf16 v[128:143], v[60:63], v[108:111], v[128:143]
v_add_u32 v54, 0, v48
v_add_u32 v54, s83, v54
ds_write_b128 v54, v[152:155]
v_add_u32 v20, 135168, v17
v_xad_u32 v21, v20, 64, s74
v_xor_b32 v22, 32, v20
v_xor_b32 v23, 32, v21
ds_read_b64_tr_b16 v[56:57], v20
ds_read_b64_tr_b16 v[58:59], v22 offset:1536
s_waitcnt lgkmcnt(6)
v_mfma_f32_32x32x16_bf16 v[128:143], v[64:67], v[112:115], v[128:143]
ds_write_b128 v54, v[156:159] offset:1024
ds_read_b64_tr_b16 v[60:61], v21
ds_read_b64_tr_b16 v[62:63], v23 offset:1536
s_waitcnt lgkmcnt(8)
v_mfma_f32_32x32x16_bf16 v[128:143], v[68:71], v[116:119], v[128:143]
ds_write_b128 v54, v[160:163] offset:2048
ds_write_b128 v54, v[164:167] offset:3072
ds_read_b64_tr_b16 v[64:65], v20 offset:128
ds_read_b64_tr_b16 v[66:67], v22 offset:1664
s_waitcnt lgkmcnt(11)
v_mfma_f32_32x32x16_bf16 v[128:143], v[72:75], v[120:123], v[128:143]
ds_write_b128 v54, v[168:171] offset:4096
ds_write_b128 v54, v[172:175] offset:5120
ds_read_b64_tr_b16 v[68:69], v20 offset:6144
ds_read_b64_tr_b16 v[70:71], v22 offset:7680
s_waitcnt lgkmcnt(14)
v_mfma_f32_32x32x16_bf16 v[128:143], v[76:79], v[124:127], v[128:143]
s_waitcnt lgkmcnt(2)
s_barrier
ds_read_b64_tr_b16 v[72:73], v21 offset:6144
ds_read_b64_tr_b16 v[74:75], v23 offset:7680
v_mfma_f32_32x32x16_bf16 a[160:175], v[56:59], a[0:3], 0
s_nop 6
v_max3_f32 v28, v128, v129, v130
ds_read_b64_tr_b16 v[76:77], v20 offset:6272
ds_read_b64_tr_b16 v[78:79], v22 offset:7808
v_mfma_f32_32x32x16_bf16 a[176:191], v[60:63], a[0:3], 0
v_max3_f32 v28, v28, v131, v132
ds_read_b64_tr_b16 v[56:57], v20 offset:12288
ds_read_b64_tr_b16 v[58:59], v22 offset:13824
v_mfma_f32_32x32x16_bf16 a[192:207], v[64:67], a[0:3], 0
ds_read_b64_tr_b16 v[60:61], v21 offset:12288
ds_read_b64_tr_b16 v[62:63], v23 offset:13824
s_waitcnt lgkmcnt(8)
v_mfma_f32_32x32x16_bf16 a[160:175], v[68:71], a[4:7], a[160:175]
v_max3_f32 v28, v28, v133, v134
ds_read_b64_tr_b16 v[64:65], v20 offset:12416
ds_read_b64_tr_b16 v[66:67], v22 offset:13952
s_waitcnt lgkmcnt(8)
v_mfma_f32_32x32x16_bf16 a[176:191], v[72:75], a[4:7], a[176:191]
v_max3_f32 v28, v28, v135, v136
ds_read_b64_tr_b16 v[68:69], v20 offset:18432
ds_read_b64_tr_b16 v[70:71], v22 offset:19968
s_waitcnt lgkmcnt(8)
v_mfma_f32_32x32x16_bf16 a[192:207], v[76:79], a[4:7], a[192:207]
ds_read_b64_tr_b16 v[72:73], v21 offset:18432
ds_read_b64_tr_b16 v[74:75], v23 offset:19968
s_waitcnt lgkmcnt(8)
v_mfma_f32_32x32x16_bf16 a[160:175], v[56:59], a[8:11], a[160:175]
v_max3_f32 v28, v28, v137, v138
ds_read_b64_tr_b16 v[76:77], v20 offset:18560
ds_read_b64_tr_b16 v[78:79], v22 offset:20096
s_waitcnt lgkmcnt(8)
v_mfma_f32_32x32x16_bf16 a[176:191], v[60:63], a[8:11], a[176:191]
v_max3_f32 v28, v28, v139, v140
v_add_u32 v20, 0, v15
v_xor_b32 v21, 32, v20
v_xor_b32 v22, 64, v20
v_xor_b32 v23, 96, v20
ds_read_b128 v[56:59], v20
s_waitcnt lgkmcnt(7)
v_mfma_f32_32x32x16_bf16 a[192:207], v[64:67], a[8:11], a[192:207]
ds_read_b128 v[60:63], v21
s_waitcnt lgkmcnt(6)
v_mfma_f32_32x32x16_bf16 a[160:175], v[68:71], a[12:15], a[160:175]
v_max3_f32 v28, v28, v141, v142
ds_read_b128 v[64:67], v22
s_waitcnt lgkmcnt(5)
v_mfma_f32_32x32x16_bf16 a[176:191], v[72:75], a[12:15], a[176:191]
v_max_f32 v28, v28, v143
ds_read_b128 v[68:71], v23
s_waitcnt lgkmcnt(4)
v_mfma_f32_32x32x16_bf16 a[192:207], v[76:79], a[12:15], a[192:207]
s_waitcnt vmcnt(12)
s_barrier
ds_read_b128 v[72:75], v20 offset:128
s_waitcnt lgkmcnt(4)
v_mfma_f32_32x32x16_bf16 v[144:159], v[56:59], v[80:83], 0
s_add_u32 s61, s84, 3
s_cmp_ge_u32 s61, 10
s_cselect_b32 s73, 10, 0
s_sub_u32 s61, s61, s73
s_mul_i32 s61, s61, 786432
s_add_u32 s61, s61, s86
s_add_u32 s61, s61, 384
s_add_u32 m0, s83, 122880
s_nop 0
buffer_load_dwordx4 v7, s[28:31], s61 offen lds
buffer_load_dwordx4 v8, s[28:31], s61 offen offset:1024 lds
ds_read_b128 v[76:79], v21 offset:128
s_waitcnt lgkmcnt(4)
v_mfma_f32_32x32x16_bf16 v[144:159], v[60:63], v[84:87], v[144:159]
buffer_load_dwordx4 v9, s[28:31], s61 offen offset:2048 lds
ds_read_b128 v[56:59], v22 offset:128
s_waitcnt lgkmcnt(4)
v_mfma_f32_32x32x16_bf16 v[144:159], v[64:67], v[88:91], v[144:159]
buffer_load_dwordx4 v10, s[28:31], s61 offen offset:3072 lds
ds_read_b128 v[60:63], v23 offset:128
s_waitcnt lgkmcnt(4)
v_mfma_f32_32x32x16_bf16 v[144:159], v[68:71], v[92:95], v[144:159]
s_add_u32 m0, s83, 126976
s_nop 0
buffer_load_dwordx4 v11, s[28:31], s61 offen lds
ds_read_b128 v[64:67], v20 offset:256
s_waitcnt lgkmcnt(4)
v_mfma_f32_32x32x16_bf16 v[144:159], v[72:75], v[96:99], v[144:159]
buffer_load_dwordx4 v12, s[28:31], s61 offen offset:1024 lds
ds_read_b128 v[68:71], v21 offset:256
s_waitcnt lgkmcnt(4)
v_mfma_f32_32x32x16_bf16 v[144:159], v[76:79], v[100:103], v[144:159]
v_add_u32 v54, 24576, v48
v_add_u32 v54, s83, v54
ds_read_b128 v[72:75], v22 offset:256
s_waitcnt lgkmcnt(4)
v_mfma_f32_32x32x16_bf16 v[144:159], v[56:59], v[104:107], v[144:159]
ds_write_b128 v54, v[176:179]
ds_write_b128 v54, v[180:183] offset:1024
ds_read_b128 v[76:79], v23 offset:256
s_waitcnt lgkmcnt(6)
v_mfma_f32_32x32x16_bf16 v[144:159], v[60:63], v[108:111], v[144:159]
ds_write_b128 v54, v[184:187] offset:2048
v_add_u32 v20, 49152, v17
v_xad_u32 v21, v20, 64, s74
v_xor_b32 v22, 32, v20
v_xor_b32 v23, 32, v21
ds_read_b64_tr_b16 v[56:57], v20
ds_read_b64_tr_b16 v[58:59], v22 offset:1536
s_waitcnt lgkmcnt(8)
v_mfma_f32_32x32x16_bf16 v[144:159], v[64:67], v[112:115], v[144:159]
ds_write_b128 v54, v[188:191] offset:3072
ds_read_b64_tr_b16 v[60:61], v21
ds_read_b64_tr_b16 v[62:63], v23 offset:1536
s_waitcnt lgkmcnt(10)
v_mfma_f32_32x32x16_bf16 v[144:159], v[68:71], v[116:119], v[144:159]
ds_write_b128 v54, v[192:195] offset:4096
ds_read_b64_tr_b16 v[64:65], v20 offset:128
ds_read_b64_tr_b16 v[66:67], v22 offset:1664
s_waitcnt lgkmcnt(12)
v_mfma_f32_32x32x16_bf16 v[144:159], v[72:75], v[120:123], v[144:159]
ds_write_b128 v54, v[196:199] offset:5120
ds_read_b64_tr_b16 v[68:69], v20 offset:6144
ds_read_b64_tr_b16 v[70:71], v22 offset:7680
s_waitcnt lgkmcnt(12)
v_mfma_f32_32x32x16_bf16 v[144:159], v[76:79], v[124:127], v[144:159]
s_waitcnt lgkmcnt(2)
s_barrier
ds_read_b64_tr_b16 v[72:73], v21 offset:6144
ds_read_b64_tr_b16 v[74:75], v23 offset:7680
v_mfma_f32_32x32x16_bf16 a[160:175], v[56:59], a[16:19], a[160:175]
s_add_u32 s61, s67, 4
s_and_b32 s61, s61, 7
s_mul_i32 s61, s61, 24576
s_add_u32 s61, s61, s83
s_add_u32 m0, s83, 0
s_nop 0
buffer_load_dwordx4 v1, s[20:23], s61 offen nt lds
buffer_load_dwordx4 v2, s[20:23], s61 offen offset:1024 nt lds
ds_read_b64_tr_b16 v[76:77], v20 offset:6272
ds_read_b64_tr_b16 v[78:79], v22 offset:7808
v_mfma_f32_32x32x16_bf16 a[176:191], v[60:63], a[16:19], a[176:191]
buffer_load_dwordx4 v3, s[20:23], s61 offen offset:2048 nt lds
ds_read_b64_tr_b16 v[56:57], v20 offset:12288
ds_read_b64_tr_b16 v[58:59], v22 offset:13824
v_mfma_f32_32x32x16_bf16 a[192:207], v[64:67], a[16:19], a[192:207]
buffer_load_dwordx4 v4, s[20:23], s61 offen offset:3072 nt lds
ds_read_b64_tr_b16 v[60:61], v21 offset:12288
ds_read_b64_tr_b16 v[62:63], v23 offset:13824
s_waitcnt lgkmcnt(8)
v_mfma_f32_32x32x16_bf16 a[160:175], v[68:71], a[20:23], a[160:175]
s_add_u32 m0, s83, 4096
s_nop 0
buffer_load_dwordx4 v5, s[20:23], s61 offen nt lds
ds_read_b64_tr_b16 v[64:65], v20 offset:12416
ds_read_b64_tr_b16 v[66:67], v22 offset:13952
s_waitcnt lgkmcnt(8)
v_mfma_f32_32x32x16_bf16 a[176:191], v[72:75], a[20:23], a[176:191]
buffer_load_dwordx4 v6, s[20:23], s61 offen offset:1024 nt lds
ds_read_b64_tr_b16 v[68:69], v20 offset:18432
ds_read_b64_tr_b16 v[70:71], v22 offset:19968
s_waitcnt lgkmcnt(8)
v_mfma_f32_32x32x16_bf16 a[192:207], v[76:79], a[20:23], a[192:207]
v_max3_f32 v28, v28, v144, v145
ds_read_b64_tr_b16 v[72:73], v21 offset:18432
ds_read_b64_tr_b16 v[74:75], v23 offset:19968
s_waitcnt lgkmcnt(8)
v_mfma_f32_32x32x16_bf16 a[160:175], v[56:59], a[24:27], a[160:175]
v_max3_f32 v28, v28, v146, v147
v_max3_f32 v28, v28, v148, v149
ds_read_b64_tr_b16 v[76:77], v20 offset:18560
ds_read_b64_tr_b16 v[78:79], v22 offset:20096
s_waitcnt lgkmcnt(8)
v_mfma_f32_32x32x16_bf16 a[176:191], v[60:63], a[24:27], a[176:191]
v_max3_f32 v28, v28, v150, v151
v_add_u32 v20, 24576, v15
v_xor_b32 v21, 32, v20
v_xor_b32 v22, 64, v20
v_xor_b32 v23, 96, v20
ds_read_b128 v[56:59], v20
s_waitcnt lgkmcnt(7)
v_mfma_f32_32x32x16_bf16 a[192:207], v[64:67], a[24:27], a[192:207]
v_max3_f32 v28, v28, v152, v153
ds_read_b128 v[60:63], v21
s_waitcnt lgkmcnt(6)
v_mfma_f32_32x32x16_bf16 a[160:175], v[68:71], a[28:31], a[160:175]
v_max3_f32 v28, v28, v154, v155
ds_read_b128 v[64:67], v22
s_waitcnt lgkmcnt(5)
v_mfma_f32_32x32x16_bf16 a[176:191], v[72:75], a[28:31], a[176:191]
v_max3_f32 v28, v28, v156, v157
ds_read_b128 v[68:71], v23
s_waitcnt lgkmcnt(4)
v_mfma_f32_32x32x16_bf16 a[192:207], v[76:79], a[28:31], a[192:207]
v_max3_f32 v28, v28, v158, v159
s_waitcnt vmcnt(18)
s_barrier
ds_read_b128 v[72:75], v20 offset:128
s_waitcnt lgkmcnt(4)
v_mfma_f32_32x32x16_bf16 v[160:175], v[56:59], v[80:83], 0
s_add_u32 s61, s84, 4
s_cmp_ge_u32 s61, 10
s_cselect_b32 s73, 10, 0
s_sub_u32 s61, s61, s73
s_mul_i32 s61, s61, 786432
s_add_u32 s61, s61, s86
s_add_u32 s61, s61, 384
s_add_u32 m0, s83, 49152
s_nop 0
buffer_load_dwordx4 v7, s[28:31], s61 offen lds
ds_read_b128 v[76:79], v21 offset:128
s_waitcnt lgkmcnt(4)
v_mfma_f32_32x32x16_bf16 v[160:175], v[60:63], v[84:87], v[160:175]
buffer_load_dwordx4 v8, s[28:31], s61 offen offset:1024 lds
ds_read_b128 v[56:59], v22 offset:128
s_waitcnt lgkmcnt(4)
v_mfma_f32_32x32x16_bf16 v[160:175], v[64:67], v[88:91], v[160:175]
buffer_load_dwordx4 v9, s[28:31], s61 offen offset:2048 lds
ds_read_b128 v[60:63], v23 offset:128
s_waitcnt lgkmcnt(4)
v_mfma_f32_32x32x16_bf16 v[160:175], v[68:71], v[92:95], v[160:175]
buffer_load_dwordx4 v10, s[28:31], s61 offen offset:3072 lds
ds_read_b128 v[64:67], v20 offset:256
s_waitcnt lgkmcnt(4)
v_mfma_f32_32x32x16_bf16 v[160:175], v[72:75], v[96:99], v[160:175]
s_add_u32 m0, s83, 53248
s_nop 0
buffer_load_dwordx4 v11, s[28:31], s61 offen lds
ds_read_b128 v[68:71], v21 offset:256
s_waitcnt lgkmcnt(4)
v_mfma_f32_32x32x16_bf16 v[160:175], v[76:79], v[100:103], v[160:175]
buffer_load_dwordx4 v12, s[28:31], s61 offen offset:1024 lds
ds_read_b128 v[72:75], v22 offset:256
s_waitcnt lgkmcnt(4)
v_mfma_f32_32x32x16_bf16 v[160:175], v[56:59], v[104:107], v[160:175]
ds_read_b128 v[76:79], v23 offset:256
s_waitcnt lgkmcnt(4)
v_mfma_f32_32x32x16_bf16 v[160:175], v[60:63], v[108:111], v[160:175]
v_add_u32 v20, 73728, v17
v_xad_u32 v21, v20, 64, s74
v_xor_b32 v22, 32, v20
v_xor_b32 v23, 32, v21
ds_read_b64_tr_b16 v[56:57], v20
ds_read_b64_tr_b16 v[58:59], v22 offset:1536
s_waitcnt lgkmcnt(5)
v_mfma_f32_32x32x16_bf16 v[160:175], v[64:67], v[112:115], v[160:175]
ds_read_b64_tr_b16 v[60:61], v21
ds_read_b64_tr_b16 v[62:63], v23 offset:1536
s_waitcnt lgkmcnt(6)
v_mfma_f32_32x32x16_bf16 v[160:175], v[68:71], v[116:119], v[160:175]
ds_read_b64_tr_b16 v[64:65], v20 offset:128
ds_read_b64_tr_b16 v[66:67], v22 offset:1664
s_waitcnt lgkmcnt(7)
v_mfma_f32_32x32x16_bf16 v[160:175], v[72:75], v[120:123], v[160:175]
ds_read_b64_tr_b16 v[68:69], v20 offset:6144
ds_read_b64_tr_b16 v[70:71], v22 offset:7680
s_waitcnt lgkmcnt(8)
v_mfma_f32_32x32x16_bf16 v[160:175], v[76:79], v[124:127], v[160:175]
s_waitcnt vmcnt(18)
s_barrier
ds_read_b64_tr_b16 v[72:73], v21 offset:6144
ds_read_b64_tr_b16 v[74:75], v23 offset:7680
s_waitcnt lgkmcnt(8)
v_mfma_f32_32x32x16_bf16 a[160:175], v[56:59], a[32:35], a[160:175]
s_add_u32 s61, s67, 5
s_and_b32 s61, s61, 7
s_mul_i32 s61, s61, 24576
s_add_u32 s61, s61, s83
s_add_u32 m0, s83, 24576
s_nop 0
buffer_load_dwordx4 v1, s[20:23], s61 offen nt lds
buffer_load_dwordx4 v2, s[20:23], s61 offen offset:1024 nt lds
ds_read_b64_tr_b16 v[76:77], v20 offset:6272
ds_read_b64_tr_b16 v[78:79], v22 offset:7808
s_waitcnt lgkmcnt(8)
v_mfma_f32_32x32x16_bf16 a[176:191], v[60:63], a[32:35], a[176:191]
buffer_load_dwordx4 v3, s[20:23], s61 offen offset:2048 nt lds
ds_read_b64_tr_b16 v[56:57], v20 offset:12288
ds_read_b64_tr_b16 v[58:59], v22 offset:13824
s_waitcnt lgkmcnt(8)
v_mfma_f32_32x32x16_bf16 a[192:207], v[64:67], a[32:35], a[192:207]
buffer_load_dwordx4 v4, s[20:23], s61 offen offset:3072 nt lds
ds_read_b64_tr_b16 v[60:61], v21 offset:12288
ds_read_b64_tr_b16 v[62:63], v23 offset:13824
s_waitcnt lgkmcnt(8)
v_mfma_f32_32x32x16_bf16 a[160:175], v[68:71], a[36:39], a[160:175]
s_add_u32 m0, s83, 28672
s_nop 0
buffer_load_dwordx4 v5, s[20:23], s61 offen nt lds
ds_read_b64_tr_b16 v[64:65], v20 offset:12416
ds_read_b64_tr_b16 v[66:67], v22 offset:13952
s_waitcnt lgkmcnt(8)
v_mfma_f32_32x32x16_bf16 a[176:191], v[72:75], a[36:39], a[176:191]
buffer_load_dwordx4 v6, s[20:23], s61 offen offset:1024 nt lds
ds_read_b64_tr_b16 v[68:69], v20 offset:18432
ds_read_b64_tr_b16 v[70:71], v22 offset:19968
s_waitcnt lgkmcnt(8)
v_mfma_f32_32x32x16_bf16 a[192:207], v[76:79], a[36:39], a[192:207]
v_max3_f32 v28, v28, v160, v161
ds_read_b64_tr_b16 v[72:73], v21 offset:18432
ds_read_b64_tr_b16 v[74:75], v23 offset:19968
s_waitcnt lgkmcnt(8)
v_mfma_f32_32x32x16_bf16 a[160:175], v[56:59], a[40:43], a[160:175]
v_max3_f32 v28, v28, v162, v163
v_max3_f32 v28, v28, v164, v165
ds_read_b64_tr_b16 v[76:77], v20 offset:18560
ds_read_b64_tr_b16 v[78:79], v22 offset:20096
s_waitcnt lgkmcnt(8)
v_mfma_f32_32x32x16_bf16 a[176:191], v[60:63], a[40:43], a[176:191]
v_max3_f32 v28, v28, v166, v167
v_add_u32 v20, 98304, v15
v_xor_b32 v21, 32, v20
v_xor_b32 v22, 64, v20
v_xor_b32 v23, 96, v20
ds_read_b128 v[56:59], v20
s_waitcnt lgkmcnt(7)
v_mfma_f32_32x32x16_bf16 a[192:207], v[64:67], a[40:43], a[192:207]
v_max3_f32 v28, v28, v168, v169
ds_read_b128 v[60:63], v21
s_waitcnt lgkmcnt(6)
v_mfma_f32_32x32x16_bf16 a[160:175], v[68:71], a[44:47], a[160:175]
v_max3_f32 v28, v28, v170, v171
ds_read_b128 v[64:67], v22
s_waitcnt lgkmcnt(5)
v_mfma_f32_32x32x16_bf16 a[176:191], v[72:75], a[44:47], a[176:191]
v_max3_f32 v28, v28, v172, v173
ds_read_b128 v[68:71], v23
s_waitcnt lgkmcnt(4)
v_mfma_f32_32x32x16_bf16 a[192:207], v[76:79], a[44:47], a[192:207]
v_max3_f32 v28, v28, v174, v175
s_waitcnt vmcnt(18)
s_barrier
ds_read_b128 v[72:75], v20 offset:128
s_waitcnt lgkmcnt(4)
v_mfma_f32_32x32x16_bf16 v[176:191], v[56:59], v[80:83], 0
s_add_u32 s61, s67, 6
s_and_b32 s61, s61, 7
s_mul_i32 s61, s61, 24576
s_add_u32 s61, s61, s83
s_add_u32 m0, s83, 73728
s_nop 0
buffer_load_dwordx4 v1, s[20:23], s61 offen nt lds
ds_read_b128 v[76:79], v21 offset:128
s_waitcnt lgkmcnt(4)
v_mfma_f32_32x32x16_bf16 v[176:191], v[60:63], v[84:87], v[176:191]
buffer_load_dwordx4 v2, s[20:23], s61 offen offset:1024 nt lds
ds_read_b128 v[56:59], v22 offset:128
s_waitcnt lgkmcnt(4)
v_mfma_f32_32x32x16_bf16 v[176:191], v[64:67], v[88:91], v[176:191]
buffer_load_dwordx4 v3, s[20:23], s61 offen offset:2048 nt lds
ds_read_b128 v[60:63], v23 offset:128
s_waitcnt lgkmcnt(4)
v_mfma_f32_32x32x16_bf16 v[176:191], v[68:71], v[92:95], v[176:191]
buffer_load_dwordx4 v4, s[20:23], s61 offen offset:3072 nt lds
ds_read_b128 v[64:67], v20 offset:256
s_waitcnt lgkmcnt(4)
v_mfma_f32_32x32x16_bf16 v[176:191], v[72:75], v[96:99], v[176:191]
s_add_u32 m0, s83, 77824
s_nop 0
buffer_load_dwordx4 v5, s[20:23], s61 offen nt lds
ds_read_b128 v[68:71], v21 offset:256
s_waitcnt lgkmcnt(4)
v_mfma_f32_32x32x16_bf16 v[176:191], v[76:79], v[100:103], v[176:191]
buffer_load_dwordx4 v6, s[20:23], s61 offen offset:1024 nt lds
ds_read_b128 v[72:75], v22 offset:256
s_waitcnt lgkmcnt(4)
v_mfma_f32_32x32x16_bf16 v[176:191], v[56:59], v[104:107], v[176:191]
ds_read_b128 v[76:79], v23 offset:256
s_waitcnt lgkmcnt(4)
v_mfma_f32_32x32x16_bf16 v[176:191], v[60:63], v[108:111], v[176:191]
v_add_u32 v20, 122880, v17
v_xad_u32 v21, v20, 64, s74
v_xor_b32 v22, 32, v20
v_xor_b32 v23, 32, v21
ds_read_b64_tr_b16 v[56:57], v20
ds_read_b64_tr_b16 v[58:59], v22 offset:1536
s_waitcnt lgkmcnt(5)
v_mfma_f32_32x32x16_bf16 v[176:191], v[64:67], v[112:115], v[176:191]
ds_read_b64_tr_b16 v[60:61], v21
ds_read_b64_tr_b16 v[62:63], v23 offset:1536
s_waitcnt lgkmcnt(6)
v_mfma_f32_32x32x16_bf16 v[176:191], v[68:71], v[116:119], v[176:191]
ds_read_b64_tr_b16 v[64:65], v20 offset:128
ds_read_b64_tr_b16 v[66:67], v22 offset:1664
s_waitcnt lgkmcnt(7)
v_mfma_f32_32x32x16_bf16 v[176:191], v[72:75], v[120:123], v[176:191]
ds_read_b64_tr_b16 v[68:69], v20 offset:6144
ds_read_b64_tr_b16 v[70:71], v22 offset:7680
s_waitcnt lgkmcnt(8)
v_mfma_f32_32x32x16_bf16 v[176:191], v[76:79], v[124:127], v[176:191]
s_waitcnt vmcnt(18)
s_barrier
ds_read_b64_tr_b16 v[72:73], v21 offset:6144
ds_read_b64_tr_b16 v[74:75], v23 offset:7680
s_waitcnt lgkmcnt(8)
v_mfma_f32_32x32x16_bf16 a[160:175], v[56:59], a[48:51], a[160:175]
s_add_u32 s61, s84, 5
s_cmp_ge_u32 s61, 10
s_cselect_b32 s73, 10, 0
s_sub_u32 s61, s61, s73
s_mul_i32 s61, s61, 786432
s_add_u32 s61, s61, s86
s_add_u32 s61, s61, 384
s_add_u32 m0, s83, 98304
s_nop 0
buffer_load_dwordx4 v7, s[28:31], s61 offen lds
buffer_load_dwordx4 v8, s[28:31], s61 offen offset:1024 lds
ds_read_b64_tr_b16 v[76:77], v20 offset:6272
ds_read_b64_tr_b16 v[78:79], v22 offset:7808
s_waitcnt lgkmcnt(8)
v_mfma_f32_32x32x16_bf16 a[176:191], v[60:63], a[48:51], a[176:191]
buffer_load_dwordx4 v9, s[28:31], s61 offen offset:2048 lds
ds_read_b64_tr_b16 v[56:57], v20 offset:12288
ds_read_b64_tr_b16 v[58:59], v22 offset:13824
s_waitcnt lgkmcnt(8)
v_mfma_f32_32x32x16_bf16 a[192:207], v[64:67], a[48:51], a[192:207]
buffer_load_dwordx4 v10, s[28:31], s61 offen offset:3072 lds
ds_read_b64_tr_b16 v[60:61], v21 offset:12288
ds_read_b64_tr_b16 v[62:63], v23 offset:13824
s_waitcnt lgkmcnt(8)
v_mfma_f32_32x32x16_bf16 a[160:175], v[68:71], a[52:55], a[160:175]
s_add_u32 m0, s83, 102400
s_nop 0
buffer_load_dwordx4 v11, s[28:31], s61 offen lds
ds_read_b64_tr_b16 v[64:65], v20 offset:12416
ds_read_b64_tr_b16 v[66:67], v22 offset:13952
s_waitcnt lgkmcnt(8)
v_mfma_f32_32x32x16_bf16 a[176:191], v[72:75], a[52:55], a[176:191]
buffer_load_dwordx4 v12, s[28:31], s61 offen offset:1024 lds
ds_read_b64_tr_b16 v[68:69], v20 offset:18432
ds_read_b64_tr_b16 v[70:71], v22 offset:19968
s_waitcnt lgkmcnt(8)
v_mfma_f32_32x32x16_bf16 a[192:207], v[76:79], a[52:55], a[192:207]
v_max3_f32 v28, v28, v176, v177
ds_read_b64_tr_b16 v[72:73], v21 offset:18432
ds_read_b64_tr_b16 v[74:75], v23 offset:19968
s_waitcnt lgkmcnt(8)
v_mfma_f32_32x32x16_bf16 a[160:175], v[56:59], a[56:59], a[160:175]
v_max3_f32 v28, v28, v178, v179
v_max3_f32 v28, v28, v180, v181
ds_read_b64_tr_b16 v[76:77], v20 offset:18560
ds_read_b64_tr_b16 v[78:79], v22 offset:20096
s_waitcnt lgkmcnt(8)
v_mfma_f32_32x32x16_bf16 a[176:191], v[60:63], a[56:59], a[176:191]
v_max3_f32 v28, v28, v182, v183
v_add_u32 v20, 0, v15
v_xor_b32 v21, 32, v20
v_xor_b32 v22, 64, v20
v_xor_b32 v23, 96, v20
ds_read_b128 v[56:59], v20
s_waitcnt lgkmcnt(7)
v_mfma_f32_32x32x16_bf16 a[192:207], v[64:67], a[56:59], a[192:207]
v_max3_f32 v28, v28, v184, v185
ds_read_b128 v[60:63], v21
s_waitcnt lgkmcnt(6)
v_mfma_f32_32x32x16_bf16 a[160:175], v[68:71], a[60:63], a[160:175]
v_max3_f32 v28, v28, v186, v187
ds_read_b128 v[64:67], v22
s_waitcnt lgkmcnt(5)
v_mfma_f32_32x32x16_bf16 a[176:191], v[72:75], a[60:63], a[176:191]
v_max3_f32 v28, v28, v188, v189
ds_read_b128 v[68:71], v23
s_waitcnt lgkmcnt(4)
v_mfma_f32_32x32x16_bf16 a[192:207], v[76:79], a[60:63], a[192:207]
v_max3_f32 v28, v28, v190, v191
s_waitcnt vmcnt(18)
s_barrier
ds_read_b128 v[72:75], v20 offset:128
s_waitcnt lgkmcnt(4)
v_mfma_f32_32x32x16_bf16 v[192:207], v[56:59], v[80:83], 0
s_add_u32 s61, s67, 7
s_and_b32 s61, s61, 7
s_mul_i32 s61, s61, 24576
s_add_u32 s61, s61, s83
s_add_u32 m0, s83, 122880
s_nop 0
buffer_load_dwordx4 v1, s[20:23], s61 offen nt lds
ds_read_b128 v[76:79], v21 offset:128
s_waitcnt lgkmcnt(4)
v_mfma_f32_32x32x16_bf16 v[192:207], v[60:63], v[84:87], v[192:207]
buffer_load_dwordx4 v2, s[20:23], s61 offen offset:1024 nt lds
ds_read_b128 v[56:59], v22 offset:128
s_waitcnt lgkmcnt(4)
v_mfma_f32_32x32x16_bf16 v[192:207], v[64:67], v[88:91], v[192:207]
buffer_load_dwordx4 v3, s[20:23], s61 offen offset:2048 nt lds
ds_read_b128 v[60:63], v23 offset:128
s_waitcnt lgkmcnt(4)
v_mfma_f32_32x32x16_bf16 v[192:207], v[68:71], v[92:95], v[192:207]
buffer_load_dwordx4 v4, s[20:23], s61 offen offset:3072 nt lds
ds_read_b128 v[64:67], v20 offset:256
s_waitcnt lgkmcnt(4)
v_mfma_f32_32x32x16_bf16 v[192:207], v[72:75], v[96:99], v[192:207]
s_add_u32 m0, s83, 126976
s_nop 0
buffer_load_dwordx4 v5, s[20:23], s61 offen nt lds
ds_read_b128 v[68:71], v21 offset:256
s_waitcnt lgkmcnt(4)
v_mfma_f32_32x32x16_bf16 v[192:207], v[76:79], v[100:103], v[192:207]
buffer_load_dwordx4 v6, s[20:23], s61 offen offset:1024 nt lds
ds_read_b128 v[72:75], v22 offset:256
s_waitcnt lgkmcnt(4)
v_mfma_f32_32x32x16_bf16 v[192:207], v[56:59], v[104:107], v[192:207]
ds_read_b128 v[76:79], v23 offset:256
s_waitcnt lgkmcnt(4)
v_mfma_f32_32x32x16_bf16 v[192:207], v[60:63], v[108:111], v[192:207]
v_add_u32 v20, 49152, v17
v_xad_u32 v21, v20, 64, s74
v_xor_b32 v22, 32, v20
v_xor_b32 v23, 32, v21
ds_read_b64_tr_b16 v[56:57], v20
ds_read_b64_tr_b16 v[58:59], v22 offset:1536
s_waitcnt lgkmcnt(5)
v_mfma_f32_32x32x16_bf16 v[192:207], v[64:67], v[112:115], v[192:207]
ds_read_b64_tr_b16 v[60:61], v21
ds_read_b64_tr_b16 v[62:63], v23 offset:1536
s_waitcnt lgkmcnt(6)
v_mfma_f32_32x32x16_bf16 v[192:207], v[68:71], v[116:119], v[192:207]
ds_read_b64_tr_b16 v[64:65], v20 offset:128
ds_read_b64_tr_b16 v[66:67], v22 offset:1664
s_waitcnt lgkmcnt(7)
v_mfma_f32_32x32x16_bf16 v[192:207], v[72:75], v[120:123], v[192:207]
ds_read_b64_tr_b16 v[68:69], v20 offset:6144
ds_read_b64_tr_b16 v[70:71], v22 offset:7680
s_waitcnt lgkmcnt(8)
v_mfma_f32_32x32x16_bf16 v[192:207], v[76:79], v[124:127], v[192:207]
s_waitcnt vmcnt(18)
s_barrier
ds_read_b64_tr_b16 v[72:73], v21 offset:6144
ds_read_b64_tr_b16 v[74:75], v23 offset:7680
s_waitcnt lgkmcnt(8)
v_mfma_f32_32x32x16_bf16 a[160:175], v[56:59], a[64:67], a[160:175]
s_add_u32 s61, s67, 0
s_and_b32 s61, s61, 7
s_mul_i32 s61, s61, 24576
s_add_u32 s61, s61, s83
s_add_u32 m0, s83, 0
s_nop 0
buffer_load_dwordx4 v1, s[24:27], s61 offen nt lds
buffer_load_dwordx4 v2, s[24:27], s61 offen offset:1024 nt lds
ds_read_b64_tr_b16 v[76:77], v20 offset:6272
ds_read_b64_tr_b16 v[78:79], v22 offset:7808
s_waitcnt lgkmcnt(8)
v_mfma_f32_32x32x16_bf16 a[176:191], v[60:63], a[64:67], a[176:191]
buffer_load_dwordx4 v3, s[24:27], s61 offen offset:2048 nt lds
ds_read_b64_tr_b16 v[56:57], v20 offset:12288
ds_read_b64_tr_b16 v[58:59], v22 offset:13824
s_waitcnt lgkmcnt(8)
v_mfma_f32_32x32x16_bf16 a[192:207], v[64:67], a[64:67], a[192:207]
buffer_load_dwordx4 v4, s[24:27], s61 offen offset:3072 nt lds
ds_read_b64_tr_b16 v[60:61], v21 offset:12288
ds_read_b64_tr_b16 v[62:63], v23 offset:13824
s_waitcnt lgkmcnt(8)
v_mfma_f32_32x32x16_bf16 a[160:175], v[68:71], a[68:71], a[160:175]
s_add_u32 m0, s83, 4096
s_nop 0
buffer_load_dwordx4 v5, s[24:27], s61 offen nt lds
ds_read_b64_tr_b16 v[64:65], v20 offset:12416
ds_read_b64_tr_b16 v[66:67], v22 offset:13952
s_waitcnt lgkmcnt(8)
v_mfma_f32_32x32x16_bf16 a[176:191], v[72:75], a[68:71], a[176:191]
buffer_load_dwordx4 v6, s[24:27], s61 offen offset:1024 nt lds
ds_read_b64_tr_b16 v[68:69], v20 offset:18432
ds_read_b64_tr_b16 v[70:71], v22 offset:19968
s_waitcnt lgkmcnt(8)
v_mfma_f32_32x32x16_bf16 a[192:207], v[76:79], a[68:71], a[192:207]
v_max3_f32 v28, v28, v192, v193
ds_read_b64_tr_b16 v[72:73], v21 offset:18432
ds_read_b64_tr_b16 v[74:75], v23 offset:19968
s_waitcnt lgkmcnt(8)
v_mfma_f32_32x32x16_bf16 a[160:175], v[56:59], a[72:75], a[160:175]
v_max3_f32 v28, v28, v194, v195
v_max3_f32 v28, v28, v196, v197
ds_read_b64_tr_b16 v[76:77], v20 offset:18560
ds_read_b64_tr_b16 v[78:79], v22 offset:20096
s_waitcnt lgkmcnt(8)
v_mfma_f32_32x32x16_bf16 a[176:191], v[60:63], a[72:75], a[176:191]
v_max3_f32 v28, v28, v198, v199
v_add_u32 v20, 24576, v15
v_xor_b32 v21, 32, v20
v_xor_b32 v22, 64, v20
v_xor_b32 v23, 96, v20
ds_read_b128 v[56:59], v20
s_waitcnt lgkmcnt(7)
v_mfma_f32_32x32x16_bf16 a[192:207], v[64:67], a[72:75], a[192:207]
v_max3_f32 v28, v28, v200, v201
ds_read_b128 v[60:63], v21
s_waitcnt lgkmcnt(6)
v_mfma_f32_32x32x16_bf16 a[160:175], v[68:71], a[76:79], a[160:175]
v_max3_f32 v28, v28, v202, v203
ds_read_b128 v[64:67], v22
s_waitcnt lgkmcnt(5)
v_mfma_f32_32x32x16_bf16 a[176:191], v[72:75], a[76:79], a[176:191]
v_max3_f32 v28, v28, v204, v205
ds_read_b128 v[68:71], v23
s_waitcnt lgkmcnt(4)
v_mfma_f32_32x32x16_bf16 a[192:207], v[76:79], a[76:79], a[192:207]
v_max3_f32 v28, v28, v206, v207
s_waitcnt vmcnt(18)
s_barrier
ds_read_b128 v[72:75], v20 offset:128
s_waitcnt lgkmcnt(4)
v_mfma_f32_32x32x16_bf16 v[208:223], v[56:59], v[80:83], 0
s_add_u32 s61, s67, 1
s_and_b32 s61, s61, 7
s_mul_i32 s61, s61, 24576
s_add_u32 s61, s61, s83
s_add_u32 m0, s83, 49152
s_nop 0
buffer_load_dwordx4 v1, s[24:27], s61 offen nt lds
ds_read_b128 v[76:79], v21 offset:128
s_waitcnt lgkmcnt(4)
v_mfma_f32_32x32x16_bf16 v[208:223], v[60:63], v[84:87], v[208:223]
buffer_load_dwordx4 v2, s[24:27], s61 offen offset:1024 nt lds
ds_read_b128 v[56:59], v22 offset:128
s_waitcnt lgkmcnt(4)
v_mfma_f32_32x32x16_bf16 v[208:223], v[64:67], v[88:91], v[208:223]
buffer_load_dwordx4 v3, s[24:27], s61 offen offset:2048 nt lds
ds_read_b128 v[60:63], v23 offset:128
s_waitcnt lgkmcnt(4)
v_mfma_f32_32x32x16_bf16 v[208:223], v[68:71], v[92:95], v[208:223]
buffer_load_dwordx4 v4, s[24:27], s61 offen offset:3072 nt lds
ds_read_b128 v[64:67], v20 offset:256
s_waitcnt lgkmcnt(4)
v_mfma_f32_32x32x16_bf16 v[208:223], v[72:75], v[96:99], v[208:223]
s_add_u32 m0, s83, 53248
s_nop 0
buffer_load_dwordx4 v5, s[24:27], s61 offen nt lds
ds_read_b128 v[68:71], v21 offset:256
s_waitcnt lgkmcnt(4)
v_mfma_f32_32x32x16_bf16 v[208:223], v[76:79], v[100:103], v[208:223]
buffer_load_dwordx4 v6, s[24:27], s61 offen offset:1024 nt lds
ds_read_b128 v[72:75], v22 offset:256
s_waitcnt lgkmcnt(4)
v_mfma_f32_32x32x16_bf16 v[208:223], v[56:59], v[104:107], v[208:223]
ds_read_b128 v[76:79], v23 offset:256
s_waitcnt lgkmcnt(4)
v_mfma_f32_32x32x16_bf16 v[208:223], v[60:63], v[108:111], v[208:223]
v_add_u32 v20, 73728, v15
v_xor_b32 v21, 32, v20
v_xor_b32 v22, 64, v20
v_xor_b32 v23, 96, v20
ds_read_b128 v[56:59], v20
s_waitcnt lgkmcnt(4)
v_mfma_f32_32x32x16_bf16 v[208:223], v[64:67], v[112:115], v[208:223]
ds_read_b128 v[60:63], v21
s_waitcnt lgkmcnt(4)
v_mfma_f32_32x32x16_bf16 v[208:223], v[68:71], v[116:119], v[208:223]
ds_read_b128 v[64:67], v22
s_waitcnt lgkmcnt(4)
v_mfma_f32_32x32x16_bf16 v[208:223], v[72:75], v[120:123], v[208:223]
ds_read_b128 v[68:71], v23
s_waitcnt lgkmcnt(4)
v_mfma_f32_32x32x16_bf16 v[208:223], v[76:79], v[124:127], v[208:223]
s_waitcnt vmcnt(18)
s_barrier
ds_read_b128 v[72:75], v20 offset:128
s_waitcnt lgkmcnt(4)
v_mfma_f32_32x32x16_bf16 v[224:239], v[56:59], v[80:83], 0
s_nop 6
v_max3_f32 v28, v28, v208, v209
ds_read_b128 v[76:79], v21 offset:128
s_waitcnt lgkmcnt(4)
v_mfma_f32_32x32x16_bf16 v[224:239], v[60:63], v[84:87], v[224:239]
v_max3_f32 v28, v28, v210, v211
ds_read_b128 v[56:59], v22 offset:128
s_waitcnt lgkmcnt(4)
v_mfma_f32_32x32x16_bf16 v[224:239], v[64:67], v[88:91], v[224:239]
ds_read_b128 v[60:63], v23 offset:128
s_waitcnt lgkmcnt(4)
v_mfma_f32_32x32x16_bf16 v[224:239], v[68:71], v[92:95], v[224:239]
v_max3_f32 v28, v28, v212, v213
ds_read_b128 v[64:67], v20 offset:256
s_waitcnt lgkmcnt(4)
v_mfma_f32_32x32x16_bf16 v[224:239], v[72:75], v[96:99], v[224:239]
v_max3_f32 v28, v28, v214, v215
ds_read_b128 v[68:71], v21 offset:256
s_waitcnt lgkmcnt(4)
v_mfma_f32_32x32x16_bf16 v[224:239], v[76:79], v[100:103], v[224:239]
ds_read_b128 v[72:75], v22 offset:256
s_waitcnt lgkmcnt(4)
v_mfma_f32_32x32x16_bf16 v[224:239], v[56:59], v[104:107], v[224:239]
v_max3_f32 v28, v28, v216, v217
ds_read_b128 v[76:79], v23 offset:256
s_waitcnt lgkmcnt(4)
v_mfma_f32_32x32x16_bf16 v[224:239], v[60:63], v[108:111], v[224:239]
v_max3_f32 v28, v28, v218, v219
v_add_u32 v20, 98304, v17
v_xad_u32 v21, v20, 64, s74
v_xor_b32 v22, 32, v20
v_xor_b32 v23, 32, v21
ds_read_b64_tr_b16 v[56:57], v20
ds_read_b64_tr_b16 v[58:59], v22 offset:1536
s_waitcnt lgkmcnt(5)
v_mfma_f32_32x32x16_bf16 v[224:239], v[64:67], v[112:115], v[224:239]
ds_read_b64_tr_b16 v[60:61], v21
ds_read_b64_tr_b16 v[62:63], v23 offset:1536
s_waitcnt lgkmcnt(6)
v_mfma_f32_32x32x16_bf16 v[224:239], v[68:71], v[116:119], v[224:239]
v_max3_f32 v28, v28, v220, v221
ds_read_b64_tr_b16 v[64:65], v20 offset:128
ds_read_b64_tr_b16 v[66:67], v22 offset:1664
s_waitcnt lgkmcnt(7)
v_mfma_f32_32x32x16_bf16 v[224:239], v[72:75], v[120:123], v[224:239]
v_max3_f32 v28, v28, v222, v223
ds_read_b64_tr_b16 v[68:69], v20 offset:6144
ds_read_b64_tr_b16 v[70:71], v22 offset:7680
s_waitcnt lgkmcnt(8)
v_mfma_f32_32x32x16_bf16 v[224:239], v[76:79], v[124:127], v[224:239]
s_waitcnt vmcnt(12)
s_barrier
ds_read_b64_tr_b16 v[72:73], v21 offset:6144
ds_read_b64_tr_b16 v[74:75], v23 offset:7680
s_waitcnt lgkmcnt(8)
v_mfma_f32_32x32x16_bf16 a[160:175], v[56:59], a[80:83], a[160:175]
s_add_u32 s61, s84, 6
s_cmp_ge_u32 s61, 10
s_cselect_b32 s73, 10, 0
s_sub_u32 s61, s61, s73
s_mul_i32 s61, s61, 786432
s_add_u32 s61, s61, s86
s_add_u32 s61, s61, 384
s_add_u32 m0, s83, 24576
s_nop 0
buffer_load_dwordx4 v7, s[28:31], s61 offen lds
buffer_load_dwordx4 v8, s[28:31], s61 offen offset:1024 lds
ds_read_b64_tr_b16 v[76:77], v20 offset:6272
ds_read_b64_tr_b16 v[78:79], v22 offset:7808
s_waitcnt lgkmcnt(8)
v_mfma_f32_32x32x16_bf16 a[176:191], v[60:63], a[80:83], a[176:191]
buffer_load_dwordx4 v9, s[28:31], s61 offen offset:2048 lds
ds_read_b64_tr_b16 v[56:57], v20 offset:12288
ds_read_b64_tr_b16 v[58:59], v22 offset:13824
s_waitcnt lgkmcnt(8)
v_mfma_f32_32x32x16_bf16 a[192:207], v[64:67], a[80:83], a[192:207]
buffer_load_dwordx4 v10, s[28:31], s61 offen offset:3072 lds
ds_read_b64_tr_b16 v[60:61], v21 offset:12288
ds_read_b64_tr_b16 v[62:63], v23 offset:13824
s_waitcnt lgkmcnt(8)
v_mfma_f32_32x32x16_bf16 a[160:175], v[68:71], a[84:87], a[160:175]
s_add_u32 m0, s83, 28672
s_nop 0
buffer_load_dwordx4 v11, s[28:31], s61 offen lds
ds_read_b64_tr_b16 v[64:65], v20 offset:12416
ds_read_b64_tr_b16 v[66:67], v22 offset:13952
s_waitcnt lgkmcnt(8)
v_mfma_f32_32x32x16_bf16 a[176:191], v[72:75], a[84:87], a[176:191]
buffer_load_dwordx4 v12, s[28:31], s61 offen offset:1024 lds
ds_read_b64_tr_b16 v[68:69], v20 offset:18432
ds_read_b64_tr_b16 v[70:71], v22 offset:19968
s_waitcnt lgkmcnt(8)
v_mfma_f32_32x32x16_bf16 a[192:207], v[76:79], a[84:87], a[192:207]
v_max3_f32 v28, v28, v224, v225
ds_read_b64_tr_b16 v[72:73], v21 offset:18432
ds_read_b64_tr_b16 v[74:75], v23 offset:19968
s_waitcnt lgkmcnt(8)
v_mfma_f32_32x32x16_bf16 a[160:175], v[56:59], a[88:91], a[160:175]
v_max3_f32 v28, v28, v226, v227
v_max3_f32 v28, v28, v228, v229
ds_read_b64_tr_b16 v[76:77], v20 offset:18560
ds_read_b64_tr_b16 v[78:79], v22 offset:20096
s_waitcnt lgkmcnt(8)
v_mfma_f32_32x32x16_bf16 a[176:191], v[60:63], a[88:91], a[176:191]
v_max3_f32 v28, v28, v230, v231
v_add_u32 v20, 122880, v15
v_xor_b32 v21, 32, v20
v_xor_b32 v22, 64, v20
v_xor_b32 v23, 96, v20
ds_read_b128 v[56:59], v20
s_waitcnt lgkmcnt(7)
v_mfma_f32_32x32x16_bf16 a[192:207], v[64:67], a[88:91], a[192:207]
v_max3_f32 v28, v28, v232, v233
ds_read_b128 v[60:63], v21
s_waitcnt lgkmcnt(6)
v_mfma_f32_32x32x16_bf16 a[160:175], v[68:71], a[92:95], a[160:175]
v_max3_f32 v28, v28, v234, v235
ds_read_b128 v[64:67], v22
s_waitcnt lgkmcnt(5)
v_mfma_f32_32x32x16_bf16 a[176:191], v[72:75], a[92:95], a[176:191]
v_max3_f32 v28, v28, v236, v237
ds_read_b128 v[68:71], v23
s_waitcnt lgkmcnt(4)
v_mfma_f32_32x32x16_bf16 a[192:207], v[76:79], a[92:95], a[192:207]
v_max3_f32 v28, v28, v238, v239
s_barrier
ds_read_b128 v[72:75], v20 offset:128
s_waitcnt lgkmcnt(4)
v_mfma_f32_32x32x16_bf16 v[240:255], v[56:59], v[80:83], 0
s_add_u32 s61, s67, 2
s_and_b32 s61, s61, 7
s_mul_i32 s61, s61, 24576
s_add_u32 s61, s61, s83
s_add_u32 m0, s83, 98304
s_nop 0
buffer_load_dwordx4 v1, s[24:27], s61 offen nt lds
ds_read_b128 v[76:79], v21 offset:128
s_waitcnt lgkmcnt(4)
v_mfma_f32_32x32x16_bf16 v[240:255], v[60:63], v[84:87], v[240:255]
buffer_load_dwordx4 v2, s[24:27], s61 offen offset:1024 nt lds
ds_read_b128 v[56:59], v22 offset:128
s_waitcnt lgkmcnt(4)
v_mfma_f32_32x32x16_bf16 v[240:255], v[64:67], v[88:91], v[240:255]
buffer_load_dwordx4 v3, s[24:27], s61 offen offset:2048 nt lds
ds_read_b128 v[60:63], v23 offset:128
s_waitcnt lgkmcnt(4)
v_mfma_f32_32x32x16_bf16 v[240:255], v[68:71], v[92:95], v[240:255]
buffer_load_dwordx4 v4, s[24:27], s61 offen offset:3072 nt lds
ds_read_b128 v[64:67], v20 offset:256
s_waitcnt lgkmcnt(4)
v_mfma_f32_32x32x16_bf16 v[240:255], v[72:75], v[96:99], v[240:255]
s_add_u32 m0, s83, 102400
s_nop 0
buffer_load_dwordx4 v5, s[24:27], s61 offen nt lds
ds_read_b128 v[68:71], v21 offset:256
s_waitcnt lgkmcnt(4)
v_mfma_f32_32x32x16_bf16 v[240:255], v[76:79], v[100:103], v[240:255]
buffer_load_dwordx4 v6, s[24:27], s61 offen offset:1024 nt lds
ds_read_b128 v[72:75], v22 offset:256
s_waitcnt lgkmcnt(4)
v_mfma_f32_32x32x16_bf16 v[240:255], v[56:59], v[104:107], v[240:255]
ds_read_b128 v[76:79], v23 offset:256
s_waitcnt lgkmcnt(4)
v_mfma_f32_32x32x16_bf16 v[240:255], v[60:63], v[108:111], v[240:255]
s_waitcnt lgkmcnt(3)
v_mfma_f32_32x32x16_bf16 v[240:255], v[64:67], v[112:115], v[240:255]
s_waitcnt lgkmcnt(2)
v_mfma_f32_32x32x16_bf16 v[240:255], v[68:71], v[116:119], v[240:255]
s_waitcnt lgkmcnt(1)
v_mfma_f32_32x32x16_bf16 v[240:255], v[72:75], v[120:123], v[240:255]
s_waitcnt lgkmcnt(0)
v_mfma_f32_32x32x16_bf16 v[240:255], v[76:79], v[124:127], v[240:255]
s_barrier
s_nop 10
v_max3_f32 v28, v28, v240, v241
v_max3_f32 v28, v28, v242, v243
v_max3_f32 v28, v28, v244, v245
v_max3_f32 v28, v28, v246, v247
v_max3_f32 v28, v28, v248, v249
v_max3_f32 v28, v28, v250, v251
v_max3_f32 v28, v28, v252, v253
v_max3_f32 v28, v28, v254, v255
v_mov_b32 v32, v28
v_mov_b32 v33, v28
s_nop 1
v_permlane32_swap_b32 v32, v33
v_max_f32 v28, v32, v33
v_lshrrev_b32 v34, 2, v48
s_lshl_b32 s72, s58, 8
s_add_u32 s72, s72, 161792
v_add_u32 v34, s72, v34
ds_write_b32 v34, v28
s_waitcnt lgkmcnt(0)
s_barrier
v_lshrrev_b32 v34, 2, v48
s_lshl_b32 s72, s58, 8
s_xor_b32 s72, s72, 512
s_add_u32 s72, s72, 161792
v_add_u32 v34, s72, v34
ds_read_b32 v35, v34
s_waitcnt lgkmcnt(0)
v_max_f32 v28, v28, v35
v_mul_f32 v29, s60, v28
v_mov_b32 v30, 0
v_fma_f32 v128, v128, s60, -v29
v_fma_f32 v129, v129, s60, -v29
v_exp_f32 v128, v128
v_exp_f32 v129, v129
v_fma_f32 v130, v130, s60, -v29
v_fma_f32 v131, v131, s60, -v29
v_exp_f32 v130, v130
v_exp_f32 v131, v131
v_add_f32 v30, v30, v128
v_add_f32 v30, v30, v129
v_cvt_pk_bf16_f32 v128, v128, v129
v_fma_f32 v132, v132, s60, -v29
v_fma_f32 v133, v133, s60, -v29
v_exp_f32 v132, v132
v_exp_f32 v133, v133
v_add_f32 v30, v30, v130
v_add_f32 v30, v30, v131
v_cvt_pk_bf16_f32 v129, v130, v131
v_fma_f32 v134, v134, s60, -v29
v_fma_f32 v135, v135, s60, -v29
v_exp_f32 v134, v134
v_exp_f32 v135, v135
v_add_f32 v30, v30, v132
v_add_f32 v30, v30, v133
v_cvt_pk_bf16_f32 v130, v132, v133
v_fma_f32 v136, v136, s60, -v29
v_fma_f32 v137, v137, s60, -v29
v_exp_f32 v136, v136
v_exp_f32 v137, v137
v_add_f32 v30, v30, v134
v_add_f32 v30, v30, v135
v_cvt_pk_bf16_f32 v131, v134, v135
v_fma_f32 v138, v138, s60, -v29
v_fma_f32 v139, v139, s60, -v29
v_exp_f32 v138, v138
v_exp_f32 v139, v139
v_add_f32 v30, v30, v136
v_add_f32 v30, v30, v137
v_cvt_pk_bf16_f32 v132, v136, v137
v_fma_f32 v140, v140, s60, -v29
v_fma_f32 v141, v141, s60, -v29
v_exp_f32 v140, v140
v_exp_f32 v141, v141
v_add_f32 v30, v30, v138
v_add_f32 v30, v30, v139
v_cvt_pk_bf16_f32 v133, v138, v139
v_fma_f32 v142, v142, s60, -v29
v_fma_f32 v143, v143, s60, -v29
v_exp_f32 v142, v142
v_exp_f32 v143, v143
v_add_f32 v30, v30, v140
v_add_f32 v30, v30, v141
v_cvt_pk_bf16_f32 v134, v140, v141
v_add_f32 v30, v30, v142
v_add_f32 v30, v30, v143
v_cvt_pk_bf16_f32 v135, v142, v143
s_waitcnt vmcnt(18)
s_waitcnt vmcnt(6)
s_barrier
v_add_u32 v20, 0, v16
v_xad_u32 v21, v20, 64, s74
v_xad_u32 v22, v20, 64, s75
v_add_u32 v23, s81, v20
v_xor_b32 v24, 16, v20
v_xor_b32 v25, 16, v21
v_xor_b32 v26, 16, v22
v_xor_b32 v27, 16, v23
ds_read_b64_tr_b16 v[56:57], v20
ds_read_b64_tr_b16 v[58:59], v24 offset:3072
ds_read_b64_tr_b16 v[60:61], v21
ds_read_b64_tr_b16 v[62:63], v25 offset:3072
ds_read_b64_tr_b16 v[64:65], v20 offset:128
ds_read_b64_tr_b16 v[66:67], v24 offset:3200
ds_read_b64_tr_b16 v[68:69], v22
ds_read_b64_tr_b16 v[70:71], v26 offset:3072
ds_read_b64_tr_b16 v[72:73], v23
ds_read_b64_tr_b16 v[74:75], v27 offset:3072
s_waitcnt lgkmcnt(8)
v_mfma_f32_32x32x16_bf16 a[0:15], v[56:59], v[128:131], 0
s_add_u32 s61, s84, 7
s_cmp_ge_u32 s61, 10
s_cselect_b32 s73, 10, 0
s_sub_u32 s61, s61, s73
s_mul_i32 s61, s61, 786432
s_add_u32 s61, s61, s86
s_add_u32 s61, s61, 384
s_add_u32 m0, s83, 73728
s_nop 0
buffer_load_dwordx4 v7, s[28:31], s61 offen lds
buffer_load_dwordx4 v8, s[28:31], s61 offen offset:1024 lds
buffer_load_dwordx4 v9, s[28:31], s61 offen offset:2048 lds
ds_read_b64_tr_b16 v[76:77], v22 offset:128
ds_read_b64_tr_b16 v[78:79], v26 offset:3200
s_waitcnt lgkmcnt(8)
v_mfma_f32_32x32x16_bf16 a[16:31], v[60:63], v[128:131], 0
buffer_load_dwordx4 v10, s[28:31], s61 offen offset:3072 lds
s_add_u32 m0, s83, 77824
s_nop 0
buffer_load_dwordx4 v11, s[28:31], s61 offen lds
ds_read_b64_tr_b16 v[56:57], v20 offset:6144
ds_read_b64_tr_b16 v[58:59], v24 offset:9216
s_waitcnt lgkmcnt(8)
v_mfma_f32_32x32x16_bf16 a[32:47], v[64:67], v[128:131], 0
buffer_load_dwordx4 v12, s[28:31], s61 offen offset:1024 lds
s_add_u32 s61, s84, 8
s_cmp_ge_u32 s61, 10
s_cselect_b32 s73, 10, 0
s_sub_u32 s61, s61, s73
s_mul_i32 s61, s61, 786432
s_add_u32 s61, s61, s86
s_add_u32 s61, s61, 384
s_add_u32 m0, s83, 122880
s_nop 0
buffer_load_dwordx4 v7, s[28:31], s61 offen lds
ds_read_b64_tr_b16 v[60:61], v21 offset:6144
ds_read_b64_tr_b16 v[62:63], v25 offset:9216
s_waitcnt lgkmcnt(8)
v_mfma_f32_32x32x16_bf16 a[48:63], v[68:71], v[128:131], 0
buffer_load_dwordx4 v8, s[28:31], s61 offen offset:1024 lds
buffer_load_dwordx4 v9, s[28:31], s61 offen offset:2048 lds
buffer_load_dwordx4 v10, s[28:31], s61 offen offset:3072 lds
ds_read_b64_tr_b16 v[64:65], v20 offset:6272
ds_read_b64_tr_b16 v[66:67], v24 offset:9344
s_waitcnt lgkmcnt(8)
v_mfma_f32_32x32x16_bf16 a[64:79], v[72:75], v[128:131], 0
s_add_u32 m0, s83, 126976
s_nop 0
buffer_load_dwordx4 v11, s[28:31], s61 offen lds
buffer_load_dwordx4 v12, s[28:31], s61 offen offset:1024 lds
ds_read_b64_tr_b16 v[68:69], v22 offset:6144
ds_read_b64_tr_b16 v[70:71], v26 offset:9216
s_waitcnt lgkmcnt(8)
v_mfma_f32_32x32x16_bf16 a[80:95], v[76:79], v[128:131], 0
v_fma_f32 v144, v144, s60, -v29
v_fma_f32 v145, v145, s60, -v29
v_exp_f32 v144, v144
v_exp_f32 v145, v145
v_fma_f32 v146, v146, s60, -v29
v_fma_f32 v147, v147, s60, -v29
v_exp_f32 v146, v146
v_exp_f32 v147, v147
ds_read_b64_tr_b16 v[72:73], v23 offset:6144
ds_read_b64_tr_b16 v[74:75], v27 offset:9216
s_waitcnt lgkmcnt(8)
v_mfma_f32_32x32x16_bf16 a[0:15], v[56:59], v[132:135], a[0:15]
v_add_f32 v30, v30, v144
v_add_f32 v30, v30, v145
v_cvt_pk_bf16_f32 v144, v144, v145
v_fma_f32 v148, v148, s60, -v29
v_fma_f32 v149, v149, s60, -v29
v_exp_f32 v148, v148
v_exp_f32 v149, v149
v_add_f32 v30, v30, v146
v_add_f32 v30, v30, v147
v_cvt_pk_bf16_f32 v145, v146, v147
ds_read_b64_tr_b16 v[76:77], v22 offset:6272
ds_read_b64_tr_b16 v[78:79], v26 offset:9344
s_waitcnt lgkmcnt(8)
v_mfma_f32_32x32x16_bf16 a[16:31], v[60:63], v[132:135], a[16:31]
v_fma_f32 v150, v150, s60, -v29
v_fma_f32 v151, v151, s60, -v29
v_exp_f32 v150, v150
v_exp_f32 v151, v151
v_add_f32 v30, v30, v148
v_add_f32 v30, v30, v149
v_cvt_pk_bf16_f32 v146, v148, v149
v_add_u32 v20, 24576, v17
v_xad_u32 v21, v20, 64, s74
v_xor_b32 v22, 32, v20
v_xor_b32 v23, 32, v21
ds_read_b64_tr_b16 v[56:57], v20
ds_read_b64_tr_b16 v[58:59], v22 offset:1536
s_waitcnt lgkmcnt(8)
v_mfma_f32_32x32x16_bf16 a[32:47], v[64:67], v[132:135], a[32:47]
v_fma_f32 v152, v152, s60, -v29
v_fma_f32 v153, v153, s60, -v29
v_exp_f32 v152, v152
v_exp_f32 v153, v153
v_add_f32 v30, v30, v150
v_add_f32 v30, v30, v151
v_cvt_pk_bf16_f32 v147, v150, v151
ds_read_b64_tr_b16 v[60:61], v21
ds_read_b64_tr_b16 v[62:63], v23 offset:1536
s_waitcnt lgkmcnt(8)
v_mfma_f32_32x32x16_bf16 a[48:63], v[68:71], v[132:135], a[48:63]
v_fma_f32 v154, v154, s60, -v29
v_fma_f32 v155, v155, s60, -v29
v_exp_f32 v154, v154
v_exp_f32 v155, v155
v_add_f32 v30, v30, v152
v_add_f32 v30, v30, v153
v_cvt_pk_bf16_f32 v148, v152, v153
v_fma_f32 v156, v156, s60, -v29
v_fma_f32 v157, v157, s60, -v29
v_exp_f32 v156, v156
v_exp_f32 v157, v157
ds_read_b64_tr_b16 v[64:65], v20 offset:128
ds_read_b64_tr_b16 v[66:67], v22 offset:1664
s_waitcnt lgkmcnt(8)
v_mfma_f32_32x32x16_bf16 a[64:79], v[72:75], v[132:135], a[64:79]
v_add_f32 v30, v30, v154
v_add_f32 v30, v30, v155
v_cvt_pk_bf16_f32 v149, v154, v155
v_fma_f32 v158, v158, s60, -v29
v_fma_f32 v159, v159, s60, -v29
v_exp_f32 v158, v158
v_exp_f32 v159, v159
ds_read_b64_tr_b16 v[68:69], v20 offset:6144
ds_read_b64_tr_b16 v[70:71], v22 offset:7680
s_waitcnt lgkmcnt(8)
v_mfma_f32_32x32x16_bf16 a[80:95], v[76:79], v[132:135], a[80:95]
v_add_f32 v30, v30, v156
v_add_f32 v30, v30, v157
v_cvt_pk_bf16_f32 v150, v156, v157
v_add_f32 v30, v30, v158
v_add_f32 v30, v30, v159
v_cvt_pk_bf16_f32 v151, v158, v159
s_barrier
ds_read_b64_tr_b16 v[72:73], v21 offset:6144
ds_read_b64_tr_b16 v[74:75], v23 offset:7680
s_waitcnt lgkmcnt(8)
v_mfma_f32_32x32x16_bf16 a[160:175], v[56:59], a[96:99], a[160:175]
s_add_u32 s61, s67, 3
s_and_b32 s61, s61, 7
s_mul_i32 s61, s61, 24576
s_add_u32 s61, s61, s83
s_add_u32 m0, s83, 0
s_nop 0
buffer_load_dwordx4 v1, s[24:27], s61 offen nt lds
ds_read_b64_tr_b16 v[76:77], v20 offset:6272
ds_read_b64_tr_b16 v[78:79], v22 offset:7808
s_waitcnt lgkmcnt(8)
v_mfma_f32_32x32x16_bf16 a[176:191], v[60:63], a[96:99], a[176:191]
buffer_load_dwordx4 v2, s[24:27], s61 offen offset:1024 nt lds
ds_read_b64_tr_b16 v[56:57], v20 offset:12288
ds_read_b64_tr_b16 v[58:59], v22 offset:13824
s_waitcnt lgkmcnt(8)
v_mfma_f32_32x32x16_bf16 a[192:207], v[64:67], a[96:99], a[192:207]
buffer_load_dwordx4 v3, s[24:27], s61 offen offset:2048 nt lds
ds_read_b64_tr_b16 v[60:61], v21 offset:12288
ds_read_b64_tr_b16 v[62:63], v23 offset:13824
s_waitcnt lgkmcnt(8)
v_mfma_f32_32x32x16_bf16 a[160:175], v[68:71], a[100:103], a[160:175]
buffer_load_dwordx4 v4, s[24:27], s61 offen offset:3072 nt lds
ds_read_b64_tr_b16 v[64:65], v20 offset:12416
ds_read_b64_tr_b16 v[66:67], v22 offset:13952
s_waitcnt lgkmcnt(8)
v_mfma_f32_32x32x16_bf16 a[176:191], v[72:75], a[100:103], a[176:191]
s_add_u32 m0, s83, 4096
s_nop 0
buffer_load_dwordx4 v5, s[24:27], s61 offen nt lds
ds_read_b64_tr_b16 v[68:69], v20 offset:18432
ds_read_b64_tr_b16 v[70:71], v22 offset:19968
s_waitcnt lgkmcnt(8)
v_mfma_f32_32x32x16_bf16 a[192:207], v[76:79], a[100:103], a[192:207]
buffer_load_dwordx4 v6, s[24:27], s61 offen offset:1024 nt lds
ds_read_b64_tr_b16 v[72:73], v21 offset:18432
ds_read_b64_tr_b16 v[74:75], v23 offset:19968
s_waitcnt lgkmcnt(8)
v_mfma_f32_32x32x16_bf16 a[160:175], v[56:59], a[104:107], a[160:175]
ds_read_b64_tr_b16 v[76:77], v20 offset:18560
ds_read_b64_tr_b16 v[78:79], v22 offset:20096
s_waitcnt lgkmcnt(8)
v_mfma_f32_32x32x16_bf16 a[176:191], v[60:63], a[104:107], a[176:191]
v_add_u32 v20, 49152, v16
v_xad_u32 v21, v20, 64, s74
v_xad_u32 v22, v20, 64, s75
v_add_u32 v23, s81, v20
v_xor_b32 v24, 16, v20
v_xor_b32 v25, 16, v21
v_xor_b32 v26, 16, v22
v_xor_b32 v27, 16, v23
ds_read_b64_tr_b16 v[56:57], v20
ds_read_b64_tr_b16 v[58:59], v24 offset:3072
s_waitcnt lgkmcnt(8)
v_mfma_f32_32x32x16_bf16 a[192:207], v[64:67], a[104:107], a[192:207]
ds_read_b64_tr_b16 v[60:61], v21
ds_read_b64_tr_b16 v[62:63], v25 offset:3072
s_waitcnt lgkmcnt(8)
v_mfma_f32_32x32x16_bf16 a[160:175], v[68:71], a[108:111], a[160:175]
ds_read_b64_tr_b16 v[64:65], v20 offset:128
ds_read_b64_tr_b16 v[66:67], v24 offset:3200
s_waitcnt lgkmcnt(8)
v_mfma_f32_32x32x16_bf16 a[176:191], v[72:75], a[108:111], a[176:191]
ds_read_b64_tr_b16 v[68:69], v22
ds_read_b64_tr_b16 v[70:71], v26 offset:3072
s_waitcnt lgkmcnt(8)
v_mfma_f32_32x32x16_bf16 a[192:207], v[76:79], a[108:111], a[192:207]
s_waitcnt vmcnt(12)
s_barrier
ds_read_b64_tr_b16 v[72:73], v23
ds_read_b64_tr_b16 v[74:75], v27 offset:3072
s_waitcnt lgkmcnt(8)
v_mfma_f32_32x32x16_bf16 a[0:15], v[56:59], v[144:147], a[0:15]
s_add_u32 s61, s84, 9
s_cmp_ge_u32 s61, 10
s_cselect_b32 s73, 10, 0
s_sub_u32 s61, s61, s73
s_mul_i32 s61, s61, 786432
s_add_u32 s61, s61, s86
s_add_u32 s61, s61, 384
s_add_u32 m0, s83, 24576
s_nop 0
buffer_load_dwordx4 v7, s[28:31], s61 offen lds
buffer_load_dwordx4 v8, s[28:31], s61 offen offset:1024 lds
ds_read_b64_tr_b16 v[76:77], v22 offset:128
ds_read_b64_tr_b16 v[78:79], v26 offset:3200
s_waitcnt lgkmcnt(8)
v_mfma_f32_32x32x16_bf16 a[16:31], v[60:63], v[144:147], a[16:31]
buffer_load_dwordx4 v9, s[28:31], s61 offen offset:2048 lds
buffer_load_dwordx4 v10, s[28:31], s61 offen offset:3072 lds
ds_read_b64_tr_b16 v[56:57], v20 offset:6144
ds_read_b64_tr_b16 v[58:59], v24 offset:9216
s_waitcnt lgkmcnt(8)
v_mfma_f32_32x32x16_bf16 a[32:47], v[64:67], v[144:147], a[32:47]
s_add_u32 m0, s83, 28672
s_nop 0
buffer_load_dwordx4 v11, s[28:31], s61 offen lds
buffer_load_dwordx4 v12, s[28:31], s61 offen offset:1024 lds
ds_read_b64_tr_b16 v[60:61], v21 offset:6144
ds_read_b64_tr_b16 v[62:63], v25 offset:9216
s_waitcnt lgkmcnt(8)
v_mfma_f32_32x32x16_bf16 a[48:63], v[68:71], v[144:147], a[48:63]
v_fma_f32 v160, v160, s60, -v29
v_fma_f32 v161, v161, s60, -v29
v_exp_f32 v160, v160
v_exp_f32 v161, v161
v_fma_f32 v162, v162, s60, -v29
v_fma_f32 v163, v163, s60, -v29
v_exp_f32 v162, v162
v_exp_f32 v163, v163
ds_read_b64_tr_b16 v[64:65], v20 offset:6272
ds_read_b64_tr_b16 v[66:67], v24 offset:9344
s_waitcnt lgkmcnt(8)
v_mfma_f32_32x32x16_bf16 a[64:79], v[72:75], v[144:147], a[64:79]
v_add_f32 v30, v30, v160
v_add_f32 v30, v30, v161
v_cvt_pk_bf16_f32 v160, v160, v161
v_fma_f32 v164, v164, s60, -v29
v_fma_f32 v165, v165, s60, -v29
v_exp_f32 v164, v164
v_exp_f32 v165, v165
ds_read_b64_tr_b16 v[68:69], v22 offset:6144
ds_read_b64_tr_b16 v[70:71], v26 offset:9216
s_waitcnt lgkmcnt(8)
v_mfma_f32_32x32x16_bf16 a[80:95], v[76:79], v[144:147], a[80:95]
v_add_f32 v30, v30, v162
v_add_f32 v30, v30, v163
v_cvt_pk_bf16_f32 v161, v162, v163
ds_read_b64_tr_b16 v[72:73], v23 offset:6144
ds_read_b64_tr_b16 v[74:75], v27 offset:9216
s_waitcnt lgkmcnt(8)
v_mfma_f32_32x32x16_bf16 a[0:15], v[56:59], v[148:151], a[0:15]
v_fma_f32 v166, v166, s60, -v29
v_fma_f32 v167, v167, s60, -v29
v_exp_f32 v166, v166
v_exp_f32 v167, v167
v_add_f32 v30, v30, v164
v_add_f32 v30, v30, v165
v_cvt_pk_bf16_f32 v162, v164, v165
ds_read_b64_tr_b16 v[76:77], v22 offset:6272
ds_read_b64_tr_b16 v[78:79], v26 offset:9344
s_waitcnt lgkmcnt(8)
v_mfma_f32_32x32x16_bf16 a[16:31], v[60:63], v[148:151], a[16:31]
v_fma_f32 v168, v168, s60, -v29
v_fma_f32 v169, v169, s60, -v29
v_exp_f32 v168, v168
v_exp_f32 v169, v169
v_add_f32 v30, v30, v166
v_add_f32 v30, v30, v167
v_cvt_pk_bf16_f32 v163, v166, v167
v_add_u32 v20, 73728, v17
v_xad_u32 v21, v20, 64, s74
v_xor_b32 v22, 32, v20
v_xor_b32 v23, 32, v21
ds_read_b64_tr_b16 v[56:57], v20
ds_read_b64_tr_b16 v[58:59], v22 offset:1536
s_waitcnt lgkmcnt(8)
v_mfma_f32_32x32x16_bf16 a[32:47], v[64:67], v[148:151], a[32:47]
v_fma_f32 v170, v170, s60, -v29
v_fma_f32 v171, v171, s60, -v29
v_exp_f32 v170, v170
v_exp_f32 v171, v171
v_add_f32 v30, v30, v168
v_add_f32 v30, v30, v169
v_cvt_pk_bf16_f32 v164, v168, v169
ds_read_b64_tr_b16 v[60:61], v21
ds_read_b64_tr_b16 v[62:63], v23 offset:1536
s_waitcnt lgkmcnt(8)
v_mfma_f32_32x32x16_bf16 a[48:63], v[68:71], v[148:151], a[48:63]
v_fma_f32 v172, v172, s60, -v29
v_fma_f32 v173, v173, s60, -v29
v_exp_f32 v172, v172
v_exp_f32 v173, v173
v_add_f32 v30, v30, v170
v_add_f32 v30, v30, v171
v_cvt_pk_bf16_f32 v165, v170, v171
ds_read_b64_tr_b16 v[64:65], v20 offset:128
ds_read_b64_tr_b16 v[66:67], v22 offset:1664
s_waitcnt lgkmcnt(8)
v_mfma_f32_32x32x16_bf16 a[64:79], v[72:75], v[148:151], a[64:79]
v_fma_f32 v174, v174, s60, -v29
v_fma_f32 v175, v175, s60, -v29
v_exp_f32 v174, v174
v_exp_f32 v175, v175
v_add_f32 v30, v30, v172
v_add_f32 v30, v30, v173
v_cvt_pk_bf16_f32 v166, v172, v173
ds_read_b64_tr_b16 v[68:69], v20 offset:6144
ds_read_b64_tr_b16 v[70:71], v22 offset:7680
s_waitcnt lgkmcnt(8)
v_mfma_f32_32x32x16_bf16 a[80:95], v[76:79], v[148:151], a[80:95]
v_add_f32 v30, v30, v174
v_add_f32 v30, v30, v175
v_cvt_pk_bf16_f32 v167, v174, v175
s_barrier
ds_read_b64_tr_b16 v[72:73], v21 offset:6144
ds_read_b64_tr_b16 v[74:75], v23 offset:7680
s_waitcnt lgkmcnt(8)
v_mfma_f32_32x32x16_bf16 a[160:175], v[56:59], a[112:115], a[160:175]
s_add_u32 s61, s67, 4
s_and_b32 s61, s61, 7
s_mul_i32 s61, s61, 24576
s_add_u32 s61, s61, s83
s_add_u32 m0, s83, 49152
s_nop 0
buffer_load_dwordx4 v1, s[24:27], s61 offen nt lds
ds_read_b64_tr_b16 v[76:77], v20 offset:6272
ds_read_b64_tr_b16 v[78:79], v22 offset:7808
s_waitcnt lgkmcnt(8)
v_mfma_f32_32x32x16_bf16 a[176:191], v[60:63], a[112:115], a[176:191]
buffer_load_dwordx4 v2, s[24:27], s61 offen offset:1024 nt lds
ds_read_b64_tr_b16 v[56:57], v20 offset:12288
ds_read_b64_tr_b16 v[58:59], v22 offset:13824
s_waitcnt lgkmcnt(8)
v_mfma_f32_32x32x16_bf16 a[192:207], v[64:67], a[112:115], a[192:207]
buffer_load_dwordx4 v3, s[24:27], s61 offen offset:2048 nt lds
ds_read_b64_tr_b16 v[60:61], v21 offset:12288
ds_read_b64_tr_b16 v[62:63], v23 offset:13824
s_waitcnt lgkmcnt(8)
v_mfma_f32_32x32x16_bf16 a[160:175], v[68:71], a[116:119], a[160:175]
buffer_load_dwordx4 v4, s[24:27], s61 offen offset:3072 nt lds
ds_read_b64_tr_b16 v[64:65], v20 offset:12416
ds_read_b64_tr_b16 v[66:67], v22 offset:13952
s_waitcnt lgkmcnt(8)
v_mfma_f32_32x32x16_bf16 a[176:191], v[72:75], a[116:119], a[176:191]
s_add_u32 m0, s83, 53248
s_nop 0
buffer_load_dwordx4 v5, s[24:27], s61 offen nt lds
ds_read_b64_tr_b16 v[68:69], v20 offset:18432
ds_read_b64_tr_b16 v[70:71], v22 offset:19968
s_waitcnt lgkmcnt(8)
v_mfma_f32_32x32x16_bf16 a[192:207], v[76:79], a[116:119], a[192:207]
buffer_load_dwordx4 v6, s[24:27], s61 offen offset:1024 nt lds
ds_read_b64_tr_b16 v[72:73], v21 offset:18432
ds_read_b64_tr_b16 v[74:75], v23 offset:19968
s_waitcnt lgkmcnt(8)
v_mfma_f32_32x32x16_bf16 a[160:175], v[56:59], a[120:123], a[160:175]
ds_read_b64_tr_b16 v[76:77], v20 offset:18560
ds_read_b64_tr_b16 v[78:79], v22 offset:20096
s_waitcnt lgkmcnt(8)
v_mfma_f32_32x32x16_bf16 a[176:191], v[60:63], a[120:123], a[176:191]
v_add_u32 v20, 98304, v16
v_xad_u32 v21, v20, 64, s74
v_xad_u32 v22, v20, 64, s75
v_add_u32 v23, s81, v20
v_xor_b32 v24, 16, v20
v_xor_b32 v25, 16, v21
v_xor_b32 v26, 16, v22
v_xor_b32 v27, 16, v23
ds_read_b64_tr_b16 v[56:57], v20
ds_read_b64_tr_b16 v[58:59], v24 offset:3072
s_waitcnt lgkmcnt(8)
v_mfma_f32_32x32x16_bf16 a[192:207], v[64:67], a[120:123], a[192:207]
ds_read_b64_tr_b16 v[60:61], v21
ds_read_b64_tr_b16 v[62:63], v25 offset:3072
s_waitcnt lgkmcnt(8)
v_mfma_f32_32x32x16_bf16 a[160:175], v[68:71], a[124:127], a[160:175]
ds_read_b64_tr_b16 v[64:65], v20 offset:128
ds_read_b64_tr_b16 v[66:67], v24 offset:3200
s_waitcnt lgkmcnt(8)
v_mfma_f32_32x32x16_bf16 a[176:191], v[72:75], a[124:127], a[176:191]
ds_read_b64_tr_b16 v[68:69], v22
ds_read_b64_tr_b16 v[70:71], v26 offset:3072
s_waitcnt lgkmcnt(8)
v_mfma_f32_32x32x16_bf16 a[192:207], v[76:79], a[124:127], a[192:207]
s_waitcnt vmcnt(18)
s_barrier
ds_read_b64_tr_b16 v[72:73], v23
ds_read_b64_tr_b16 v[74:75], v27 offset:3072
s_waitcnt lgkmcnt(8)
v_mfma_f32_32x32x16_bf16 a[0:15], v[56:59], v[160:163], a[0:15]
s_add_u32 s61, s67, 5
s_and_b32 s61, s61, 7
s_mul_i32 s61, s61, 24576
s_add_u32 s61, s61, s83
s_add_u32 m0, s83, 73728
s_nop 0
buffer_load_dwordx4 v1, s[24:27], s61 offen nt lds
buffer_load_dwordx4 v2, s[24:27], s61 offen offset:1024 nt lds
ds_read_b64_tr_b16 v[76:77], v22 offset:128
ds_read_b64_tr_b16 v[78:79], v26 offset:3200
s_waitcnt lgkmcnt(8)
v_mfma_f32_32x32x16_bf16 a[16:31], v[60:63], v[160:163], a[16:31]
buffer_load_dwordx4 v3, s[24:27], s61 offen offset:2048 nt lds
buffer_load_dwordx4 v4, s[24:27], s61 offen offset:3072 nt lds
ds_read_b64_tr_b16 v[56:57], v20 offset:6144
ds_read_b64_tr_b16 v[58:59], v24 offset:9216
s_waitcnt lgkmcnt(8)
v_mfma_f32_32x32x16_bf16 a[32:47], v[64:67], v[160:163], a[32:47]
s_add_u32 m0, s83, 77824
s_nop 0
buffer_load_dwordx4 v5, s[24:27], s61 offen nt lds
buffer_load_dwordx4 v6, s[24:27], s61 offen offset:1024 nt lds
ds_read_b64_tr_b16 v[60:61], v21 offset:6144
ds_read_b64_tr_b16 v[62:63], v25 offset:9216
s_waitcnt lgkmcnt(8)
v_mfma_f32_32x32x16_bf16 a[48:63], v[68:71], v[160:163], a[48:63]
v_fma_f32 v176, v176, s60, -v29
v_fma_f32 v177, v177, s60, -v29
v_exp_f32 v176, v176
v_exp_f32 v177, v177
v_fma_f32 v178, v178, s60, -v29
v_fma_f32 v179, v179, s60, -v29
v_exp_f32 v178, v178
v_exp_f32 v179, v179
ds_read_b64_tr_b16 v[64:65], v20 offset:6272
ds_read_b64_tr_b16 v[66:67], v24 offset:9344
s_waitcnt lgkmcnt(8)
v_mfma_f32_32x32x16_bf16 a[64:79], v[72:75], v[160:163], a[64:79]
v_add_f32 v30, v30, v176
v_add_f32 v30, v30, v177
v_cvt_pk_bf16_f32 v176, v176, v177
v_fma_f32 v180, v180, s60, -v29
v_fma_f32 v181, v181, s60, -v29
v_exp_f32 v180, v180
v_exp_f32 v181, v181
ds_read_b64_tr_b16 v[68:69], v22 offset:6144
ds_read_b64_tr_b16 v[70:71], v26 offset:9216
s_waitcnt lgkmcnt(8)
v_mfma_f32_32x32x16_bf16 a[80:95], v[76:79], v[160:163], a[80:95]
v_add_f32 v30, v30, v178
v_add_f32 v30, v30, v179
v_cvt_pk_bf16_f32 v177, v178, v179
ds_read_b64_tr_b16 v[72:73], v23 offset:6144
ds_read_b64_tr_b16 v[74:75], v27 offset:9216
s_waitcnt lgkmcnt(8)
v_mfma_f32_32x32x16_bf16 a[0:15], v[56:59], v[164:167], a[0:15]
v_fma_f32 v182, v182, s60, -v29
v_fma_f32 v183, v183, s60, -v29
v_exp_f32 v182, v182
v_exp_f32 v183, v183
v_add_f32 v30, v30, v180
v_add_f32 v30, v30, v181
v_cvt_pk_bf16_f32 v178, v180, v181
ds_read_b64_tr_b16 v[76:77], v22 offset:6272
ds_read_b64_tr_b16 v[78:79], v26 offset:9344
s_waitcnt lgkmcnt(8)
v_mfma_f32_32x32x16_bf16 a[16:31], v[60:63], v[164:167], a[16:31]
v_fma_f32 v184, v184, s60, -v29
v_fma_f32 v185, v185, s60, -v29
v_exp_f32 v184, v184
v_exp_f32 v185, v185
v_add_f32 v30, v30, v182
v_add_f32 v30, v30, v183
v_cvt_pk_bf16_f32 v179, v182, v183
v_add_u32 v20, 122880, v17
v_xad_u32 v21, v20, 64, s74
v_xor_b32 v22, 32, v20
v_xor_b32 v23, 32, v21
ds_read_b64_tr_b16 v[56:57], v20
ds_read_b64_tr_b16 v[58:59], v22 offset:1536
s_waitcnt lgkmcnt(8)
v_mfma_f32_32x32x16_bf16 a[32:47], v[64:67], v[164:167], a[32:47]
v_fma_f32 v186, v186, s60, -v29
v_fma_f32 v187, v187, s60, -v29
v_exp_f32 v186, v186
v_exp_f32 v187, v187
v_add_f32 v30, v30, v184
v_add_f32 v30, v30, v185
v_cvt_pk_bf16_f32 v180, v184, v185
ds_read_b64_tr_b16 v[60:61], v21
ds_read_b64_tr_b16 v[62:63], v23 offset:1536
s_waitcnt lgkmcnt(8)
v_mfma_f32_32x32x16_bf16 a[48:63], v[68:71], v[164:167], a[48:63]
v_fma_f32 v188, v188, s60, -v29
v_fma_f32 v189, v189, s60, -v29
v_exp_f32 v188, v188
v_exp_f32 v189, v189
v_add_f32 v30, v30, v186
v_add_f32 v30, v30, v187
v_cvt_pk_bf16_f32 v181, v186, v187
ds_read_b64_tr_b16 v[64:65], v20 offset:128
ds_read_b64_tr_b16 v[66:67], v22 offset:1664
s_waitcnt lgkmcnt(8)
v_mfma_f32_32x32x16_bf16 a[64:79], v[72:75], v[164:167], a[64:79]
v_fma_f32 v190, v190, s60, -v29
v_fma_f32 v191, v191, s60, -v29
v_exp_f32 v190, v190
v_exp_f32 v191, v191
v_add_f32 v30, v30, v188
v_add_f32 v30, v30, v189
v_cvt_pk_bf16_f32 v182, v188, v189
ds_read_b64_tr_b16 v[68:69], v20 offset:6144
ds_read_b64_tr_b16 v[70:71], v22 offset:7680
s_waitcnt lgkmcnt(8)
v_mfma_f32_32x32x16_bf16 a[80:95], v[76:79], v[164:167], a[80:95]
v_add_f32 v30, v30, v190
v_add_f32 v30, v30, v191
v_cvt_pk_bf16_f32 v183, v190, v191
s_waitcnt vmcnt(18)
s_barrier
ds_read_b64_tr_b16 v[72:73], v21 offset:6144
ds_read_b64_tr_b16 v[74:75], v23 offset:7680
s_waitcnt lgkmcnt(8)
v_mfma_f32_32x32x16_bf16 a[160:175], v[56:59], a[128:131], a[160:175]
s_add_u32 s61, s67, 6
s_and_b32 s61, s61, 7
s_mul_i32 s61, s61, 24576
s_add_u32 s61, s61, s83
s_add_u32 m0, s83, 98304
s_nop 0
buffer_load_dwordx4 v1, s[24:27], s61 offen nt lds
ds_read_b64_tr_b16 v[76:77], v20 offset:6272
ds_read_b64_tr_b16 v[78:79], v22 offset:7808
s_waitcnt lgkmcnt(8)
v_mfma_f32_32x32x16_bf16 a[176:191], v[60:63], a[128:131], a[176:191]
buffer_load_dwordx4 v2, s[24:27], s61 offen offset:1024 nt lds
ds_read_b64_tr_b16 v[56:57], v20 offset:12288
ds_read_b64_tr_b16 v[58:59], v22 offset:13824
s_waitcnt lgkmcnt(8)
v_mfma_f32_32x32x16_bf16 a[192:207], v[64:67], a[128:131], a[192:207]
buffer_load_dwordx4 v3, s[24:27], s61 offen offset:2048 nt lds
ds_read_b64_tr_b16 v[60:61], v21 offset:12288
ds_read_b64_tr_b16 v[62:63], v23 offset:13824
s_waitcnt lgkmcnt(8)
v_mfma_f32_32x32x16_bf16 a[160:175], v[68:71], a[132:135], a[160:175]
buffer_load_dwordx4 v4, s[24:27], s61 offen offset:3072 nt lds
ds_read_b64_tr_b16 v[64:65], v20 offset:12416
ds_read_b64_tr_b16 v[66:67], v22 offset:13952
s_waitcnt lgkmcnt(8)
v_mfma_f32_32x32x16_bf16 a[176:191], v[72:75], a[132:135], a[176:191]
s_add_u32 m0, s83, 102400
s_nop 0
buffer_load_dwordx4 v5, s[24:27], s61 offen nt lds
ds_read_b64_tr_b16 v[68:69], v20 offset:18432
ds_read_b64_tr_b16 v[70:71], v22 offset:19968
s_waitcnt lgkmcnt(8)
v_mfma_f32_32x32x16_bf16 a[192:207], v[76:79], a[132:135], a[192:207]
buffer_load_dwordx4 v6, s[24:27], s61 offen offset:1024 nt lds
ds_read_b64_tr_b16 v[72:73], v21 offset:18432
ds_read_b64_tr_b16 v[74:75], v23 offset:19968
s_waitcnt lgkmcnt(8)
v_mfma_f32_32x32x16_bf16 a[160:175], v[56:59], a[136:139], a[160:175]
ds_read_b64_tr_b16 v[76:77], v20 offset:18560
ds_read_b64_tr_b16 v[78:79], v22 offset:20096
s_waitcnt lgkmcnt(8)
v_mfma_f32_32x32x16_bf16 a[176:191], v[60:63], a[136:139], a[176:191]
v_add_u32 v20, 0, v16
v_xad_u32 v21, v20, 64, s74
v_xad_u32 v22, v20, 64, s75
v_add_u32 v23, s81, v20
v_xor_b32 v24, 16, v20
v_xor_b32 v25, 16, v21
v_xor_b32 v26, 16, v22
v_xor_b32 v27, 16, v23
ds_read_b64_tr_b16 v[56:57], v20
ds_read_b64_tr_b16 v[58:59], v24 offset:3072
s_waitcnt lgkmcnt(8)
v_mfma_f32_32x32x16_bf16 a[192:207], v[64:67], a[136:139], a[192:207]
ds_read_b64_tr_b16 v[60:61], v21
ds_read_b64_tr_b16 v[62:63], v25 offset:3072
s_waitcnt lgkmcnt(8)
v_mfma_f32_32x32x16_bf16 a[160:175], v[68:71], a[140:143], a[160:175]
ds_read_b64_tr_b16 v[64:65], v20 offset:128
ds_read_b64_tr_b16 v[66:67], v24 offset:3200
s_waitcnt lgkmcnt(8)
v_mfma_f32_32x32x16_bf16 a[176:191], v[72:75], a[140:143], a[176:191]
ds_read_b64_tr_b16 v[68:69], v22
ds_read_b64_tr_b16 v[70:71], v26 offset:3072
s_waitcnt lgkmcnt(8)
v_mfma_f32_32x32x16_bf16 a[192:207], v[76:79], a[140:143], a[192:207]
s_waitcnt vmcnt(18)
s_barrier
ds_read_b64_tr_b16 v[72:73], v23
ds_read_b64_tr_b16 v[74:75], v27 offset:3072
s_waitcnt lgkmcnt(8)
v_mfma_f32_32x32x16_bf16 a[0:15], v[56:59], v[176:179], a[0:15]
s_add_u32 s61, s67, 7
s_and_b32 s61, s61, 7
s_mul_i32 s61, s61, 24576
s_add_u32 s61, s61, s83
s_add_u32 m0, s83, 122880
s_nop 0
buffer_load_dwordx4 v1, s[24:27], s61 offen nt lds
buffer_load_dwordx4 v2, s[24:27], s61 offen offset:1024 nt lds
ds_read_b64_tr_b16 v[76:77], v22 offset:128
ds_read_b64_tr_b16 v[78:79], v26 offset:3200
s_waitcnt lgkmcnt(8)
v_mfma_f32_32x32x16_bf16 a[16:31], v[60:63], v[176:179], a[16:31]
buffer_load_dwordx4 v3, s[24:27], s61 offen offset:2048 nt lds
buffer_load_dwordx4 v4, s[24:27], s61 offen offset:3072 nt lds
ds_read_b64_tr_b16 v[56:57], v20 offset:6144
ds_read_b64_tr_b16 v[58:59], v24 offset:9216
s_waitcnt lgkmcnt(8)
v_mfma_f32_32x32x16_bf16 a[32:47], v[64:67], v[176:179], a[32:47]
s_add_u32 m0, s83, 126976
s_nop 0
buffer_load_dwordx4 v5, s[24:27], s61 offen nt lds
buffer_load_dwordx4 v6, s[24:27], s61 offen offset:1024 nt lds
ds_read_b64_tr_b16 v[60:61], v21 offset:6144
ds_read_b64_tr_b16 v[62:63], v25 offset:9216
s_waitcnt lgkmcnt(8)
v_mfma_f32_32x32x16_bf16 a[48:63], v[68:71], v[176:179], a[48:63]
v_fma_f32 v192, v192, s60, -v29
v_fma_f32 v193, v193, s60, -v29
v_exp_f32 v192, v192
v_exp_f32 v193, v193
v_fma_f32 v194, v194, s60, -v29
v_fma_f32 v195, v195, s60, -v29
v_exp_f32 v194, v194
v_exp_f32 v195, v195
ds_read_b64_tr_b16 v[64:65], v20 offset:6272
ds_read_b64_tr_b16 v[66:67], v24 offset:9344
s_waitcnt lgkmcnt(8)
v_mfma_f32_32x32x16_bf16 a[64:79], v[72:75], v[176:179], a[64:79]
v_add_f32 v30, v30, v192
v_add_f32 v30, v30, v193
v_cvt_pk_bf16_f32 v192, v192, v193
v_fma_f32 v196, v196, s60, -v29
v_fma_f32 v197, v197, s60, -v29
v_exp_f32 v196, v196
v_exp_f32 v197, v197
ds_read_b64_tr_b16 v[68:69], v22 offset:6144
ds_read_b64_tr_b16 v[70:71], v26 offset:9216
s_waitcnt lgkmcnt(8)
v_mfma_f32_32x32x16_bf16 a[80:95], v[76:79], v[176:179], a[80:95]
v_add_f32 v30, v30, v194
v_add_f32 v30, v30, v195
v_cvt_pk_bf16_f32 v193, v194, v195
ds_read_b64_tr_b16 v[72:73], v23 offset:6144
ds_read_b64_tr_b16 v[74:75], v27 offset:9216
s_waitcnt lgkmcnt(8)
v_mfma_f32_32x32x16_bf16 a[0:15], v[56:59], v[180:183], a[0:15]
v_fma_f32 v198, v198, s60, -v29
v_fma_f32 v199, v199, s60, -v29
v_exp_f32 v198, v198
v_exp_f32 v199, v199
v_add_f32 v30, v30, v196
v_add_f32 v30, v30, v197
v_cvt_pk_bf16_f32 v194, v196, v197
ds_read_b64_tr_b16 v[76:77], v22 offset:6272
ds_read_b64_tr_b16 v[78:79], v26 offset:9344
s_waitcnt lgkmcnt(8)
v_mfma_f32_32x32x16_bf16 a[16:31], v[60:63], v[180:183], a[16:31]
v_fma_f32 v200, v200, s60, -v29
v_fma_f32 v201, v201, s60, -v29
v_exp_f32 v200, v200
v_exp_f32 v201, v201
v_add_f32 v30, v30, v198
v_add_f32 v30, v30, v199
v_cvt_pk_bf16_f32 v195, v198, v199
v_add_u32 v20, 24576, v17
v_xad_u32 v21, v20, 64, s74
v_xor_b32 v22, 32, v20
v_xor_b32 v23, 32, v21
ds_read_b64_tr_b16 v[56:57], v20
ds_read_b64_tr_b16 v[58:59], v22 offset:1536
s_waitcnt lgkmcnt(8)
v_mfma_f32_32x32x16_bf16 a[32:47], v[64:67], v[180:183], a[32:47]
v_fma_f32 v202, v202, s60, -v29
v_fma_f32 v203, v203, s60, -v29
v_exp_f32 v202, v202
v_exp_f32 v203, v203
v_add_f32 v30, v30, v200
v_add_f32 v30, v30, v201
v_cvt_pk_bf16_f32 v196, v200, v201
ds_read_b64_tr_b16 v[60:61], v21
ds_read_b64_tr_b16 v[62:63], v23 offset:1536
s_waitcnt lgkmcnt(8)
v_mfma_f32_32x32x16_bf16 a[48:63], v[68:71], v[180:183], a[48:63]
v_fma_f32 v204, v204, s60, -v29
v_fma_f32 v205, v205, s60, -v29
v_exp_f32 v204, v204
v_exp_f32 v205, v205
v_add_f32 v30, v30, v202
v_add_f32 v30, v30, v203
v_cvt_pk_bf16_f32 v197, v202, v203
ds_read_b64_tr_b16 v[64:65], v20 offset:128
ds_read_b64_tr_b16 v[66:67], v22 offset:1664
s_waitcnt lgkmcnt(8)
v_mfma_f32_32x32x16_bf16 a[64:79], v[72:75], v[180:183], a[64:79]
v_fma_f32 v206, v206, s60, -v29
v_fma_f32 v207, v207, s60, -v29
v_exp_f32 v206, v206
v_exp_f32 v207, v207
v_add_f32 v30, v30, v204
v_add_f32 v30, v30, v205
v_cvt_pk_bf16_f32 v198, v204, v205
ds_read_b64_tr_b16 v[68:69], v20 offset:6144
ds_read_b64_tr_b16 v[70:71], v22 offset:7680
s_waitcnt lgkmcnt(8)
v_mfma_f32_32x32x16_bf16 a[80:95], v[76:79], v[180:183], a[80:95]
v_add_f32 v30, v30, v206
v_add_f32 v30, v30, v207
v_cvt_pk_bf16_f32 v199, v206, v207
s_waitcnt vmcnt(18)
s_barrier
ds_read_b64_tr_b16 v[72:73], v21 offset:6144
ds_read_b64_tr_b16 v[74:75], v23 offset:7680
s_waitcnt lgkmcnt(8)
v_mfma_f32_32x32x16_bf16 a[160:175], v[56:59], a[144:147], a[160:175]
ds_read_b64_tr_b16 v[76:77], v20 offset:6272
ds_read_b64_tr_b16 v[78:79], v22 offset:7808
s_waitcnt lgkmcnt(8)
v_mfma_f32_32x32x16_bf16 a[176:191], v[60:63], a[144:147], a[176:191]
ds_read_b64_tr_b16 v[56:57], v20 offset:12288
ds_read_b64_tr_b16 v[58:59], v22 offset:13824
s_waitcnt lgkmcnt(8)
v_mfma_f32_32x32x16_bf16 a[192:207], v[64:67], a[144:147], a[192:207]
ds_read_b64_tr_b16 v[60:61], v21 offset:12288
ds_read_b64_tr_b16 v[62:63], v23 offset:13824
s_waitcnt lgkmcnt(8)
v_mfma_f32_32x32x16_bf16 a[160:175], v[68:71], a[148:151], a[160:175]
ds_read_b64_tr_b16 v[64:65], v20 offset:12416
ds_read_b64_tr_b16 v[66:67], v22 offset:13952
s_waitcnt lgkmcnt(8)
v_mfma_f32_32x32x16_bf16 a[176:191], v[72:75], a[148:151], a[176:191]
ds_read_b64_tr_b16 v[68:69], v20 offset:18432
ds_read_b64_tr_b16 v[70:71], v22 offset:19968
s_waitcnt lgkmcnt(8)
v_mfma_f32_32x32x16_bf16 a[192:207], v[76:79], a[148:151], a[192:207]
ds_read_b64_tr_b16 v[72:73], v21 offset:18432
ds_read_b64_tr_b16 v[74:75], v23 offset:19968
s_waitcnt lgkmcnt(8)
v_mfma_f32_32x32x16_bf16 a[160:175], v[56:59], a[152:155], a[160:175]
ds_read_b64_tr_b16 v[76:77], v20 offset:18560
ds_read_b64_tr_b16 v[78:79], v22 offset:20096
s_waitcnt lgkmcnt(8)
v_mfma_f32_32x32x16_bf16 a[176:191], v[60:63], a[152:155], a[176:191]
v_add_u32 v20, 49152, v16
v_xad_u32 v21, v20, 64, s74
v_xad_u32 v22, v20, 64, s75
v_add_u32 v23, s81, v20
v_xor_b32 v24, 16, v20
v_xor_b32 v25, 16, v21
v_xor_b32 v26, 16, v22
v_xor_b32 v27, 16, v23
ds_read_b64_tr_b16 v[56:57], v20
ds_read_b64_tr_b16 v[58:59], v24 offset:3072
s_waitcnt lgkmcnt(8)
v_mfma_f32_32x32x16_bf16 a[192:207], v[64:67], a[152:155], a[192:207]
ds_read_b64_tr_b16 v[60:61], v21
ds_read_b64_tr_b16 v[62:63], v25 offset:3072
s_waitcnt lgkmcnt(8)
v_mfma_f32_32x32x16_bf16 a[160:175], v[68:71], a[156:159], a[160:175]
ds_read_b64_tr_b16 v[64:65], v20 offset:128
ds_read_b64_tr_b16 v[66:67], v24 offset:3200
s_waitcnt lgkmcnt(8)
v_mfma_f32_32x32x16_bf16 a[176:191], v[72:75], a[156:159], a[176:191]
ds_read_b64_tr_b16 v[68:69], v22
ds_read_b64_tr_b16 v[70:71], v26 offset:3072
s_waitcnt lgkmcnt(8)
v_mfma_f32_32x32x16_bf16 a[192:207], v[76:79], a[156:159], a[192:207]
s_waitcnt vmcnt(12)
s_barrier
ds_read_b64_tr_b16 v[72:73], v23
ds_read_b64_tr_b16 v[74:75], v27 offset:3072
s_waitcnt lgkmcnt(8)
v_mfma_f32_32x32x16_bf16 a[0:15], v[56:59], v[192:195], a[0:15]
v_accvgpr_read_b32 v32, a160
v_accvgpr_read_b32 v33, a161
v_accvgpr_read_b32 v34, a162
v_accvgpr_read_b32 v35, a163
v_accvgpr_read_b32 v36, a164
v_accvgpr_read_b32 v37, a165
v_accvgpr_read_b32 v38, a166
v_accvgpr_read_b32 v39, a167
v_cvt_pk_bf16_f32 v40, v32, v33
v_cvt_pk_bf16_f32 v41, v34, v35
v_cvt_pk_bf16_f32 v42, v36, v37
v_cvt_pk_bf16_f32 v43, v38, v39
s_nop 0
v_permlane32_swap_b32 v40, v42
v_permlane32_swap_b32 v41, v43
v_add_u32 v32, 0, v49
ds_write_b128 v32, v[40:43]
s_nop 1
v_accvgpr_read_b32 v32, a168
v_accvgpr_read_b32 v33, a169
v_accvgpr_read_b32 v34, a170
v_accvgpr_read_b32 v35, a171
v_accvgpr_read_b32 v36, a172
v_accvgpr_read_b32 v37, a173
v_accvgpr_read_b32 v38, a174
v_accvgpr_read_b32 v39, a175
v_cvt_pk_bf16_f32 v40, v32, v33
v_cvt_pk_bf16_f32 v41, v34, v35
v_cvt_pk_bf16_f32 v42, v36, v37
v_cvt_pk_bf16_f32 v43, v38, v39
s_nop 0
v_permlane32_swap_b32 v40, v42
v_permlane32_swap_b32 v41, v43
v_add_u32 v32, 0, v49
ds_write_b128 v32, v[40:43] offset:1024
ds_read_b64_tr_b16 v[76:77], v22 offset:128
ds_read_b64_tr_b16 v[78:79], v26 offset:3200
s_waitcnt lgkmcnt(10)
v_mfma_f32_32x32x16_bf16 a[16:31], v[60:63], v[192:195], a[16:31]
v_accvgpr_read_b32 v32, a176
v_accvgpr_read_b32 v33, a177
v_accvgpr_read_b32 v34, a178
v_accvgpr_read_b32 v35, a179
v_accvgpr_read_b32 v36, a180
v_accvgpr_read_b32 v37, a181
v_accvgpr_read_b32 v38, a182
v_accvgpr_read_b32 v39, a183
v_cvt_pk_bf16_f32 v40, v32, v33
v_cvt_pk_bf16_f32 v41, v34, v35
v_cvt_pk_bf16_f32 v42, v36, v37
v_cvt_pk_bf16_f32 v43, v38, v39
s_nop 0
v_permlane32_swap_b32 v40, v42
v_permlane32_swap_b32 v41, v43
v_add_u32 v32, 0, v49
ds_write_b128 v32, v[40:43] offset:2048
s_nop 1
v_accvgpr_read_b32 v32, a184
v_accvgpr_read_b32 v33, a185
v_accvgpr_read_b32 v34, a186
v_accvgpr_read_b32 v35, a187
v_accvgpr_read_b32 v36, a188
v_accvgpr_read_b32 v37, a189
v_accvgpr_read_b32 v38, a190
v_accvgpr_read_b32 v39, a191
v_cvt_pk_bf16_f32 v40, v32, v33
v_cvt_pk_bf16_f32 v41, v34, v35
v_cvt_pk_bf16_f32 v42, v36, v37
v_cvt_pk_bf16_f32 v43, v38, v39
s_nop 0
v_permlane32_swap_b32 v40, v42
v_permlane32_swap_b32 v41, v43
v_add_u32 v32, 0, v49
ds_write_b128 v32, v[40:43] offset:3072
ds_read_b64_tr_b16 v[56:57], v20 offset:6144
ds_read_b64_tr_b16 v[58:59], v24 offset:9216
s_waitcnt lgkmcnt(12)
v_mfma_f32_32x32x16_bf16 a[32:47], v[64:67], v[192:195], a[32:47]
v_accvgpr_read_b32 v32, a192
v_accvgpr_read_b32 v33, a193
v_accvgpr_read_b32 v34, a194
v_accvgpr_read_b32 v35, a195
v_accvgpr_read_b32 v36, a196
v_accvgpr_read_b32 v37, a197
v_accvgpr_read_b32 v38, a198
v_accvgpr_read_b32 v39, a199
v_cvt_pk_bf16_f32 v40, v32, v33
v_cvt_pk_bf16_f32 v41, v34, v35
v_cvt_pk_bf16_f32 v42, v36, v37
v_cvt_pk_bf16_f32 v43, v38, v39
s_nop 0
v_permlane32_swap_b32 v40, v42
v_permlane32_swap_b32 v41, v43
v_add_u32 v32, 0, v49
ds_write_b128 v32, v[40:43] offset:4096
s_nop 1
v_accvgpr_read_b32 v32, a200
v_accvgpr_read_b32 v33, a201
v_accvgpr_read_b32 v34, a202
v_accvgpr_read_b32 v35, a203
v_accvgpr_read_b32 v36, a204
v_accvgpr_read_b32 v37, a205
v_accvgpr_read_b32 v38, a206
v_accvgpr_read_b32 v39, a207
v_cvt_pk_bf16_f32 v40, v32, v33
v_cvt_pk_bf16_f32 v41, v34, v35
v_cvt_pk_bf16_f32 v42, v36, v37
v_cvt_pk_bf16_f32 v43, v38, v39
s_nop 0
v_permlane32_swap_b32 v40, v42
v_permlane32_swap_b32 v41, v43
v_add_u32 v32, 0, v49
ds_write_b128 v32, v[40:43] offset:5120
ds_read_b64_tr_b16 v[60:61], v21 offset:6144
ds_read_b64_tr_b16 v[62:63], v25 offset:9216
s_waitcnt lgkmcnt(14)
v_mfma_f32_32x32x16_bf16 a[48:63], v[68:71], v[192:195], a[48:63]
s_waitcnt lgkmcnt(0)
v_fma_f32 v208, v208, s60, -v29
v_fma_f32 v209, v209, s60, -v29
v_exp_f32 v208, v208
v_exp_f32 v209, v209
ds_read_b64_tr_b16 v[64:65], v20 offset:6272
ds_read_b64_tr_b16 v[66:67], v24 offset:9344
v_mfma_f32_32x32x16_bf16 a[64:79], v[72:75], v[192:195], a[64:79]
v_fma_f32 v210, v210, s60, -v29
v_fma_f32 v211, v211, s60, -v29
v_exp_f32 v210, v210
v_exp_f32 v211, v211
v_add_f32 v30, v30, v208
v_add_f32 v30, v30, v209
v_cvt_pk_bf16_f32 v208, v208, v209
ds_read_b64_tr_b16 v[68:69], v22 offset:6144
ds_read_b64_tr_b16 v[70:71], v26 offset:9216
v_mfma_f32_32x32x16_bf16 a[80:95], v[76:79], v[192:195], a[80:95]
v_fma_f32 v212, v212, s60, -v29
v_fma_f32 v213, v213, s60, -v29
v_exp_f32 v212, v212
v_exp_f32 v213, v213
v_add_f32 v30, v30, v210
v_add_f32 v30, v30, v211
v_cvt_pk_bf16_f32 v209, v210, v211
ds_read_b64_tr_b16 v[72:73], v23 offset:6144
ds_read_b64_tr_b16 v[74:75], v27 offset:9216
v_mfma_f32_32x32x16_bf16 a[0:15], v[56:59], v[196:199], a[0:15]
v_fma_f32 v214, v214, s60, -v29
v_fma_f32 v215, v215, s60, -v29
v_exp_f32 v214, v214
v_exp_f32 v215, v215
v_add_f32 v30, v30, v212
v_add_f32 v30, v30, v213
v_cvt_pk_bf16_f32 v210, v212, v213
ds_read_b64_tr_b16 v[76:77], v22 offset:6272
ds_read_b64_tr_b16 v[78:79], v26 offset:9344
v_mfma_f32_32x32x16_bf16 a[16:31], v[60:63], v[196:199], a[16:31]
v_fma_f32 v216, v216, s60, -v29
v_fma_f32 v217, v217, s60, -v29
v_exp_f32 v216, v216
v_exp_f32 v217, v217
v_add_f32 v30, v30, v214
v_add_f32 v30, v30, v215
v_cvt_pk_bf16_f32 v211, v214, v215
v_add_u32 v20, 73728, v16
v_xad_u32 v21, v20, 64, s74
v_xad_u32 v22, v20, 64, s75
v_add_u32 v23, s81, v20
v_xor_b32 v24, 16, v20
v_xor_b32 v25, 16, v21
v_xor_b32 v26, 16, v22
v_xor_b32 v27, 16, v23
ds_read_b64_tr_b16 v[56:57], v20
ds_read_b64_tr_b16 v[58:59], v24 offset:3072
s_waitcnt lgkmcnt(8)
v_mfma_f32_32x32x16_bf16 a[32:47], v[64:67], v[196:199], a[32:47]
v_fma_f32 v218, v218, s60, -v29
v_fma_f32 v219, v219, s60, -v29
v_exp_f32 v218, v218
v_exp_f32 v219, v219
v_add_f32 v30, v30, v216
v_add_f32 v30, v30, v217
v_cvt_pk_bf16_f32 v212, v216, v217
ds_read_b64_tr_b16 v[60:61], v21
ds_read_b64_tr_b16 v[62:63], v25 offset:3072
s_waitcnt lgkmcnt(8)
v_mfma_f32_32x32x16_bf16 a[48:63], v[68:71], v[196:199], a[48:63]
v_fma_f32 v220, v220, s60, -v29
v_fma_f32 v221, v221, s60, -v29
v_exp_f32 v220, v220
v_exp_f32 v221, v221
v_add_f32 v30, v30, v218
v_add_f32 v30, v30, v219
v_cvt_pk_bf16_f32 v213, v218, v219
ds_read_b64_tr_b16 v[64:65], v20 offset:128
ds_read_b64_tr_b16 v[66:67], v24 offset:3200
s_waitcnt lgkmcnt(8)
v_mfma_f32_32x32x16_bf16 a[64:79], v[72:75], v[196:199], a[64:79]
v_fma_f32 v222, v222, s60, -v29
v_fma_f32 v223, v223, s60, -v29
v_exp_f32 v222, v222
v_exp_f32 v223, v223
v_add_f32 v30, v30, v220
v_add_f32 v30, v30, v221
v_cvt_pk_bf16_f32 v214, v220, v221
ds_read_b64_tr_b16 v[68:69], v22
ds_read_b64_tr_b16 v[70:71], v26 offset:3072
s_waitcnt lgkmcnt(8)
v_mfma_f32_32x32x16_bf16 a[80:95], v[76:79], v[196:199], a[80:95]
v_add_f32 v30, v30, v222
v_add_f32 v30, v30, v223
v_cvt_pk_bf16_f32 v215, v222, v223
s_waitcnt vmcnt(6)
s_barrier
ds_read_b64_tr_b16 v[72:73], v23
ds_read_b64_tr_b16 v[74:75], v27 offset:3072
s_waitcnt lgkmcnt(8)
v_mfma_f32_32x32x16_bf16 a[0:15], v[56:59], v[208:211], a[0:15]
s_add_u32 s61, s67, 0
s_and_b32 s61, s61, 7
s_mul_i32 s61, s61, 24576
s_add_u32 s61, s61, s83
s_add_u32 s61, s61, 196608
s_add_u32 m0, s83, 49152
s_nop 0
buffer_load_dwordx4 v1, s[20:23], s61 offen nt lds
buffer_load_dwordx4 v2, s[20:23], s61 offen offset:1024 nt lds
buffer_load_dwordx4 v3, s[20:23], s61 offen offset:2048 nt lds
ds_read_b64_tr_b16 v[76:77], v22 offset:128
ds_read_b64_tr_b16 v[78:79], v26 offset:3200
s_waitcnt lgkmcnt(8)
v_mfma_f32_32x32x16_bf16 a[16:31], v[60:63], v[208:211], a[16:31]
buffer_load_dwordx4 v4, s[20:23], s61 offen offset:3072 nt lds
s_add_u32 m0, s83, 53248
s_nop 0
buffer_load_dwordx4 v5, s[20:23], s61 offen nt lds
buffer_load_dwordx4 v6, s[20:23], s61 offen offset:1024 nt lds
ds_read_b64_tr_b16 v[56:57], v20 offset:6144
ds_read_b64_tr_b16 v[58:59], v24 offset:9216
s_waitcnt lgkmcnt(8)
v_mfma_f32_32x32x16_bf16 a[32:47], v[64:67], v[208:211], a[32:47]
v_add_u32 v44, 0, v50
ds_read_b128 v[80:83], v44
ds_read_b128 v[84:87], v44 offset:1024
ds_read_b64_tr_b16 v[60:61], v21 offset:6144
ds_read_b64_tr_b16 v[62:63], v25 offset:9216
s_waitcnt lgkmcnt(10)
v_mfma_f32_32x32x16_bf16 a[48:63], v[68:71], v[208:211], a[48:63]
ds_read_b128 v[88:91], v44 offset:2048
ds_read_b128 v[92:95], v44 offset:3072
ds_read_b128 v[96:99], v44 offset:4096
ds_read_b64_tr_b16 v[64:65], v20 offset:6272
ds_read_b64_tr_b16 v[66:67], v24 offset:9344
s_waitcnt lgkmcnt(13)
v_mfma_f32_32x32x16_bf16 a[64:79], v[72:75], v[208:211], a[64:79]
ds_read_b128 v[100:103], v44 offset:5120
ds_read_b128 v[104:107], v44 offset:6144
ds_read_b128 v[108:111], v44 offset:7168
ds_read_b64_tr_b16 v[68:69], v22 offset:6144
ds_read_b64_tr_b16 v[70:71], v26 offset:9216
s_waitcnt lgkmcnt(15)
v_mfma_f32_32x32x16_bf16 a[80:95], v[76:79], v[208:211], a[80:95]
ds_read_b128 v[112:115], v44 offset:8192
ds_read_b128 v[116:119], v44 offset:9216
ds_read_b128 v[120:123], v44 offset:10240
ds_read_b64_tr_b16 v[72:73], v23 offset:6144
ds_read_b64_tr_b16 v[74:75], v27 offset:9216
s_waitcnt lgkmcnt(15)
v_mfma_f32_32x32x16_bf16 a[0:15], v[56:59], v[212:215], a[0:15]
ds_read_b128 v[124:127], v44 offset:11264
s_waitcnt lgkmcnt(0)
v_fma_f32 v224, v224, s60, -v29
v_fma_f32 v225, v225, s60, -v29
v_exp_f32 v224, v224
v_exp_f32 v225, v225
ds_read_b64_tr_b16 v[76:77], v22 offset:6272
ds_read_b64_tr_b16 v[78:79], v26 offset:9344
v_mfma_f32_32x32x16_bf16 a[16:31], v[60:63], v[212:215], a[16:31]
v_fma_f32 v226, v226, s60, -v29
v_fma_f32 v227, v227, s60, -v29
v_exp_f32 v226, v226
v_exp_f32 v227, v227
v_add_f32 v30, v30, v224
v_add_f32 v30, v30, v225
v_cvt_pk_bf16_f32 v224, v224, v225
v_fma_f32 v228, v228, s60, -v29
v_fma_f32 v229, v229, s60, -v29
v_exp_f32 v228, v228
v_exp_f32 v229, v229
v_add_u32 v20, 98304, v16
v_xad_u32 v21, v20, 64, s74
v_xad_u32 v22, v20, 64, s75
v_add_u32 v23, s81, v20
v_xor_b32 v24, 16, v20
v_xor_b32 v25, 16, v21
v_xor_b32 v26, 16, v22
v_xor_b32 v27, 16, v23
ds_read_b64_tr_b16 v[56:57], v20
ds_read_b64_tr_b16 v[58:59], v24 offset:3072
v_mfma_f32_32x32x16_bf16 a[32:47], v[64:67], v[212:215], a[32:47]
v_add_f32 v30, v30, v226
v_add_f32 v30, v30, v227
v_cvt_pk_bf16_f32 v225, v226, v227
v_fma_f32 v230, v230, s60, -v29
v_fma_f32 v231, v231, s60, -v29
v_exp_f32 v230, v230
v_exp_f32 v231, v231
v_add_f32 v30, v30, v228
v_add_f32 v30, v30, v229
v_cvt_pk_bf16_f32 v226, v228, v229
ds_read_b64_tr_b16 v[60:61], v21
ds_read_b64_tr_b16 v[62:63], v25 offset:3072
v_mfma_f32_32x32x16_bf16 a[48:63], v[68:71], v[212:215], a[48:63]
v_fma_f32 v232, v232, s60, -v29
v_fma_f32 v233, v233, s60, -v29
v_exp_f32 v232, v232
v_exp_f32 v233, v233
v_add_f32 v30, v30, v230
v_add_f32 v30, v30, v231
v_cvt_pk_bf16_f32 v227, v230, v231
v_fma_f32 v234, v234, s60, -v29
v_fma_f32 v235, v235, s60, -v29
v_exp_f32 v234, v234
v_exp_f32 v235, v235
ds_read_b64_tr_b16 v[64:65], v20 offset:128
ds_read_b64_tr_b16 v[66:67], v24 offset:3200
v_mfma_f32_32x32x16_bf16 a[64:79], v[72:75], v[212:215], a[64:79]
v_add_f32 v30, v30, v232
v_add_f32 v30, v30, v233
v_cvt_pk_bf16_f32 v228, v232, v233
v_fma_f32 v236, v236, s60, -v29
v_fma_f32 v237, v237, s60, -v29
v_exp_f32 v236, v236
v_exp_f32 v237, v237
v_add_f32 v30, v30, v234
v_add_f32 v30, v30, v235
v_cvt_pk_bf16_f32 v229, v234, v235
ds_read_b64_tr_b16 v[68:69], v22
ds_read_b64_tr_b16 v[70:71], v26 offset:3072
s_waitcnt lgkmcnt(8)
v_mfma_f32_32x32x16_bf16 a[80:95], v[76:79], v[212:215], a[80:95]
v_fma_f32 v238, v238, s60, -v29
v_fma_f32 v239, v239, s60, -v29
v_exp_f32 v238, v238
v_exp_f32 v239, v239
v_add_f32 v30, v30, v236
v_add_f32 v30, v30, v237
v_cvt_pk_bf16_f32 v230, v236, v237
v_add_f32 v30, v30, v238
v_add_f32 v30, v30, v239
v_cvt_pk_bf16_f32 v231, v238, v239
s_waitcnt vmcnt(6)
s_barrier
ds_read_b64_tr_b16 v[72:73], v23
ds_read_b64_tr_b16 v[74:75], v27 offset:3072
s_waitcnt lgkmcnt(8)
v_mfma_f32_32x32x16_bf16 a[0:15], v[56:59], v[224:227], a[0:15]
s_add_u32 s61, s67, 1
s_and_b32 s61, s61, 7
s_mul_i32 s61, s61, 24576
s_add_u32 s61, s61, s83
s_add_u32 s61, s61, 196608
s_add_u32 m0, s83, 73728
s_nop 0
buffer_load_dwordx4 v1, s[20:23], s61 offen nt lds
buffer_load_dwordx4 v2, s[20:23], s61 offen offset:1024 nt lds
ds_read_b64_tr_b16 v[76:77], v22 offset:128
ds_read_b64_tr_b16 v[78:79], v26 offset:3200
s_waitcnt lgkmcnt(8)
v_mfma_f32_32x32x16_bf16 a[16:31], v[60:63], v[224:227], a[16:31]
buffer_load_dwordx4 v3, s[20:23], s61 offen offset:2048 nt lds
buffer_load_dwordx4 v4, s[20:23], s61 offen offset:3072 nt lds
ds_read_b64_tr_b16 v[56:57], v20 offset:6144
ds_read_b64_tr_b16 v[58:59], v24 offset:9216
s_waitcnt lgkmcnt(8)
v_mfma_f32_32x32x16_bf16 a[32:47], v[64:67], v[224:227], a[32:47]
s_add_u32 m0, s83, 77824
s_nop 0
buffer_load_dwordx4 v5, s[20:23], s61 offen nt lds
buffer_load_dwordx4 v6, s[20:23], s61 offen offset:1024 nt lds
ds_read_b64_tr_b16 v[60:61], v21 offset:6144
ds_read_b64_tr_b16 v[62:63], v25 offset:9216
s_waitcnt lgkmcnt(8)
v_mfma_f32_32x32x16_bf16 a[48:63], v[68:71], v[224:227], a[48:63]
v_fma_f32 v240, v240, s60, -v29
v_fma_f32 v241, v241, s60, -v29
v_exp_f32 v240, v240
v_exp_f32 v241, v241
v_fma_f32 v242, v242, s60, -v29
v_fma_f32 v243, v243, s60, -v29
v_exp_f32 v242, v242
v_exp_f32 v243, v243
ds_read_b64_tr_b16 v[64:65], v20 offset:6272
ds_read_b64_tr_b16 v[66:67], v24 offset:9344
s_waitcnt lgkmcnt(8)
v_mfma_f32_32x32x16_bf16 a[64:79], v[72:75], v[224:227], a[64:79]
v_add_f32 v30, v30, v240
v_add_f32 v30, v30, v241
v_cvt_pk_bf16_f32 v240, v240, v241
v_fma_f32 v244, v244, s60, -v29
v_fma_f32 v245, v245, s60, -v29
v_exp_f32 v244, v244
v_exp_f32 v245, v245
ds_read_b64_tr_b16 v[68:69], v22 offset:6144
ds_read_b64_tr_b16 v[70:71], v26 offset:9216
s_waitcnt lgkmcnt(8)
v_mfma_f32_32x32x16_bf16 a[80:95], v[76:79], v[224:227], a[80:95]
v_add_f32 v30, v30, v242
v_add_f32 v30, v30, v243
v_cvt_pk_bf16_f32 v241, v242, v243
v_fma_f32 v246, v246, s60, -v29
v_fma_f32 v247, v247, s60, -v29
v_exp_f32 v246, v246
v_exp_f32 v247, v247
ds_read_b64_tr_b16 v[72:73], v23 offset:6144
ds_read_b64_tr_b16 v[74:75], v27 offset:9216
s_waitcnt lgkmcnt(8)
v_mfma_f32_32x32x16_bf16 a[0:15], v[56:59], v[228:231], a[0:15]
v_add_f32 v30, v30, v244
v_add_f32 v30, v30, v245
v_cvt_pk_bf16_f32 v242, v244, v245
v_fma_f32 v248, v248, s60, -v29
v_fma_f32 v249, v249, s60, -v29
v_exp_f32 v248, v248
v_exp_f32 v249, v249
ds_read_b64_tr_b16 v[76:77], v22 offset:6272
ds_read_b64_tr_b16 v[78:79], v26 offset:9344
s_waitcnt lgkmcnt(8)
v_mfma_f32_32x32x16_bf16 a[16:31], v[60:63], v[228:231], a[16:31]
v_add_f32 v30, v30, v246
v_add_f32 v30, v30, v247
v_cvt_pk_bf16_f32 v243, v246, v247
v_fma_f32 v250, v250, s60, -v29
v_fma_f32 v251, v251, s60, -v29
v_exp_f32 v250, v250
v_exp_f32 v251, v251
v_add_u32 v20, 122880, v16
v_xad_u32 v21, v20, 64, s74
v_xad_u32 v22, v20, 64, s75
v_add_u32 v23, s81, v20
v_xor_b32 v24, 16, v20
v_xor_b32 v25, 16, v21
v_xor_b32 v26, 16, v22
v_xor_b32 v27, 16, v23
ds_read_b64_tr_b16 v[56:57], v20
ds_read_b64_tr_b16 v[58:59], v24 offset:3072
s_waitcnt lgkmcnt(8)
v_mfma_f32_32x32x16_bf16 a[32:47], v[64:67], v[228:231], a[32:47]
v_add_f32 v30, v30, v248
v_add_f32 v30, v30, v249
v_cvt_pk_bf16_f32 v244, v248, v249
v_fma_f32 v252, v252, s60, -v29
v_fma_f32 v253, v253, s60, -v29
v_exp_f32 v252, v252
v_exp_f32 v253, v253
ds_read_b64_tr_b16 v[60:61], v21
ds_read_b64_tr_b16 v[62:63], v25 offset:3072
s_waitcnt lgkmcnt(8)
v_mfma_f32_32x32x16_bf16 a[48:63], v[68:71], v[228:231], a[48:63]
v_add_f32 v30, v30, v250
v_add_f32 v30, v30, v251
v_cvt_pk_bf16_f32 v245, v250, v251
v_fma_f32 v254, v254, s60, -v29
v_fma_f32 v255, v255, s60, -v29
v_exp_f32 v254, v254
v_exp_f32 v255, v255
ds_read_b64_tr_b16 v[64:65], v20 offset:128
ds_read_b64_tr_b16 v[66:67], v24 offset:3200
s_waitcnt lgkmcnt(8)
v_mfma_f32_32x32x16_bf16 a[64:79], v[72:75], v[228:231], a[64:79]
v_add_f32 v30, v30, v252
v_add_f32 v30, v30, v253
v_cvt_pk_bf16_f32 v246, v252, v253
v_add_f32 v30, v30, v254
v_add_f32 v30, v30, v255
v_cvt_pk_bf16_f32 v247, v254, v255
ds_read_b64_tr_b16 v[68:69], v22
ds_read_b64_tr_b16 v[70:71], v26 offset:3072
s_waitcnt lgkmcnt(8)
v_mfma_f32_32x32x16_bf16 a[80:95], v[76:79], v[228:231], a[80:95]
v_mov_b32 v32, v30
v_mov_b32 v33, v30
s_nop 1
v_permlane32_swap_b32 v32, v33
v_add_f32 v30, v32, v33
v_lshrrev_b32 v34, 2, v48
s_lshl_b32 s72, s58, 8
s_add_u32 s72, s72, 161792
v_add_u32 v34, s72, v34
ds_write_b32 v34, v30
s_waitcnt lgkmcnt(0)
s_waitcnt vmcnt(6)
s_barrier
ds_read_b64_tr_b16 v[72:73], v23
ds_read_b64_tr_b16 v[74:75], v27 offset:3072
v_mfma_f32_32x32x16_bf16 a[0:15], v[56:59], v[240:243], a[0:15]
s_add_u32 s61, s67, 2
s_and_b32 s61, s61, 7
s_mul_i32 s61, s61, 24576
s_add_u32 s61, s61, s83
s_add_u32 s61, s61, 196608
s_add_u32 m0, s83, 98304
s_nop 0
buffer_load_dwordx4 v1, s[20:23], s61 offen nt lds
ds_read_b64_tr_b16 v[76:77], v22 offset:128
ds_read_b64_tr_b16 v[78:79], v26 offset:3200
v_mfma_f32_32x32x16_bf16 a[16:31], v[60:63], v[240:243], a[16:31]
buffer_load_dwordx4 v2, s[20:23], s61 offen offset:1024 nt lds
ds_read_b64_tr_b16 v[56:57], v20 offset:6144
ds_read_b64_tr_b16 v[58:59], v24 offset:9216
v_mfma_f32_32x32x16_bf16 a[32:47], v[64:67], v[240:243], a[32:47]
buffer_load_dwordx4 v3, s[20:23], s61 offen offset:2048 nt lds
ds_read_b64_tr_b16 v[60:61], v21 offset:6144
ds_read_b64_tr_b16 v[62:63], v25 offset:9216
v_mfma_f32_32x32x16_bf16 a[48:63], v[68:71], v[240:243], a[48:63]
buffer_load_dwordx4 v4, s[20:23], s61 offen offset:3072 nt lds
ds_read_b64_tr_b16 v[64:65], v20 offset:6272
ds_read_b64_tr_b16 v[66:67], v24 offset:9344
s_waitcnt lgkmcnt(8)
v_mfma_f32_32x32x16_bf16 a[64:79], v[72:75], v[240:243], a[64:79]
s_add_u32 m0, s83, 102400
s_nop 0
buffer_load_dwordx4 v5, s[20:23], s61 offen nt lds
ds_read_b64_tr_b16 v[68:69], v22 offset:6144
ds_read_b64_tr_b16 v[70:71], v26 offset:9216
s_waitcnt lgkmcnt(8)
v_mfma_f32_32x32x16_bf16 a[80:95], v[76:79], v[240:243], a[80:95]
buffer_load_dwordx4 v6, s[20:23], s61 offen offset:1024 nt lds
ds_read_b64_tr_b16 v[72:73], v23 offset:6144
ds_read_b64_tr_b16 v[74:75], v27 offset:9216
s_waitcnt lgkmcnt(8)
v_mfma_f32_32x32x16_bf16 a[0:15], v[56:59], v[244:247], a[0:15]
ds_read_b64_tr_b16 v[76:77], v22 offset:6272
ds_read_b64_tr_b16 v[78:79], v26 offset:9344
s_waitcnt lgkmcnt(8)
v_mfma_f32_32x32x16_bf16 a[16:31], v[60:63], v[244:247], a[16:31]
v_add_u32 v20, 49152, v15
v_xor_b32 v21, 32, v20
v_xor_b32 v22, 64, v20
v_xor_b32 v23, 96, v20
ds_read_b128 v[56:59], v20
s_waitcnt lgkmcnt(7)
v_mfma_f32_32x32x16_bf16 a[32:47], v[64:67], v[244:247], a[32:47]
ds_read_b128 v[60:63], v21
s_waitcnt lgkmcnt(6)
v_mfma_f32_32x32x16_bf16 a[48:63], v[68:71], v[244:247], a[48:63]
ds_read_b128 v[64:67], v22
s_waitcnt lgkmcnt(5)
v_mfma_f32_32x32x16_bf16 a[64:79], v[72:75], v[244:247], a[64:79]
ds_read_b128 v[68:71], v23
s_waitcnt lgkmcnt(4)
v_mfma_f32_32x32x16_bf16 a[80:95], v[76:79], v[244:247], a[80:95]
s_waitcnt vmcnt(6)
s_barrier
ds_read_b128 v[72:75], v20 offset:128
s_waitcnt lgkmcnt(4)
v_mfma_f32_32x32x16_bf16 v[128:143], v[56:59], v[80:83], 0
s_add_u32 s61, s59, 0
s_cmp_ge_u32 s61, 10
s_cselect_b32 s73, 10, 0
s_sub_u32 s61, s61, s73
s_lshl_b32 s61, s61, 7
s_add_u32 s61, s61, s88
s_add_u32 m0, s83, 122880
s_nop 0
buffer_load_dwordx4 v13, s[32:35], s61 offen lds
buffer_load_dwordx4 v14, s[32:35], s61 offen offset:1024 lds
ds_read_b128 v[76:79], v21 offset:128
s_waitcnt lgkmcnt(4)
v_mfma_f32_32x32x16_bf16 v[128:143], v[60:63], v[84:87], v[128:143]
s_add_u32 s72, s61, 18432
buffer_load_dwordx4 v13, s[32:35], s72 offen offset:2048 lds
s_add_u32 s72, s61, 18432
buffer_load_dwordx4 v14, s[32:35], s72 offen offset:3072 lds
ds_read_b128 v[56:59], v22 offset:128
s_waitcnt lgkmcnt(4)
v_mfma_f32_32x32x16_bf16 v[128:143], v[64:67], v[88:91], v[128:143]
s_add_u32 m0, s83, 126976
s_add_u32 s72, s61, 40960
buffer_load_dwordx4 v13, s[32:35], s72 offen lds
ds_read_b128 v[60:63], v23 offset:128
s_waitcnt lgkmcnt(4)
v_mfma_f32_32x32x16_bf16 v[128:143], v[68:71], v[92:95], v[128:143]
s_add_u32 s72, s61, 40960
buffer_load_dwordx4 v14, s[32:35], s72 offen offset:1024 lds
v_add_u32 v44, 0, v51
ds_read_b128 v[64:67], v20 offset:256
s_waitcnt lgkmcnt(4)
v_mfma_f32_32x32x16_bf16 v[128:143], v[72:75], v[96:99], v[128:143]
ds_write_b128 v44, a[48:51]
ds_write_b128 v44, a[52:55] offset:1024
ds_read_b128 v[68:71], v21 offset:256
s_waitcnt lgkmcnt(6)
v_mfma_f32_32x32x16_bf16 v[128:143], v[76:79], v[100:103], v[128:143]
ds_write_b128 v44, a[56:59] offset:2048
ds_read_b128 v[72:75], v22 offset:256
s_waitcnt lgkmcnt(7)
v_mfma_f32_32x32x16_bf16 v[128:143], v[56:59], v[104:107], v[128:143]
ds_write_b128 v44, a[60:63] offset:3072
ds_write_b128 v44, a[64:67] offset:4096
ds_read_b128 v[76:79], v23 offset:256
s_waitcnt lgkmcnt(9)
v_mfma_f32_32x32x16_bf16 v[128:143], v[60:63], v[108:111], v[128:143]
ds_write_b128 v44, a[68:71] offset:5120
ds_write_b128 v44, a[72:75] offset:6144
v_add_u32 v20, 73728, v15
v_xor_b32 v21, 32, v20
v_xor_b32 v22, 64, v20
v_xor_b32 v23, 96, v20
ds_read_b128 v[56:59], v20
s_waitcnt lgkmcnt(11)
v_mfma_f32_32x32x16_bf16 v[128:143], v[64:67], v[112:115], v[128:143]
ds_write_b128 v44, a[76:79] offset:7168
ds_read_b128 v[60:63], v21
s_waitcnt lgkmcnt(10)
v_mfma_f32_32x32x16_bf16 v[128:143], v[68:71], v[116:119], v[128:143]
ds_write_b128 v44, a[80:83] offset:8192
ds_write_b128 v44, a[84:87] offset:9216
ds_read_b128 v[64:67], v22
s_waitcnt lgkmcnt(11)
v_mfma_f32_32x32x16_bf16 v[128:143], v[72:75], v[120:123], v[128:143]
ds_write_b128 v44, a[88:91] offset:10240
ds_write_b128 v44, a[92:95] offset:11264
ds_read_b128 v[68:71], v23
s_waitcnt lgkmcnt(11)
v_mfma_f32_32x32x16_bf16 v[128:143], v[76:79], v[124:127], v[128:143]
s_waitcnt lgkmcnt(0)
s_waitcnt vmcnt(6)
s_barrier
ds_read_b128 v[72:75], v20 offset:128
v_mfma_f32_32x32x16_bf16 v[144:159], v[56:59], v[80:83], 0
s_add_u32 s61, s67, 3
s_and_b32 s61, s61, 7
s_mul_i32 s61, s61, 24576
s_add_u32 s61, s61, s83
s_add_u32 s61, s61, 196608
s_add_u32 m0, s83, 49152
s_nop 0
buffer_load_dwordx4 v1, s[20:23], s61 offen nt lds
buffer_load_dwordx4 v2, s[20:23], s61 offen offset:1024 nt lds
ds_read_b128 v[76:79], v21 offset:128
v_mfma_f32_32x32x16_bf16 v[144:159], v[60:63], v[84:87], v[144:159]
buffer_load_dwordx4 v3, s[20:23], s61 offen offset:2048 nt lds
buffer_load_dwordx4 v4, s[20:23], s61 offen offset:3072 nt lds
ds_read_b128 v[56:59], v22 offset:128
v_mfma_f32_32x32x16_bf16 v[144:159], v[64:67], v[88:91], v[144:159]
s_add_u32 m0, s83, 53248
s_nop 0
buffer_load_dwordx4 v5, s[20:23], s61 offen nt lds
buffer_load_dwordx4 v6, s[20:23], s61 offen offset:1024 nt lds
ds_read_b128 v[60:63], v23 offset:128
v_mfma_f32_32x32x16_bf16 v[144:159], v[68:71], v[92:95], v[144:159]
v_max3_f32 v28, v128, v129, v130
v_max3_f32 v28, v28, v131, v132
ds_read_b128 v[64:67], v20 offset:256
s_waitcnt lgkmcnt(4)
v_mfma_f32_32x32x16_bf16 v[144:159], v[72:75], v[96:99], v[144:159]
v_max3_f32 v28, v28, v133, v134
v_max3_f32 v28, v28, v135, v136
ds_read_b128 v[68:71], v21 offset:256
s_waitcnt lgkmcnt(4)
v_mfma_f32_32x32x16_bf16 v[144:159], v[76:79], v[100:103], v[144:159]
v_max3_f32 v28, v28, v137, v138
ds_read_b128 v[72:75], v22 offset:256
s_waitcnt lgkmcnt(4)
v_mfma_f32_32x32x16_bf16 v[144:159], v[56:59], v[104:107], v[144:159]
v_max3_f32 v28, v28, v139, v140
v_max3_f32 v28, v28, v141, v142
ds_read_b128 v[76:79], v23 offset:256
s_waitcnt lgkmcnt(4)
v_mfma_f32_32x32x16_bf16 v[144:159], v[60:63], v[108:111], v[144:159]
v_max_f32 v28, v28, v143
v_add_u32 v44, 0, v55
v_lshrrev_b32 v45, 2, v48
s_lshl_b32 s72, s58, 8
s_xor_b32 s72, s72, 512
s_add_u32 s72, s72, 161792
v_add_u32 v45, s72, v45
ds_read_b32 v46, v45
ds_read_b128 v[192:195], v44
ds_read_b128 v[196:199], v44 offset:1024
ds_read_b128 v[200:203], v44 offset:2048
ds_read_b128 v[204:207], v44 offset:3072
ds_read_b128 v[208:211], v44 offset:4096
ds_read_b128 v[212:215], v44 offset:5120
ds_read_b128 v[216:219], v44 offset:6144
ds_read_b128 v[220:223], v44 offset:7168
ds_read_b128 v[224:227], v44 offset:8192
ds_read_b128 v[228:231], v44 offset:9216
ds_read_b128 v[232:235], v44 offset:10240
ds_read_b128 v[236:239], v44 offset:11264
s_waitcnt lgkmcnt(0)
v_add_f32 v31, v30, v46
v_rcp_f32 v31, v31
v_add_u32 v20, 98304, v15
v_xor_b32 v21, 32, v20
v_xor_b32 v22, 64, v20
v_xor_b32 v23, 96, v20
ds_read_b128 v[56:59], v20
v_mfma_f32_32x32x16_bf16 v[144:159], v[64:67], v[112:115], v[144:159]
v_accvgpr_read_b32 v32, a0
v_accvgpr_read_b32 v33, a1
v_accvgpr_read_b32 v34, a2
v_accvgpr_read_b32 v35, a3
v_accvgpr_read_b32 v36, a4
v_accvgpr_read_b32 v37, a5
v_accvgpr_read_b32 v38, a6
v_accvgpr_read_b32 v39, a7
v_pk_add_f32 v[32:33], v[32:33], v[192:193]
v_pk_add_f32 v[34:35], v[34:35], v[194:195]
v_pk_add_f32 v[36:37], v[36:37], v[196:197]
v_pk_add_f32 v[38:39], v[38:39], v[198:199]
v_pk_mul_f32 v[32:33], v[32:33], v[30:31] op_sel:[0,1] op_sel_hi:[1,1]
v_pk_mul_f32 v[34:35], v[34:35], v[30:31] op_sel:[0,1] op_sel_hi:[1,1]
v_pk_mul_f32 v[36:37], v[36:37], v[30:31] op_sel:[0,1] op_sel_hi:[1,1]
v_pk_mul_f32 v[38:39], v[38:39], v[30:31] op_sel:[0,1] op_sel_hi:[1,1]
v_cvt_pk_bf16_f32 v40, v32, v33
v_cvt_pk_bf16_f32 v41, v34, v35
v_cvt_pk_bf16_f32 v42, v36, v37
v_cvt_pk_bf16_f32 v43, v38, v39
ds_write_b128 v44, v[40:43]
v_accvgpr_read_b32 v32, a8
v_accvgpr_read_b32 v33, a9
v_accvgpr_read_b32 v34, a10
v_accvgpr_read_b32 v35, a11
v_accvgpr_read_b32 v36, a12
v_accvgpr_read_b32 v37, a13
v_accvgpr_read_b32 v38, a14
v_accvgpr_read_b32 v39, a15
v_pk_add_f32 v[32:33], v[32:33], v[200:201]
v_pk_add_f32 v[34:35], v[34:35], v[202:203]
v_pk_add_f32 v[36:37], v[36:37], v[204:205]
v_pk_add_f32 v[38:39], v[38:39], v[206:207]
v_pk_mul_f32 v[32:33], v[32:33], v[30:31] op_sel:[0,1] op_sel_hi:[1,1]
v_pk_mul_f32 v[34:35], v[34:35], v[30:31] op_sel:[0,1] op_sel_hi:[1,1]
v_pk_mul_f32 v[36:37], v[36:37], v[30:31] op_sel:[0,1] op_sel_hi:[1,1]
v_pk_mul_f32 v[38:39], v[38:39], v[30:31] op_sel:[0,1] op_sel_hi:[1,1]
v_cvt_pk_bf16_f32 v40, v32, v33
v_cvt_pk_bf16_f32 v41, v34, v35
v_cvt_pk_bf16_f32 v42, v36, v37
v_cvt_pk_bf16_f32 v43, v38, v39
ds_write_b128 v44, v[40:43] offset:1024
ds_read_b128 v[60:63], v21
v_mfma_f32_32x32x16_bf16 v[144:159], v[68:71], v[116:119], v[144:159]
v_accvgpr_read_b32 v32, a16
v_accvgpr_read_b32 v33, a17
v_accvgpr_read_b32 v34, a18
v_accvgpr_read_b32 v35, a19
v_accvgpr_read_b32 v36, a20
v_accvgpr_read_b32 v37, a21
v_accvgpr_read_b32 v38, a22
v_accvgpr_read_b32 v39, a23
v_pk_add_f32 v[32:33], v[32:33], v[208:209]
v_pk_add_f32 v[34:35], v[34:35], v[210:211]
v_pk_add_f32 v[36:37], v[36:37], v[212:213]
v_pk_add_f32 v[38:39], v[38:39], v[214:215]
v_pk_mul_f32 v[32:33], v[32:33], v[30:31] op_sel:[0,1] op_sel_hi:[1,1]
v_pk_mul_f32 v[34:35], v[34:35], v[30:31] op_sel:[0,1] op_sel_hi:[1,1]
v_pk_mul_f32 v[36:37], v[36:37], v[30:31] op_sel:[0,1] op_sel_hi:[1,1]
v_pk_mul_f32 v[38:39], v[38:39], v[30:31] op_sel:[0,1] op_sel_hi:[1,1]
v_cvt_pk_bf16_f32 v40, v32, v33
v_cvt_pk_bf16_f32 v41, v34, v35
v_cvt_pk_bf16_f32 v42, v36, v37
v_cvt_pk_bf16_f32 v43, v38, v39
ds_write_b128 v44, v[40:43] offset:2048
v_accvgpr_read_b32 v32, a24
v_accvgpr_read_b32 v33, a25
v_accvgpr_read_b32 v34, a26
v_accvgpr_read_b32 v35, a27
v_accvgpr_read_b32 v36, a28
v_accvgpr_read_b32 v37, a29
v_accvgpr_read_b32 v38, a30
v_accvgpr_read_b32 v39, a31
v_pk_add_f32 v[32:33], v[32:33], v[216:217]
v_pk_add_f32 v[34:35], v[34:35], v[218:219]
v_pk_add_f32 v[36:37], v[36:37], v[220:221]
v_pk_add_f32 v[38:39], v[38:39], v[222:223]
v_pk_mul_f32 v[32:33], v[32:33], v[30:31] op_sel:[0,1] op_sel_hi:[1,1]
v_pk_mul_f32 v[34:35], v[34:35], v[30:31] op_sel:[0,1] op_sel_hi:[1,1]
v_pk_mul_f32 v[36:37], v[36:37], v[30:31] op_sel:[0,1] op_sel_hi:[1,1]
v_pk_mul_f32 v[38:39], v[38:39], v[30:31] op_sel:[0,1] op_sel_hi:[1,1]
v_cvt_pk_bf16_f32 v40, v32, v33
v_cvt_pk_bf16_f32 v41, v34, v35
v_cvt_pk_bf16_f32 v42, v36, v37
v_cvt_pk_bf16_f32 v43, v38, v39
ds_write_b128 v44, v[40:43] offset:3072
ds_read_b128 v[64:67], v22
v_mfma_f32_32x32x16_bf16 v[144:159], v[72:75], v[120:123], v[144:159]
v_accvgpr_read_b32 v32, a32
v_accvgpr_read_b32 v33, a33
v_accvgpr_read_b32 v34, a34
v_accvgpr_read_b32 v35, a35
v_accvgpr_read_b32 v36, a36
v_accvgpr_read_b32 v37, a37
v_accvgpr_read_b32 v38, a38
v_accvgpr_read_b32 v39, a39
v_pk_add_f32 v[32:33], v[32:33], v[224:225]
v_pk_add_f32 v[34:35], v[34:35], v[226:227]
v_pk_add_f32 v[36:37], v[36:37], v[228:229]
v_pk_add_f32 v[38:39], v[38:39], v[230:231]
v_pk_mul_f32 v[32:33], v[32:33], v[30:31] op_sel:[0,1] op_sel_hi:[1,1]
v_pk_mul_f32 v[34:35], v[34:35], v[30:31] op_sel:[0,1] op_sel_hi:[1,1]
v_pk_mul_f32 v[36:37], v[36:37], v[30:31] op_sel:[0,1] op_sel_hi:[1,1]
v_pk_mul_f32 v[38:39], v[38:39], v[30:31] op_sel:[0,1] op_sel_hi:[1,1]
v_cvt_pk_bf16_f32 v40, v32, v33
v_cvt_pk_bf16_f32 v41, v34, v35
v_cvt_pk_bf16_f32 v42, v36, v37
v_cvt_pk_bf16_f32 v43, v38, v39
ds_write_b128 v44, v[40:43] offset:4096
v_accvgpr_read_b32 v32, a40
v_accvgpr_read_b32 v33, a41
v_accvgpr_read_b32 v34, a42
v_accvgpr_read_b32 v35, a43
v_accvgpr_read_b32 v36, a44
v_accvgpr_read_b32 v37, a45
v_accvgpr_read_b32 v38, a46
v_accvgpr_read_b32 v39, a47
v_pk_add_f32 v[32:33], v[32:33], v[232:233]
v_pk_add_f32 v[34:35], v[34:35], v[234:235]
v_pk_add_f32 v[36:37], v[36:37], v[236:237]
v_pk_add_f32 v[38:39], v[38:39], v[238:239]
v_pk_mul_f32 v[32:33], v[32:33], v[30:31] op_sel:[0,1] op_sel_hi:[1,1]
v_pk_mul_f32 v[34:35], v[34:35], v[30:31] op_sel:[0,1] op_sel_hi:[1,1]
v_pk_mul_f32 v[36:37], v[36:37], v[30:31] op_sel:[0,1] op_sel_hi:[1,1]
v_pk_mul_f32 v[38:39], v[38:39], v[30:31] op_sel:[0,1] op_sel_hi:[1,1]
v_cvt_pk_bf16_f32 v40, v32, v33
v_cvt_pk_bf16_f32 v41, v34, v35
v_cvt_pk_bf16_f32 v42, v36, v37
v_cvt_pk_bf16_f32 v43, v38, v39
ds_write_b128 v44, v[40:43] offset:5120
ds_read_b128 v[68:71], v23
v_mfma_f32_32x32x16_bf16 v[144:159], v[76:79], v[124:127], v[144:159]
s_waitcnt lgkmcnt(0)
s_waitcnt vmcnt(6)
s_barrier
ds_read_b128 v[72:75], v20 offset:128
v_mfma_f32_32x32x16_bf16 v[160:175], v[56:59], v[80:83], 0
s_add_u32 s61, s59, 1
s_cmp_ge_u32 s61, 10
s_cselect_b32 s73, 10, 0
s_sub_u32 s61, s61, s73
s_lshl_b32 s61, s61, 7
s_add_u32 s61, s61, s88
s_add_u32 m0, s83, 73728
s_nop 0
buffer_load_dwordx4 v13, s[32:35], s61 offen lds
buffer_load_dwordx4 v14, s[32:35], s61 offen offset:1024 lds
s_add_u32 s72, s61, 18432
buffer_load_dwordx4 v13, s[32:35], s72 offen offset:2048 lds
ds_read_b128 v[76:79], v21 offset:128
v_mfma_f32_32x32x16_bf16 v[160:175], v[60:63], v[84:87], v[160:175]
s_add_u32 s72, s61, 18432
buffer_load_dwordx4 v14, s[32:35], s72 offen offset:3072 lds
s_add_u32 m0, s83, 77824
s_add_u32 s72, s61, 40960
buffer_load_dwordx4 v13, s[32:35], s72 offen lds
ds_read_b128 v[56:59], v22 offset:128
v_mfma_f32_32x32x16_bf16 v[160:175], v[64:67], v[88:91], v[160:175]
s_add_u32 s72, s61, 40960
buffer_load_dwordx4 v14, s[32:35], s72 offen offset:1024 lds
v_max3_f32 v28, v28, v144, v145
ds_read_b128 v[60:63], v23 offset:128
v_mfma_f32_32x32x16_bf16 v[160:175], v[68:71], v[92:95], v[160:175]
v_max3_f32 v28, v28, v146, v147
v_max3_f32 v28, v28, v148, v149
v_max3_f32 v28, v28, v150, v151
ds_read_b128 v[64:67], v20 offset:256
s_waitcnt lgkmcnt(4)
v_mfma_f32_32x32x16_bf16 v[160:175], v[72:75], v[96:99], v[160:175]
v_max3_f32 v28, v28, v152, v153
v_max3_f32 v28, v28, v154, v155
ds_read_b128 v[68:71], v21 offset:256
s_waitcnt lgkmcnt(4)
v_mfma_f32_32x32x16_bf16 v[160:175], v[76:79], v[100:103], v[160:175]
v_max3_f32 v28, v28, v156, v157
v_max3_f32 v28, v28, v158, v159
ds_read_b128 v[72:75], v22 offset:256
s_waitcnt lgkmcnt(4)
v_mfma_f32_32x32x16_bf16 v[160:175], v[56:59], v[104:107], v[160:175]
v_add_u32 v44, 0, v50
ds_read_b128 a[160:163], v44 offset:24576
ds_read_b128 a[164:167], v44 offset:25600
ds_read_b128 v[76:79], v23 offset:256
s_waitcnt lgkmcnt(6)
v_mfma_f32_32x32x16_bf16 v[160:175], v[60:63], v[108:111], v[160:175]
ds_read_b128 a[168:171], v44 offset:26624
ds_read_b128 a[172:175], v44 offset:27648
v_add_u32 v20, 122880, v19
v_xor_b32 v21, 16, v20
ds_read_b64_tr_b16 v[56:57], v20
ds_read_b64_tr_b16 v[58:59], v21 offset:1024
s_waitcnt lgkmcnt(9)
v_mfma_f32_32x32x16_bf16 v[160:175], v[64:67], v[112:115], v[160:175]
ds_read_b128 a[176:179], v44 offset:28672
ds_read_b128 a[180:183], v44 offset:29696
ds_read_b64_tr_b16 v[60:61], v20 offset:2048
ds_read_b64_tr_b16 v[62:63], v21 offset:3072
s_waitcnt lgkmcnt(12)
v_mfma_f32_32x32x16_bf16 v[160:175], v[68:71], v[116:119], v[160:175]
ds_read_b128 a[184:187], v44
ds_read_b128 a[188:191], v44 offset:1024
ds_read_b128 a[192:195], v44 offset:2048
ds_read_b64_tr_b16 v[64:65], v20 offset:4096
ds_read_b64_tr_b16 v[66:67], v21 offset:5120
s_waitcnt lgkmcnt(15)
v_mfma_f32_32x32x16_bf16 v[160:175], v[72:75], v[120:123], v[160:175]
ds_read_b128 a[196:199], v44 offset:3072
ds_read_b128 a[200:203], v44 offset:4096
ds_read_b64_tr_b16 v[68:69], v20 offset:6144
ds_read_b64_tr_b16 v[70:71], v21 offset:7168
s_waitcnt lgkmcnt(15)
v_mfma_f32_32x32x16_bf16 v[160:175], v[76:79], v[124:127], v[160:175]
ds_read_b128 a[204:207], v44 offset:5120
s_waitcnt lgkmcnt(0)
s_waitcnt vmcnt(6)
s_barrier
ds_read_b64_tr_b16 v[72:73], v20 offset:8192
ds_read_b64_tr_b16 v[74:75], v21 offset:9216
v_mfma_f32_32x32x16_bf16 a[0:15], v[56:59], a[160:163], 0
s_add_u32 s61, s67, 4
s_and_b32 s61, s61, 7
s_mul_i32 s61, s61, 24576
s_add_u32 s61, s61, s83
s_add_u32 s61, s61, 196608
s_add_u32 m0, s83, 0
s_nop 0
buffer_load_dwordx4 v1, s[20:23], s61 offen nt lds
buffer_load_dwordx4 v2, s[20:23], s61 offen offset:1024 nt lds
buffer_load_dwordx4 v3, s[20:23], s61 offen offset:2048 nt lds
ds_read_b64_tr_b16 v[76:77], v20 offset:10240
ds_read_b64_tr_b16 v[78:79], v21 offset:11264
v_mfma_f32_32x32x16_bf16 a[0:15], v[60:63], a[164:167], a[0:15]
buffer_load_dwordx4 v4, s[20:23], s61 offen offset:3072 nt lds
s_add_u32 m0, s83, 4096
s_nop 0
buffer_load_dwordx4 v5, s[20:23], s61 offen nt lds
buffer_load_dwordx4 v6, s[20:23], s61 offen offset:1024 nt lds
ds_read_b64_tr_b16 v[56:57], v20 offset:12288
ds_read_b64_tr_b16 v[58:59], v21 offset:13312
v_mfma_f32_32x32x16_bf16 a[0:15], v[64:67], a[168:171], a[0:15]
s_add_u32 s61, s59, 2
s_cmp_ge_u32 s61, 10
s_cselect_b32 s73, 10, 0
s_sub_u32 s61, s61, s73
s_lshl_b32 s61, s61, 7
s_add_u32 s61, s61, s88
s_add_u32 m0, s83, 24576
s_nop 0
buffer_load_dwordx4 v13, s[32:35], s61 offen lds
buffer_load_dwordx4 v14, s[32:35], s61 offen offset:1024 lds
ds_read_b64_tr_b16 v[60:61], v20 offset:14336
ds_read_b64_tr_b16 v[62:63], v21 offset:15360
v_mfma_f32_32x32x16_bf16 a[0:15], v[68:71], a[172:175], a[0:15]
s_add_u32 s72, s61, 18432
buffer_load_dwordx4 v13, s[32:35], s72 offen offset:2048 lds
s_add_u32 s72, s61, 18432
buffer_load_dwordx4 v14, s[32:35], s72 offen offset:3072 lds
s_add_u32 m0, s83, 28672
s_add_u32 s72, s61, 40960
buffer_load_dwordx4 v13, s[32:35], s72 offen lds
ds_read_b64_tr_b16 v[64:65], v20 offset:16384
ds_read_b64_tr_b16 v[66:67], v21 offset:17408
s_waitcnt lgkmcnt(8)
v_mfma_f32_32x32x16_bf16 a[0:15], v[72:75], a[176:179], a[0:15]
s_add_u32 s72, s61, 40960
buffer_load_dwordx4 v14, s[32:35], s72 offen offset:1024 lds
s_add_u32 s61, s67, 5
s_and_b32 s61, s61, 7
s_mul_i32 s61, s61, 24576
s_add_u32 s61, s61, s83
s_add_u32 s61, s61, 196608
s_add_u32 m0, s83, 98304
s_nop 0
buffer_load_dwordx4 v1, s[20:23], s61 offen nt lds
ds_read_b64_tr_b16 v[68:69], v20 offset:18432
ds_read_b64_tr_b16 v[70:71], v21 offset:19456
s_waitcnt lgkmcnt(8)
v_mfma_f32_32x32x16_bf16 a[0:15], v[76:79], a[180:183], a[0:15]
buffer_load_dwordx4 v2, s[20:23], s61 offen offset:1024 nt lds
buffer_load_dwordx4 v3, s[20:23], s61 offen offset:2048 nt lds
buffer_load_dwordx4 v4, s[20:23], s61 offen offset:3072 nt lds
ds_read_b64_tr_b16 v[72:73], v20 offset:20480
ds_read_b64_tr_b16 v[74:75], v21 offset:21504
s_waitcnt lgkmcnt(8)
v_mfma_f32_32x32x16_bf16 a[0:15], v[56:59], a[184:187], a[0:15]
s_add_u32 m0, s83, 102400
s_nop 0
buffer_load_dwordx4 v5, s[20:23], s61 offen nt lds
buffer_load_dwordx4 v6, s[20:23], s61 offen offset:1024 nt lds
ds_read_b64_tr_b16 v[76:77], v20 offset:22528
ds_read_b64_tr_b16 v[78:79], v21 offset:23552
s_waitcnt lgkmcnt(8)
v_mfma_f32_32x32x16_bf16 a[0:15], v[60:63], a[188:191], a[0:15]
v_add_u32 v20, 49152, v15
v_xor_b32 v21, 32, v20
v_xor_b32 v22, 64, v20
v_xor_b32 v23, 96, v20
ds_read_b128 v[56:59], v20
s_waitcnt lgkmcnt(7)
v_mfma_f32_32x32x16_bf16 a[0:15], v[64:67], a[192:195], a[0:15]
v_max3_f32 v28, v28, v160, v161
v_max3_f32 v28, v28, v162, v163
ds_read_b128 v[60:63], v21
s_waitcnt lgkmcnt(6)
v_mfma_f32_32x32x16_bf16 a[0:15], v[68:71], a[196:199], a[0:15]
v_max3_f32 v28, v28, v164, v165
v_max3_f32 v28, v28, v166, v167
ds_read_b128 v[64:67], v22
s_waitcnt lgkmcnt(5)
v_mfma_f32_32x32x16_bf16 a[0:15], v[72:75], a[200:203], a[0:15]
v_max3_f32 v28, v28, v168, v169
v_max3_f32 v28, v28, v170, v171
ds_read_b128 v[68:71], v23
s_waitcnt lgkmcnt(4)
v_mfma_f32_32x32x16_bf16 a[0:15], v[76:79], a[204:207], a[0:15]
v_max3_f32 v28, v28, v172, v173
v_max3_f32 v28, v28, v174, v175
s_waitcnt vmcnt(18)
s_barrier
ds_read_b128 v[72:75], v20 offset:128
s_waitcnt lgkmcnt(4)
v_mfma_f32_32x32x16_bf16 v[176:191], v[56:59], v[80:83], 0
s_add_u32 s61, s59, 3
s_cmp_ge_u32 s61, 10
s_cselect_b32 s73, 10, 0
s_sub_u32 s61, s61, s73
s_lshl_b32 s61, s61, 7
s_add_u32 s61, s61, s88
s_add_u32 m0, s83, 122880
s_nop 0
buffer_load_dwordx4 v13, s[32:35], s61 offen lds
ds_read_b128 v[76:79], v21 offset:128
s_waitcnt lgkmcnt(4)
v_mfma_f32_32x32x16_bf16 v[176:191], v[60:63], v[84:87], v[176:191]
buffer_load_dwordx4 v14, s[32:35], s61 offen offset:1024 lds
ds_read_b128 v[56:59], v22 offset:128
s_waitcnt lgkmcnt(4)
v_mfma_f32_32x32x16_bf16 v[176:191], v[64:67], v[88:91], v[176:191]
s_add_u32 s72, s61, 18432
buffer_load_dwordx4 v13, s[32:35], s72 offen offset:2048 lds
ds_read_b128 v[60:63], v23 offset:128
s_waitcnt lgkmcnt(4)
v_mfma_f32_32x32x16_bf16 v[176:191], v[68:71], v[92:95], v[176:191]
s_add_u32 s72, s61, 18432
buffer_load_dwordx4 v14, s[32:35], s72 offen offset:3072 lds
ds_read_b128 v[64:67], v20 offset:256
s_waitcnt lgkmcnt(4)
v_mfma_f32_32x32x16_bf16 v[176:191], v[72:75], v[96:99], v[176:191]
s_add_u32 m0, s83, 126976
s_add_u32 s72, s61, 40960
buffer_load_dwordx4 v13, s[32:35], s72 offen lds
ds_read_b128 v[68:71], v21 offset:256
s_waitcnt lgkmcnt(4)
v_mfma_f32_32x32x16_bf16 v[176:191], v[76:79], v[100:103], v[176:191]
s_add_u32 s72, s61, 40960
buffer_load_dwordx4 v14, s[32:35], s72 offen offset:1024 lds
ds_read_b128 v[72:75], v22 offset:256
s_waitcnt lgkmcnt(4)
v_mfma_f32_32x32x16_bf16 v[176:191], v[56:59], v[104:107], v[176:191]
ds_read_b128 v[76:79], v23 offset:256
s_waitcnt lgkmcnt(4)
v_mfma_f32_32x32x16_bf16 v[176:191], v[60:63], v[108:111], v[176:191]
v_add_u32 v20, 73728, v19
v_xor_b32 v21, 16, v20
ds_read_b64_tr_b16 v[56:57], v20
ds_read_b64_tr_b16 v[58:59], v21 offset:1024
s_waitcnt lgkmcnt(5)
v_mfma_f32_32x32x16_bf16 v[176:191], v[64:67], v[112:115], v[176:191]
ds_read_b64_tr_b16 v[60:61], v20 offset:2048
ds_read_b64_tr_b16 v[62:63], v21 offset:3072
s_waitcnt lgkmcnt(6)
v_mfma_f32_32x32x16_bf16 v[176:191], v[68:71], v[116:119], v[176:191]
ds_read_b64_tr_b16 v[64:65], v20 offset:4096
ds_read_b64_tr_b16 v[66:67], v21 offset:5120
s_waitcnt lgkmcnt(7)
v_mfma_f32_32x32x16_bf16 v[176:191], v[72:75], v[120:123], v[176:191]
ds_read_b64_tr_b16 v[68:69], v20 offset:6144
ds_read_b64_tr_b16 v[70:71], v21 offset:7168
s_waitcnt lgkmcnt(8)
v_mfma_f32_32x32x16_bf16 v[176:191], v[76:79], v[124:127], v[176:191]
s_waitcnt vmcnt(18)
s_barrier
ds_read_b64_tr_b16 v[72:73], v20 offset:8192
ds_read_b64_tr_b16 v[74:75], v21 offset:9216
s_waitcnt lgkmcnt(8)
v_mfma_f32_32x32x16_bf16 a[16:31], v[56:59], a[160:163], 0
s_add_u32 s61, s67, 6
s_and_b32 s61, s61, 7
s_mul_i32 s61, s61, 24576
s_add_u32 s61, s61, s83
s_add_u32 s61, s61, 196608
s_add_u32 m0, s83, 49152
s_nop 0
buffer_load_dwordx4 v1, s[20:23], s61 offen nt lds
buffer_load_dwordx4 v2, s[20:23], s61 offen offset:1024 nt lds
ds_read_b64_tr_b16 v[76:77], v20 offset:10240
ds_read_b64_tr_b16 v[78:79], v21 offset:11264
s_waitcnt lgkmcnt(8)
v_mfma_f32_32x32x16_bf16 a[16:31], v[60:63], a[164:167], a[16:31]
buffer_load_dwordx4 v3, s[20:23], s61 offen offset:2048 nt lds
ds_read_b64_tr_b16 v[56:57], v20 offset:12288
ds_read_b64_tr_b16 v[58:59], v21 offset:13312
s_waitcnt lgkmcnt(8)
v_mfma_f32_32x32x16_bf16 a[16:31], v[64:67], a[168:171], a[16:31]
buffer_load_dwordx4 v4, s[20:23], s61 offen offset:3072 nt lds
ds_read_b64_tr_b16 v[60:61], v20 offset:14336
ds_read_b64_tr_b16 v[62:63], v21 offset:15360
s_waitcnt lgkmcnt(8)
v_mfma_f32_32x32x16_bf16 a[16:31], v[68:71], a[172:175], a[16:31]
s_add_u32 m0, s83, 53248
s_nop 0
buffer_load_dwordx4 v5, s[20:23], s61 offen nt lds
ds_read_b64_tr_b16 v[64:65], v20 offset:16384
ds_read_b64_tr_b16 v[66:67], v21 offset:17408
s_waitcnt lgkmcnt(8)
v_mfma_f32_32x32x16_bf16 a[16:31], v[72:75], a[176:179], a[16:31]
buffer_load_dwordx4 v6, s[20:23], s61 offen offset:1024 nt lds
ds_read_b64_tr_b16 v[68:69], v20 offset:18432
ds_read_b64_tr_b16 v[70:71], v21 offset:19456
s_waitcnt lgkmcnt(8)
v_mfma_f32_32x32x16_bf16 a[16:31], v[76:79], a[180:183], a[16:31]
v_max3_f32 v28, v28, v176, v177
ds_read_b64_tr_b16 v[72:73], v20 offset:20480
ds_read_b64_tr_b16 v[74:75], v21 offset:21504
s_waitcnt lgkmcnt(8)
v_mfma_f32_32x32x16_bf16 a[16:31], v[56:59], a[184:187], a[16:31]
v_max3_f32 v28, v28, v178, v179
v_max3_f32 v28, v28, v180, v181
ds_read_b64_tr_b16 v[76:77], v20 offset:22528
ds_read_b64_tr_b16 v[78:79], v21 offset:23552
s_waitcnt lgkmcnt(8)
v_mfma_f32_32x32x16_bf16 a[16:31], v[60:63], a[188:191], a[16:31]
v_max3_f32 v28, v28, v182, v183
v_add_u32 v20, 0, v15
v_xor_b32 v21, 32, v20
v_xor_b32 v22, 64, v20
v_xor_b32 v23, 96, v20
ds_read_b128 v[56:59], v20
s_waitcnt lgkmcnt(7)
v_mfma_f32_32x32x16_bf16 a[16:31], v[64:67], a[192:195], a[16:31]
v_max3_f32 v28, v28, v184, v185
ds_read_b128 v[60:63], v21
s_waitcnt lgkmcnt(6)
v_mfma_f32_32x32x16_bf16 a[16:31], v[68:71], a[196:199], a[16:31]
v_max3_f32 v28, v28, v186, v187
ds_read_b128 v[64:67], v22
s_waitcnt lgkmcnt(5)
v_mfma_f32_32x32x16_bf16 a[16:31], v[72:75], a[200:203], a[16:31]
v_max3_f32 v28, v28, v188, v189
ds_read_b128 v[68:71], v23
s_waitcnt lgkmcnt(4)
v_mfma_f32_32x32x16_bf16 a[16:31], v[76:79], a[204:207], a[16:31]
v_max3_f32 v28, v28, v190, v191
s_waitcnt vmcnt(18)
s_barrier
ds_read_b128 v[72:75], v20 offset:128
s_waitcnt lgkmcnt(4)
v_mfma_f32_32x32x16_bf16 v[192:207], v[56:59], v[80:83], 0
s_add_u32 s61, s67, 7
s_and_b32 s61, s61, 7
s_mul_i32 s61, s61, 24576
s_add_u32 s61, s61, s83
s_add_u32 s61, s61, 196608
s_add_u32 m0, s83, 73728
s_nop 0
buffer_load_dwordx4 v1, s[20:23], s61 offen nt lds
ds_read_b128 v[76:79], v21 offset:128
s_waitcnt lgkmcnt(4)
v_mfma_f32_32x32x16_bf16 v[192:207], v[60:63], v[84:87], v[192:207]
buffer_load_dwordx4 v2, s[20:23], s61 offen offset:1024 nt lds
ds_read_b128 v[56:59], v22 offset:128
s_waitcnt lgkmcnt(4)
v_mfma_f32_32x32x16_bf16 v[192:207], v[64:67], v[88:91], v[192:207]
buffer_load_dwordx4 v3, s[20:23], s61 offen offset:2048 nt lds
ds_read_b128 v[60:63], v23 offset:128
s_waitcnt lgkmcnt(4)
v_mfma_f32_32x32x16_bf16 v[192:207], v[68:71], v[92:95], v[192:207]
buffer_load_dwordx4 v4, s[20:23], s61 offen offset:3072 nt lds
ds_read_b128 v[64:67], v20 offset:256
s_waitcnt lgkmcnt(4)
v_mfma_f32_32x32x16_bf16 v[192:207], v[72:75], v[96:99], v[192:207]
s_add_u32 m0, s83, 77824
s_nop 0
buffer_load_dwordx4 v5, s[20:23], s61 offen nt lds
ds_read_b128 v[68:71], v21 offset:256
s_waitcnt lgkmcnt(4)
v_mfma_f32_32x32x16_bf16 v[192:207], v[76:79], v[100:103], v[192:207]
buffer_load_dwordx4 v6, s[20:23], s61 offen offset:1024 nt lds
ds_read_b128 v[72:75], v22 offset:256
s_waitcnt lgkmcnt(4)
v_mfma_f32_32x32x16_bf16 v[192:207], v[56:59], v[104:107], v[192:207]
ds_read_b128 v[76:79], v23 offset:256
s_waitcnt lgkmcnt(4)
v_mfma_f32_32x32x16_bf16 v[192:207], v[60:63], v[108:111], v[192:207]
v_add_u32 v20, 24576, v19
v_xor_b32 v21, 16, v20
ds_read_b64_tr_b16 v[56:57], v20
ds_read_b64_tr_b16 v[58:59], v21 offset:1024
s_waitcnt lgkmcnt(5)
v_mfma_f32_32x32x16_bf16 v[192:207], v[64:67], v[112:115], v[192:207]
ds_read_b64_tr_b16 v[60:61], v20 offset:2048
ds_read_b64_tr_b16 v[62:63], v21 offset:3072
s_waitcnt lgkmcnt(6)
v_mfma_f32_32x32x16_bf16 v[192:207], v[68:71], v[116:119], v[192:207]
ds_read_b64_tr_b16 v[64:65], v20 offset:4096
ds_read_b64_tr_b16 v[66:67], v21 offset:5120
s_waitcnt lgkmcnt(7)
v_mfma_f32_32x32x16_bf16 v[192:207], v[72:75], v[120:123], v[192:207]
ds_read_b64_tr_b16 v[68:69], v20 offset:6144
ds_read_b64_tr_b16 v[70:71], v21 offset:7168
s_waitcnt lgkmcnt(8)
v_mfma_f32_32x32x16_bf16 v[192:207], v[76:79], v[124:127], v[192:207]
s_waitcnt vmcnt(18)
s_barrier
ds_read_b64_tr_b16 v[72:73], v20 offset:8192
ds_read_b64_tr_b16 v[74:75], v21 offset:9216
s_waitcnt lgkmcnt(8)
v_mfma_f32_32x32x16_bf16 a[32:47], v[56:59], a[160:163], 0
s_add_u32 s61, s59, 4
s_cmp_ge_u32 s61, 10
s_cselect_b32 s73, 10, 0
s_sub_u32 s61, s61, s73
s_lshl_b32 s61, s61, 7
s_add_u32 s61, s61, s88
s_add_u32 m0, s83, 0
s_nop 0
buffer_load_dwordx4 v13, s[32:35], s61 offen lds
buffer_load_dwordx4 v14, s[32:35], s61 offen offset:1024 lds
ds_read_b64_tr_b16 v[76:77], v20 offset:10240
ds_read_b64_tr_b16 v[78:79], v21 offset:11264
s_waitcnt lgkmcnt(8)
v_mfma_f32_32x32x16_bf16 a[32:47], v[60:63], a[164:167], a[32:47]
s_add_u32 s72, s61, 18432
buffer_load_dwordx4 v13, s[32:35], s72 offen offset:2048 lds
ds_read_b64_tr_b16 v[56:57], v20 offset:12288
ds_read_b64_tr_b16 v[58:59], v21 offset:13312
s_waitcnt lgkmcnt(8)
v_mfma_f32_32x32x16_bf16 a[32:47], v[64:67], a[168:171], a[32:47]
s_add_u32 s72, s61, 18432
buffer_load_dwordx4 v14, s[32:35], s72 offen offset:3072 lds
ds_read_b64_tr_b16 v[60:61], v20 offset:14336
ds_read_b64_tr_b16 v[62:63], v21 offset:15360
s_waitcnt lgkmcnt(8)
v_mfma_f32_32x32x16_bf16 a[32:47], v[68:71], a[172:175], a[32:47]
s_add_u32 m0, s83, 4096
s_add_u32 s72, s61, 40960
buffer_load_dwordx4 v13, s[32:35], s72 offen lds
ds_read_b64_tr_b16 v[64:65], v20 offset:16384
ds_read_b64_tr_b16 v[66:67], v21 offset:17408
s_waitcnt lgkmcnt(8)
v_mfma_f32_32x32x16_bf16 a[32:47], v[72:75], a[176:179], a[32:47]
s_add_u32 s72, s61, 40960
buffer_load_dwordx4 v14, s[32:35], s72 offen offset:1024 lds
ds_read_b64_tr_b16 v[68:69], v20 offset:18432
ds_read_b64_tr_b16 v[70:71], v21 offset:19456
s_waitcnt lgkmcnt(8)
v_mfma_f32_32x32x16_bf16 a[32:47], v[76:79], a[180:183], a[32:47]
v_max3_f32 v28, v28, v192, v193
ds_read_b64_tr_b16 v[72:73], v20 offset:20480
ds_read_b64_tr_b16 v[74:75], v21 offset:21504
s_waitcnt lgkmcnt(8)
v_mfma_f32_32x32x16_bf16 a[32:47], v[56:59], a[184:187], a[32:47]
v_max3_f32 v28, v28, v194, v195
v_max3_f32 v28, v28, v196, v197
ds_read_b64_tr_b16 v[76:77], v20 offset:22528
ds_read_b64_tr_b16 v[78:79], v21 offset:23552
s_waitcnt lgkmcnt(8)
v_mfma_f32_32x32x16_bf16 a[32:47], v[60:63], a[188:191], a[32:47]
v_max3_f32 v28, v28, v198, v199
v_add_u32 v20, 98304, v15
v_xor_b32 v21, 32, v20
v_xor_b32 v22, 64, v20
v_xor_b32 v23, 96, v20
ds_read_b128 v[56:59], v20
s_waitcnt lgkmcnt(7)
v_mfma_f32_32x32x16_bf16 a[32:47], v[64:67], a[192:195], a[32:47]
v_max3_f32 v28, v28, v200, v201
ds_read_b128 v[60:63], v21
s_waitcnt lgkmcnt(6)
v_mfma_f32_32x32x16_bf16 a[32:47], v[68:71], a[196:199], a[32:47]
v_max3_f32 v28, v28, v202, v203
ds_read_b128 v[64:67], v22
s_waitcnt lgkmcnt(5)
v_mfma_f32_32x32x16_bf16 a[32:47], v[72:75], a[200:203], a[32:47]
v_max3_f32 v28, v28, v204, v205
ds_read_b128 v[68:71], v23
s_waitcnt lgkmcnt(4)
v_mfma_f32_32x32x16_bf16 a[32:47], v[76:79], a[204:207], a[32:47]
v_max3_f32 v28, v28, v206, v207
s_waitcnt vmcnt(18)
s_barrier
ds_read_b128 v[72:75], v20 offset:128
s_waitcnt lgkmcnt(4)
v_mfma_f32_32x32x16_bf16 v[208:223], v[56:59], v[80:83], 0
s_add_u32 s61, s67, 0
s_and_b32 s61, s61, 7
s_mul_i32 s61, s61, 24576
s_add_u32 s61, s61, s83
s_add_u32 s61, s61, 196608
s_add_u32 m0, s83, 24576
s_nop 0
buffer_load_dwordx4 v1, s[24:27], s61 offen nt lds
ds_read_b128 v[76:79], v21 offset:128
s_waitcnt lgkmcnt(4)
v_mfma_f32_32x32x16_bf16 v[208:223], v[60:63], v[84:87], v[208:223]
buffer_load_dwordx4 v2, s[24:27], s61 offen offset:1024 nt lds
ds_read_b128 v[56:59], v22 offset:128
s_waitcnt lgkmcnt(4)
v_mfma_f32_32x32x16_bf16 v[208:223], v[64:67], v[88:91], v[208:223]
buffer_load_dwordx4 v3, s[24:27], s61 offen offset:2048 nt lds
ds_read_b128 v[60:63], v23 offset:128
s_waitcnt lgkmcnt(4)
v_mfma_f32_32x32x16_bf16 v[208:223], v[68:71], v[92:95], v[208:223]
buffer_load_dwordx4 v4, s[24:27], s61 offen offset:3072 nt lds
ds_read_b128 v[64:67], v20 offset:256
s_waitcnt lgkmcnt(4)
v_mfma_f32_32x32x16_bf16 v[208:223], v[72:75], v[96:99], v[208:223]
s_add_u32 m0, s83, 28672
s_nop 0
buffer_load_dwordx4 v5, s[24:27], s61 offen nt lds
ds_read_b128 v[68:71], v21 offset:256
s_waitcnt lgkmcnt(4)
v_mfma_f32_32x32x16_bf16 v[208:223], v[76:79], v[100:103], v[208:223]
buffer_load_dwordx4 v6, s[24:27], s61 offen offset:1024 nt lds
ds_read_b128 v[72:75], v22 offset:256
s_waitcnt lgkmcnt(4)
v_mfma_f32_32x32x16_bf16 v[208:223], v[56:59], v[104:107], v[208:223]
ds_read_b128 v[76:79], v23 offset:256
s_waitcnt lgkmcnt(4)
v_mfma_f32_32x32x16_bf16 v[208:223], v[60:63], v[108:111], v[208:223]
v_add_u32 v20, 122880, v19
v_xor_b32 v21, 16, v20
ds_read_b64_tr_b16 v[56:57], v20
ds_read_b64_tr_b16 v[58:59], v21 offset:1024
s_waitcnt lgkmcnt(5)
v_mfma_f32_32x32x16_bf16 v[208:223], v[64:67], v[112:115], v[208:223]
ds_read_b64_tr_b16 v[60:61], v20 offset:2048
ds_read_b64_tr_b16 v[62:63], v21 offset:3072
s_waitcnt lgkmcnt(6)
v_mfma_f32_32x32x16_bf16 v[208:223], v[68:71], v[116:119], v[208:223]
ds_read_b64_tr_b16 v[64:65], v20 offset:4096
ds_read_b64_tr_b16 v[66:67], v21 offset:5120
s_waitcnt lgkmcnt(7)
v_mfma_f32_32x32x16_bf16 v[208:223], v[72:75], v[120:123], v[208:223]
ds_read_b64_tr_b16 v[68:69], v20 offset:6144
ds_read_b64_tr_b16 v[70:71], v21 offset:7168
s_waitcnt lgkmcnt(8)
v_mfma_f32_32x32x16_bf16 v[208:223], v[76:79], v[124:127], v[208:223]
s_waitcnt vmcnt(18)
s_barrier
ds_read_b64_tr_b16 v[72:73], v20 offset:8192
ds_read_b64_tr_b16 v[74:75], v21 offset:9216
s_waitcnt lgkmcnt(8)
v_mfma_f32_32x32x16_bf16 a[48:63], v[56:59], a[160:163], 0
s_nop 5
v_max3_f32 v28, v28, v208, v209
ds_read_b64_tr_b16 v[76:77], v20 offset:10240
ds_read_b64_tr_b16 v[78:79], v21 offset:11264
s_waitcnt lgkmcnt(8)
v_mfma_f32_32x32x16_bf16 a[48:63], v[60:63], a[164:167], a[48:63]
v_max3_f32 v28, v28, v210, v211
ds_read_b64_tr_b16 v[56:57], v20 offset:12288
ds_read_b64_tr_b16 v[58:59], v21 offset:13312
s_waitcnt lgkmcnt(8)
v_mfma_f32_32x32x16_bf16 a[48:63], v[64:67], a[168:171], a[48:63]
ds_read_b64_tr_b16 v[60:61], v20 offset:14336
ds_read_b64_tr_b16 v[62:63], v21 offset:15360
s_waitcnt lgkmcnt(8)
v_mfma_f32_32x32x16_bf16 a[48:63], v[68:71], a[172:175], a[48:63]
v_max3_f32 v28, v28, v212, v213
ds_read_b64_tr_b16 v[64:65], v20 offset:16384
ds_read_b64_tr_b16 v[66:67], v21 offset:17408
s_waitcnt lgkmcnt(8)
v_mfma_f32_32x32x16_bf16 a[48:63], v[72:75], a[176:179], a[48:63]
v_max3_f32 v28, v28, v214, v215
ds_read_b64_tr_b16 v[68:69], v20 offset:18432
ds_read_b64_tr_b16 v[70:71], v21 offset:19456
s_waitcnt lgkmcnt(8)
v_mfma_f32_32x32x16_bf16 a[48:63], v[76:79], a[180:183], a[48:63]
ds_read_b64_tr_b16 v[72:73], v20 offset:20480
ds_read_b64_tr_b16 v[74:75], v21 offset:21504
s_waitcnt lgkmcnt(8)
v_mfma_f32_32x32x16_bf16 a[48:63], v[56:59], a[184:187], a[48:63]
v_max3_f32 v28, v28, v216, v217
ds_read_b64_tr_b16 v[76:77], v20 offset:22528
ds_read_b64_tr_b16 v[78:79], v21 offset:23552
s_waitcnt lgkmcnt(8)
v_mfma_f32_32x32x16_bf16 a[48:63], v[60:63], a[188:191], a[48:63]
v_max3_f32 v28, v28, v218, v219
v_add_u32 v20, 49152, v15
v_xor_b32 v21, 32, v20
v_xor_b32 v22, 64, v20
v_xor_b32 v23, 96, v20
ds_read_b128 v[56:59], v20
s_waitcnt lgkmcnt(7)
v_mfma_f32_32x32x16_bf16 a[48:63], v[64:67], a[192:195], a[48:63]
ds_read_b128 v[60:63], v21
s_waitcnt lgkmcnt(6)
v_mfma_f32_32x32x16_bf16 a[48:63], v[68:71], a[196:199], a[48:63]
v_max3_f32 v28, v28, v220, v221
ds_read_b128 v[64:67], v22
s_waitcnt lgkmcnt(5)
v_mfma_f32_32x32x16_bf16 a[48:63], v[72:75], a[200:203], a[48:63]
v_max3_f32 v28, v28, v222, v223
ds_read_b128 v[68:71], v23
s_waitcnt lgkmcnt(4)
v_mfma_f32_32x32x16_bf16 a[48:63], v[76:79], a[204:207], a[48:63]
s_waitcnt vmcnt(12)
s_barrier
ds_read_b128 v[72:75], v20 offset:128
s_waitcnt lgkmcnt(4)
v_mfma_f32_32x32x16_bf16 v[224:239], v[56:59], v[80:83], 0
s_add_u32 s61, s59, 5
s_cmp_ge_u32 s61, 10
s_cselect_b32 s73, 10, 0
s_sub_u32 s61, s61, s73
s_lshl_b32 s61, s61, 7
s_add_u32 s61, s61, s88
s_add_u32 m0, s83, 98304
s_nop 0
buffer_load_dwordx4 v13, s[32:35], s61 offen lds
buffer_load_dwordx4 v14, s[32:35], s61 offen offset:1024 lds
ds_read_b128 v[76:79], v21 offset:128
s_waitcnt lgkmcnt(4)
v_mfma_f32_32x32x16_bf16 v[224:239], v[60:63], v[84:87], v[224:239]
s_add_u32 s72, s61, 18432
buffer_load_dwordx4 v13, s[32:35], s72 offen offset:2048 lds
s_add_u32 s72, s61, 18432
buffer_load_dwordx4 v14, s[32:35], s72 offen offset:3072 lds
ds_read_b128 v[56:59], v22 offset:128
s_waitcnt lgkmcnt(4)
v_mfma_f32_32x32x16_bf16 v[224:239], v[64:67], v[88:91], v[224:239]
s_add_u32 m0, s83, 102400
s_add_u32 s72, s61, 40960
buffer_load_dwordx4 v13, s[32:35], s72 offen lds
s_add_u32 s72, s61, 40960
buffer_load_dwordx4 v14, s[32:35], s72 offen offset:1024 lds
ds_read_b128 v[60:63], v23 offset:128
s_waitcnt lgkmcnt(4)
v_mfma_f32_32x32x16_bf16 v[224:239], v[68:71], v[92:95], v[224:239]
s_add_u32 s61, s67, 1
s_and_b32 s61, s61, 7
s_mul_i32 s61, s61, 24576
s_add_u32 s61, s61, s83
s_add_u32 s61, s61, 196608
s_add_u32 m0, s83, 122880
s_nop 0
buffer_load_dwordx4 v1, s[24:27], s61 offen nt lds
ds_read_b128 v[64:67], v20 offset:256
s_waitcnt lgkmcnt(4)
v_mfma_f32_32x32x16_bf16 v[224:239], v[72:75], v[96:99], v[224:239]
buffer_load_dwordx4 v2, s[24:27], s61 offen offset:1024 nt lds
buffer_load_dwordx4 v3, s[24:27], s61 offen offset:2048 nt lds
ds_read_b128 v[68:71], v21 offset:256
s_waitcnt lgkmcnt(4)
v_mfma_f32_32x32x16_bf16 v[224:239], v[76:79], v[100:103], v[224:239]
buffer_load_dwordx4 v4, s[24:27], s61 offen offset:3072 nt lds
s_add_u32 m0, s83, 126976
s_nop 0
buffer_load_dwordx4 v5, s[24:27], s61 offen nt lds
ds_read_b128 v[72:75], v22 offset:256
s_waitcnt lgkmcnt(4)
v_mfma_f32_32x32x16_bf16 v[224:239], v[56:59], v[104:107], v[224:239]
buffer_load_dwordx4 v6, s[24:27], s61 offen offset:1024 nt lds
ds_read_b128 v[76:79], v23 offset:256
s_waitcnt lgkmcnt(4)
v_mfma_f32_32x32x16_bf16 v[224:239], v[60:63], v[108:111], v[224:239]
v_add_u32 v20, 73728, v15
v_xor_b32 v21, 32, v20
v_xor_b32 v22, 64, v20
v_xor_b32 v23, 96, v20
ds_read_b128 v[56:59], v20
s_waitcnt lgkmcnt(4)
v_mfma_f32_32x32x16_bf16 v[224:239], v[64:67], v[112:115], v[224:239]
ds_read_b128 v[60:63], v21
s_waitcnt lgkmcnt(4)
v_mfma_f32_32x32x16_bf16 v[224:239], v[68:71], v[116:119], v[224:239]
ds_read_b128 v[64:67], v22
s_waitcnt lgkmcnt(4)
v_mfma_f32_32x32x16_bf16 v[224:239], v[72:75], v[120:123], v[224:239]
ds_read_b128 v[68:71], v23
s_waitcnt lgkmcnt(4)
v_mfma_f32_32x32x16_bf16 v[224:239], v[76:79], v[124:127], v[224:239]
s_waitcnt vmcnt(18)
s_barrier
ds_read_b128 v[72:75], v20 offset:128
s_waitcnt lgkmcnt(4)
v_mfma_f32_32x32x16_bf16 v[240:255], v[56:59], v[80:83], 0
s_nop 6
v_max3_f32 v28, v28, v224, v225
ds_read_b128 v[76:79], v21 offset:128
s_waitcnt lgkmcnt(4)
v_mfma_f32_32x32x16_bf16 v[240:255], v[60:63], v[84:87], v[240:255]
v_max3_f32 v28, v28, v226, v227
ds_read_b128 v[56:59], v22 offset:128
s_waitcnt lgkmcnt(4)
v_mfma_f32_32x32x16_bf16 v[240:255], v[64:67], v[88:91], v[240:255]
ds_read_b128 v[60:63], v23 offset:128
s_waitcnt lgkmcnt(4)
v_mfma_f32_32x32x16_bf16 v[240:255], v[68:71], v[92:95], v[240:255]
v_max3_f32 v28, v28, v228, v229
ds_read_b128 v[64:67], v20 offset:256
s_waitcnt lgkmcnt(4)
v_mfma_f32_32x32x16_bf16 v[240:255], v[72:75], v[96:99], v[240:255]
v_max3_f32 v28, v28, v230, v231
ds_read_b128 v[68:71], v21 offset:256
s_waitcnt lgkmcnt(4)
v_mfma_f32_32x32x16_bf16 v[240:255], v[76:79], v[100:103], v[240:255]
ds_read_b128 v[72:75], v22 offset:256
s_waitcnt lgkmcnt(4)
v_mfma_f32_32x32x16_bf16 v[240:255], v[56:59], v[104:107], v[240:255]
v_max3_f32 v28, v28, v232, v233
ds_read_b128 v[76:79], v23 offset:256
s_waitcnt lgkmcnt(4)
v_mfma_f32_32x32x16_bf16 v[240:255], v[60:63], v[108:111], v[240:255]
v_max3_f32 v28, v28, v234, v235
v_add_u32 v20, 0, v19
v_xor_b32 v21, 16, v20
ds_read_b64_tr_b16 v[56:57], v20
ds_read_b64_tr_b16 v[58:59], v21 offset:1024
s_waitcnt lgkmcnt(5)
v_mfma_f32_32x32x16_bf16 v[240:255], v[64:67], v[112:115], v[240:255]
ds_read_b64_tr_b16 v[60:61], v20 offset:2048
ds_read_b64_tr_b16 v[62:63], v21 offset:3072
s_waitcnt lgkmcnt(6)
v_mfma_f32_32x32x16_bf16 v[240:255], v[68:71], v[116:119], v[240:255]
v_max3_f32 v28, v28, v236, v237
ds_read_b64_tr_b16 v[64:65], v20 offset:4096
ds_read_b64_tr_b16 v[66:67], v21 offset:5120
s_waitcnt lgkmcnt(7)
v_mfma_f32_32x32x16_bf16 v[240:255], v[72:75], v[120:123], v[240:255]
v_max3_f32 v28, v28, v238, v239
ds_read_b64_tr_b16 v[68:69], v20 offset:6144
ds_read_b64_tr_b16 v[70:71], v21 offset:7168
s_waitcnt lgkmcnt(8)
v_mfma_f32_32x32x16_bf16 v[240:255], v[76:79], v[124:127], v[240:255]
s_barrier
ds_read_b64_tr_b16 v[72:73], v20 offset:8192
ds_read_b64_tr_b16 v[74:75], v21 offset:9216
s_waitcnt lgkmcnt(8)
v_mfma_f32_32x32x16_bf16 a[64:79], v[56:59], a[160:163], 0
s_add_u32 s61, s59, 6
s_cmp_ge_u32 s61, 10
s_cselect_b32 s73, 10, 0
s_sub_u32 s61, s61, s73
s_lshl_b32 s61, s61, 7
s_add_u32 s61, s61, s88
s_add_u32 m0, s83, 49152
s_nop 0
buffer_load_dwordx4 v13, s[32:35], s61 offen lds
buffer_load_dwordx4 v14, s[32:35], s61 offen offset:1024 lds
ds_read_b64_tr_b16 v[76:77], v20 offset:10240
ds_read_b64_tr_b16 v[78:79], v21 offset:11264
s_waitcnt lgkmcnt(8)
v_mfma_f32_32x32x16_bf16 a[64:79], v[60:63], a[164:167], a[64:79]
s_add_u32 s72, s61, 18432
buffer_load_dwordx4 v13, s[32:35], s72 offen offset:2048 lds
s_add_u32 s72, s61, 18432
buffer_load_dwordx4 v14, s[32:35], s72 offen offset:3072 lds
ds_read_b64_tr_b16 v[56:57], v20 offset:12288
ds_read_b64_tr_b16 v[58:59], v21 offset:13312
s_waitcnt lgkmcnt(8)
v_mfma_f32_32x32x16_bf16 a[64:79], v[64:67], a[168:171], a[64:79]
s_add_u32 m0, s83, 53248
s_add_u32 s72, s61, 40960
buffer_load_dwordx4 v13, s[32:35], s72 offen lds
s_add_u32 s72, s61, 40960
buffer_load_dwordx4 v14, s[32:35], s72 offen offset:1024 lds
ds_read_b64_tr_b16 v[60:61], v20 offset:14336
ds_read_b64_tr_b16 v[62:63], v21 offset:15360
s_waitcnt lgkmcnt(8)
v_mfma_f32_32x32x16_bf16 a[64:79], v[68:71], a[172:175], a[64:79]
s_add_u32 s61, s67, 2
s_and_b32 s61, s61, 7
s_mul_i32 s61, s61, 24576
s_add_u32 s61, s61, s83
s_add_u32 s61, s61, 196608
s_add_u32 m0, s83, 73728
s_nop 0
buffer_load_dwordx4 v1, s[24:27], s61 offen nt lds
ds_read_b64_tr_b16 v[64:65], v20 offset:16384
ds_read_b64_tr_b16 v[66:67], v21 offset:17408
s_waitcnt lgkmcnt(8)
v_mfma_f32_32x32x16_bf16 a[64:79], v[72:75], a[176:179], a[64:79]
buffer_load_dwordx4 v2, s[24:27], s61 offen offset:1024 nt lds
buffer_load_dwordx4 v3, s[24:27], s61 offen offset:2048 nt lds
ds_read_b64_tr_b16 v[68:69], v20 offset:18432
ds_read_b64_tr_b16 v[70:71], v21 offset:19456
s_waitcnt lgkmcnt(8)
v_mfma_f32_32x32x16_bf16 a[64:79], v[76:79], a[180:183], a[64:79]
buffer_load_dwordx4 v4, s[24:27], s61 offen offset:3072 nt lds
s_add_u32 m0, s83, 77824
s_nop 0
buffer_load_dwordx4 v5, s[24:27], s61 offen nt lds
ds_read_b64_tr_b16 v[72:73], v20 offset:20480
ds_read_b64_tr_b16 v[74:75], v21 offset:21504
s_waitcnt lgkmcnt(8)
v_mfma_f32_32x32x16_bf16 a[64:79], v[56:59], a[184:187], a[64:79]
buffer_load_dwordx4 v6, s[24:27], s61 offen offset:1024 nt lds
v_max3_f32 v28, v28, v240, v241
ds_read_b64_tr_b16 v[76:77], v20 offset:22528
ds_read_b64_tr_b16 v[78:79], v21 offset:23552
s_waitcnt lgkmcnt(8)
v_mfma_f32_32x32x16_bf16 a[64:79], v[60:63], a[188:191], a[64:79]
v_max3_f32 v28, v28, v242, v243
s_waitcnt lgkmcnt(6)
v_mfma_f32_32x32x16_bf16 a[64:79], v[64:67], a[192:195], a[64:79]
v_max3_f32 v28, v28, v244, v245
v_max3_f32 v28, v28, v246, v247
s_waitcnt lgkmcnt(4)
v_mfma_f32_32x32x16_bf16 a[64:79], v[68:71], a[196:199], a[64:79]
v_max3_f32 v28, v28, v248, v249
v_max3_f32 v28, v28, v250, v251
s_waitcnt lgkmcnt(2)
v_mfma_f32_32x32x16_bf16 a[64:79], v[72:75], a[200:203], a[64:79]
v_max3_f32 v28, v28, v252, v253
v_max3_f32 v28, v28, v254, v255
s_waitcnt lgkmcnt(0)
v_mfma_f32_32x32x16_bf16 a[64:79], v[76:79], a[204:207], a[64:79]
v_mov_b32 v32, v28
v_mov_b32 v33, v28
s_nop 1
v_permlane32_swap_b32 v32, v33
v_max_f32 v28, v32, v33
v_lshrrev_b32 v34, 2, v48
s_lshl_b32 s72, s58, 8
s_add_u32 s72, s72, 161792
v_add_u32 v34, s72, v34
ds_write_b32 v34, v28
s_waitcnt lgkmcnt(0)
s_barrier
v_lshrrev_b32 v34, 2, v48
s_lshl_b32 s72, s58, 8
s_xor_b32 s72, s72, 512
s_add_u32 s72, s72, 161792
v_add_u32 v34, s72, v34
ds_read_b32 v35, v34
s_waitcnt lgkmcnt(0)
v_max_f32 v28, v28, v35
v_mul_f32 v29, s60, v28
v_mov_b32 v30, 0
v_accvgpr_read_b32 v80, a160
v_accvgpr_read_b32 v81, a161
v_accvgpr_read_b32 v82, a162
v_accvgpr_read_b32 v83, a163
v_accvgpr_read_b32 v84, a164
v_accvgpr_read_b32 v85, a165
v_accvgpr_read_b32 v86, a166
v_accvgpr_read_b32 v87, a167
v_accvgpr_read_b32 v88, a168
v_accvgpr_read_b32 v89, a169
v_accvgpr_read_b32 v90, a170
v_accvgpr_read_b32 v91, a171
v_accvgpr_read_b32 v92, a172
v_accvgpr_read_b32 v93, a173
v_accvgpr_read_b32 v94, a174
v_accvgpr_read_b32 v95, a175
v_accvgpr_read_b32 v96, a176
v_accvgpr_read_b32 v97, a177
v_accvgpr_read_b32 v98, a178
v_accvgpr_read_b32 v99, a179
v_accvgpr_read_b32 v100, a180
v_accvgpr_read_b32 v101, a181
v_accvgpr_read_b32 v102, a182
v_accvgpr_read_b32 v103, a183
v_accvgpr_read_b32 v104, a184
v_accvgpr_read_b32 v105, a185
v_accvgpr_read_b32 v106, a186
v_accvgpr_read_b32 v107, a187
v_accvgpr_read_b32 v108, a188
v_accvgpr_read_b32 v109, a189
v_accvgpr_read_b32 v110, a190
v_accvgpr_read_b32 v111, a191
v_accvgpr_read_b32 v112, a192
v_accvgpr_read_b32 v113, a193
v_accvgpr_read_b32 v114, a194
v_accvgpr_read_b32 v115, a195
v_accvgpr_read_b32 v116, a196
v_accvgpr_read_b32 v117, a197
v_accvgpr_read_b32 v118, a198
v_accvgpr_read_b32 v119, a199
v_accvgpr_read_b32 v120, a200
v_accvgpr_read_b32 v121, a201
v_accvgpr_read_b32 v122, a202
v_accvgpr_read_b32 v123, a203
v_accvgpr_read_b32 v124, a204
v_accvgpr_read_b32 v125, a205
v_accvgpr_read_b32 v126, a206
v_accvgpr_read_b32 v127, a207
v_fma_f32 v128, v128, s60, -v29
v_fma_f32 v129, v129, s60, -v29
v_exp_f32 v128, v128
v_exp_f32 v129, v129
v_fma_f32 v130, v130, s60, -v29
v_fma_f32 v131, v131, s60, -v29
v_exp_f32 v130, v130
v_exp_f32 v131, v131
v_add_f32 v30, v30, v128
v_add_f32 v30, v30, v129
v_cvt_pk_bf16_f32 v128, v128, v129
v_fma_f32 v132, v132, s60, -v29
v_fma_f32 v133, v133, s60, -v29
v_exp_f32 v132, v132
v_exp_f32 v133, v133
v_add_f32 v30, v30, v130
v_add_f32 v30, v30, v131
v_cvt_pk_bf16_f32 v129, v130, v131
v_fma_f32 v134, v134, s60, -v29
v_fma_f32 v135, v135, s60, -v29
v_exp_f32 v134, v134
v_exp_f32 v135, v135
v_add_f32 v30, v30, v132
v_add_f32 v30, v30, v133
v_cvt_pk_bf16_f32 v130, v132, v133
v_fma_f32 v136, v136, s60, -v29
v_fma_f32 v137, v137, s60, -v29
v_exp_f32 v136, v136
v_exp_f32 v137, v137
v_add_f32 v30, v30, v134
v_add_f32 v30, v30, v135
v_cvt_pk_bf16_f32 v131, v134, v135
v_fma_f32 v138, v138, s60, -v29
v_fma_f32 v139, v139, s60, -v29
v_exp_f32 v138, v138
v_exp_f32 v139, v139
v_add_f32 v30, v30, v136
v_add_f32 v30, v30, v137
v_cvt_pk_bf16_f32 v132, v136, v137
v_fma_f32 v140, v140, s60, -v29
v_fma_f32 v141, v141, s60, -v29
v_exp_f32 v140, v140
v_exp_f32 v141, v141
v_add_f32 v30, v30, v138
v_add_f32 v30, v30, v139
v_cvt_pk_bf16_f32 v133, v138, v139
v_fma_f32 v142, v142, s60, -v29
v_fma_f32 v143, v143, s60, -v29
v_exp_f32 v142, v142
v_exp_f32 v143, v143
v_add_f32 v30, v30, v140
v_add_f32 v30, v30, v141
v_cvt_pk_bf16_f32 v134, v140, v141
v_add_f32 v30, v30, v142
v_add_f32 v30, v30, v143
v_cvt_pk_bf16_f32 v135, v142, v143
s_waitcnt vmcnt(24)
s_waitcnt vmcnt(18)
s_barrier
v_add_u32 v20, 24576, v16
v_xad_u32 v21, v20, 64, s74
v_xad_u32 v22, v20, 64, s75
v_add_u32 v23, s81, v20
v_xor_b32 v24, 16, v20
v_xor_b32 v25, 16, v21
v_xor_b32 v26, 16, v22
v_xor_b32 v27, 16, v23
ds_read_b64_tr_b16 v[56:57], v20
ds_read_b64_tr_b16 v[58:59], v24 offset:3072
ds_read_b64_tr_b16 v[60:61], v21
ds_read_b64_tr_b16 v[62:63], v25 offset:3072
ds_read_b64_tr_b16 v[64:65], v20 offset:128
ds_read_b64_tr_b16 v[66:67], v24 offset:3200
ds_read_b64_tr_b16 v[68:69], v22
ds_read_b64_tr_b16 v[70:71], v26 offset:3072
ds_read_b64_tr_b16 v[72:73], v23
ds_read_b64_tr_b16 v[74:75], v27 offset:3072
s_waitcnt lgkmcnt(8)
v_mfma_f32_32x32x16_bf16 a[160:175], v[56:59], v[128:131], 0
s_add_u32 s61, s59, 7
s_cmp_ge_u32 s61, 10
s_cselect_b32 s73, 10, 0
s_sub_u32 s61, s61, s73
s_lshl_b32 s61, s61, 7
s_add_u32 s61, s61, s88
s_add_u32 m0, s83, 0
s_nop 0
buffer_load_dwordx4 v13, s[32:35], s61 offen lds
buffer_load_dwordx4 v14, s[32:35], s61 offen offset:1024 lds
ds_read_b64_tr_b16 v[76:77], v22 offset:128
ds_read_b64_tr_b16 v[78:79], v26 offset:3200
s_waitcnt lgkmcnt(8)
v_mfma_f32_32x32x16_bf16 a[176:191], v[60:63], v[128:131], 0
s_add_u32 s72, s61, 18432
buffer_load_dwordx4 v13, s[32:35], s72 offen offset:2048 lds
s_add_u32 s72, s61, 18432
buffer_load_dwordx4 v14, s[32:35], s72 offen offset:3072 lds
ds_read_b64_tr_b16 v[56:57], v20 offset:6144
ds_read_b64_tr_b16 v[58:59], v24 offset:9216
s_waitcnt lgkmcnt(8)
v_mfma_f32_32x32x16_bf16 a[192:207], v[64:67], v[128:131], 0
s_add_u32 m0, s83, 4096
s_add_u32 s72, s61, 40960
buffer_load_dwordx4 v13, s[32:35], s72 offen lds
s_add_u32 s72, s61, 40960
buffer_load_dwordx4 v14, s[32:35], s72 offen offset:1024 lds
ds_read_b64_tr_b16 v[60:61], v21 offset:6144
ds_read_b64_tr_b16 v[62:63], v25 offset:9216
s_waitcnt lgkmcnt(8)
v_mfma_f32_32x32x16_bf16 a[208:223], v[68:71], v[128:131], 0
v_fma_f32 v144, v144, s60, -v29
v_fma_f32 v145, v145, s60, -v29
v_exp_f32 v144, v144
v_exp_f32 v145, v145
v_fma_f32 v146, v146, s60, -v29
v_fma_f32 v147, v147, s60, -v29
v_exp_f32 v146, v146
v_exp_f32 v147, v147
ds_read_b64_tr_b16 v[64:65], v20 offset:6272
ds_read_b64_tr_b16 v[66:67], v24 offset:9344
s_waitcnt lgkmcnt(8)
v_mfma_f32_32x32x16_bf16 a[224:239], v[72:75], v[128:131], 0
v_add_f32 v30, v30, v144
v_add_f32 v30, v30, v145
v_cvt_pk_bf16_f32 v144, v144, v145
v_fma_f32 v148, v148, s60, -v29
v_fma_f32 v149, v149, s60, -v29
v_exp_f32 v148, v148
v_exp_f32 v149, v149
ds_read_b64_tr_b16 v[68:69], v22 offset:6144
ds_read_b64_tr_b16 v[70:71], v26 offset:9216
s_waitcnt lgkmcnt(8)
v_mfma_f32_32x32x16_bf16 a[240:255], v[76:79], v[128:131], 0
v_add_f32 v30, v30, v146
v_add_f32 v30, v30, v147
v_cvt_pk_bf16_f32 v145, v146, v147
ds_read_b64_tr_b16 v[72:73], v23 offset:6144
ds_read_b64_tr_b16 v[74:75], v27 offset:9216
s_waitcnt lgkmcnt(8)
v_mfma_f32_32x32x16_bf16 a[160:175], v[56:59], v[132:135], a[160:175]
v_fma_f32 v150, v150, s60, -v29
v_fma_f32 v151, v151, s60, -v29
v_exp_f32 v150, v150
v_exp_f32 v151, v151
v_add_f32 v30, v30, v148
v_add_f32 v30, v30, v149
v_cvt_pk_bf16_f32 v146, v148, v149
ds_read_b64_tr_b16 v[76:77], v22 offset:6272
ds_read_b64_tr_b16 v[78:79], v26 offset:9344
s_waitcnt lgkmcnt(8)
v_mfma_f32_32x32x16_bf16 a[176:191], v[60:63], v[132:135], a[176:191]
v_fma_f32 v152, v152, s60, -v29
v_fma_f32 v153, v153, s60, -v29
v_exp_f32 v152, v152
v_exp_f32 v153, v153
v_add_f32 v30, v30, v150
v_add_f32 v30, v30, v151
v_cvt_pk_bf16_f32 v147, v150, v151
v_add_u32 v20, 98304, v19
v_xor_b32 v21, 16, v20
ds_read_b64_tr_b16 v[56:57], v20
ds_read_b64_tr_b16 v[58:59], v21 offset:1024
s_waitcnt lgkmcnt(8)
v_mfma_f32_32x32x16_bf16 a[192:207], v[64:67], v[132:135], a[192:207]
v_fma_f32 v154, v154, s60, -v29
v_fma_f32 v155, v155, s60, -v29
v_exp_f32 v154, v154
v_exp_f32 v155, v155
v_add_f32 v30, v30, v152
v_add_f32 v30, v30, v153
v_cvt_pk_bf16_f32 v148, v152, v153
ds_read_b64_tr_b16 v[60:61], v20 offset:2048
ds_read_b64_tr_b16 v[62:63], v21 offset:3072
s_waitcnt lgkmcnt(8)
v_mfma_f32_32x32x16_bf16 a[208:223], v[68:71], v[132:135], a[208:223]
v_fma_f32 v156, v156, s60, -v29
v_fma_f32 v157, v157, s60, -v29
v_exp_f32 v156, v156
v_exp_f32 v157, v157
v_add_f32 v30, v30, v154
v_add_f32 v30, v30, v155
v_cvt_pk_bf16_f32 v149, v154, v155
ds_read_b64_tr_b16 v[64:65], v20 offset:4096
ds_read_b64_tr_b16 v[66:67], v21 offset:5120
s_waitcnt lgkmcnt(8)
v_mfma_f32_32x32x16_bf16 a[224:239], v[72:75], v[132:135], a[224:239]
v_fma_f32 v158, v158, s60, -v29
v_fma_f32 v159, v159, s60, -v29
v_exp_f32 v158, v158
v_exp_f32 v159, v159
v_add_f32 v30, v30, v156
v_add_f32 v30, v30, v157
v_cvt_pk_bf16_f32 v150, v156, v157
ds_read_b64_tr_b16 v[68:69], v20 offset:6144
ds_read_b64_tr_b16 v[70:71], v21 offset:7168
s_waitcnt lgkmcnt(8)
v_mfma_f32_32x32x16_bf16 a[240:255], v[76:79], v[132:135], a[240:255]
v_add_f32 v30, v30, v158
v_add_f32 v30, v30, v159
v_cvt_pk_bf16_f32 v151, v158, v159
s_waitcnt vmcnt(18)
s_barrier
ds_read_b64_tr_b16 v[72:73], v20 offset:8192
ds_read_b64_tr_b16 v[74:75], v21 offset:9216
s_waitcnt lgkmcnt(8)
v_mfma_f32_32x32x16_bf16 a[80:95], v[56:59], v[80:83], 0
s_add_u32 s61, s67, 3
s_and_b32 s61, s61, 7
s_mul_i32 s61, s61, 24576
s_add_u32 s61, s61, s83
s_add_u32 s61, s61, 196608
s_add_u32 m0, s83, 24576
s_nop 0
buffer_load_dwordx4 v1, s[24:27], s61 offen nt lds
ds_read_b64_tr_b16 v[76:77], v20 offset:10240
ds_read_b64_tr_b16 v[78:79], v21 offset:11264
s_waitcnt lgkmcnt(8)
v_mfma_f32_32x32x16_bf16 a[80:95], v[60:63], v[84:87], a[80:95]
buffer_load_dwordx4 v2, s[24:27], s61 offen offset:1024 nt lds
ds_read_b64_tr_b16 v[56:57], v20 offset:12288
ds_read_b64_tr_b16 v[58:59], v21 offset:13312
s_waitcnt lgkmcnt(8)
v_mfma_f32_32x32x16_bf16 a[80:95], v[64:67], v[88:91], a[80:95]
buffer_load_dwordx4 v3, s[24:27], s61 offen offset:2048 nt lds
ds_read_b64_tr_b16 v[60:61], v20 offset:14336
ds_read_b64_tr_b16 v[62:63], v21 offset:15360
s_waitcnt lgkmcnt(8)
v_mfma_f32_32x32x16_bf16 a[80:95], v[68:71], v[92:95], a[80:95]
buffer_load_dwordx4 v4, s[24:27], s61 offen offset:3072 nt lds
ds_read_b64_tr_b16 v[64:65], v20 offset:16384
ds_read_b64_tr_b16 v[66:67], v21 offset:17408
s_waitcnt lgkmcnt(8)
v_mfma_f32_32x32x16_bf16 a[80:95], v[72:75], v[96:99], a[80:95]
s_add_u32 m0, s83, 28672
s_nop 0
buffer_load_dwordx4 v5, s[24:27], s61 offen nt lds
ds_read_b64_tr_b16 v[68:69], v20 offset:18432
ds_read_b64_tr_b16 v[70:71], v21 offset:19456
s_waitcnt lgkmcnt(8)
v_mfma_f32_32x32x16_bf16 a[80:95], v[76:79], v[100:103], a[80:95]
buffer_load_dwordx4 v6, s[24:27], s61 offen offset:1024 nt lds
ds_read_b64_tr_b16 v[72:73], v20 offset:20480
ds_read_b64_tr_b16 v[74:75], v21 offset:21504
s_waitcnt lgkmcnt(8)
v_mfma_f32_32x32x16_bf16 a[80:95], v[56:59], v[104:107], a[80:95]
ds_read_b64_tr_b16 v[76:77], v20 offset:22528
ds_read_b64_tr_b16 v[78:79], v21 offset:23552
s_waitcnt lgkmcnt(8)
v_mfma_f32_32x32x16_bf16 a[80:95], v[60:63], v[108:111], a[80:95]
v_add_u32 v20, 122880, v16
v_xad_u32 v21, v20, 64, s74
v_xad_u32 v22, v20, 64, s75
v_add_u32 v23, s81, v20
v_xor_b32 v24, 16, v20
v_xor_b32 v25, 16, v21
v_xor_b32 v26, 16, v22
v_xor_b32 v27, 16, v23
ds_read_b64_tr_b16 v[56:57], v20
ds_read_b64_tr_b16 v[58:59], v24 offset:3072
s_waitcnt lgkmcnt(8)
v_mfma_f32_32x32x16_bf16 a[80:95], v[64:67], v[112:115], a[80:95]
ds_read_b64_tr_b16 v[60:61], v21
ds_read_b64_tr_b16 v[62:63], v25 offset:3072
s_waitcnt lgkmcnt(8)
v_mfma_f32_32x32x16_bf16 a[80:95], v[68:71], v[116:119], a[80:95]
ds_read_b64_tr_b16 v[64:65], v20 offset:128
ds_read_b64_tr_b16 v[66:67], v24 offset:3200
s_waitcnt lgkmcnt(8)
v_mfma_f32_32x32x16_bf16 a[80:95], v[72:75], v[120:123], a[80:95]
ds_read_b64_tr_b16 v[68:69], v22
ds_read_b64_tr_b16 v[70:71], v26 offset:3072
s_waitcnt lgkmcnt(8)
v_mfma_f32_32x32x16_bf16 a[80:95], v[76:79], v[124:127], a[80:95]
s_waitcnt vmcnt(18)
s_barrier
ds_read_b64_tr_b16 v[72:73], v23
ds_read_b64_tr_b16 v[74:75], v27 offset:3072
s_waitcnt lgkmcnt(8)
v_mfma_f32_32x32x16_bf16 a[160:175], v[56:59], v[144:147], a[160:175]
s_add_u32 s61, s59, 8
s_cmp_ge_u32 s61, 10
s_cselect_b32 s73, 10, 0
s_sub_u32 s61, s61, s73
s_lshl_b32 s61, s61, 7
s_add_u32 s61, s61, s88
s_add_u32 m0, s83, 98304
s_nop 0
buffer_load_dwordx4 v13, s[32:35], s61 offen lds
buffer_load_dwordx4 v14, s[32:35], s61 offen offset:1024 lds
ds_read_b64_tr_b16 v[76:77], v22 offset:128
ds_read_b64_tr_b16 v[78:79], v26 offset:3200
s_waitcnt lgkmcnt(8)
v_mfma_f32_32x32x16_bf16 a[176:191], v[60:63], v[144:147], a[176:191]
s_add_u32 s72, s61, 18432
buffer_load_dwordx4 v13, s[32:35], s72 offen offset:2048 lds
s_add_u32 s72, s61, 18432
buffer_load_dwordx4 v14, s[32:35], s72 offen offset:3072 lds
ds_read_b64_tr_b16 v[56:57], v20 offset:6144
ds_read_b64_tr_b16 v[58:59], v24 offset:9216
s_waitcnt lgkmcnt(8)
v_mfma_f32_32x32x16_bf16 a[192:207], v[64:67], v[144:147], a[192:207]
s_add_u32 m0, s83, 102400
s_add_u32 s72, s61, 40960
buffer_load_dwordx4 v13, s[32:35], s72 offen lds
s_add_u32 s72, s61, 40960
buffer_load_dwordx4 v14, s[32:35], s72 offen offset:1024 lds
ds_read_b64_tr_b16 v[60:61], v21 offset:6144
ds_read_b64_tr_b16 v[62:63], v25 offset:9216
s_waitcnt lgkmcnt(8)
v_mfma_f32_32x32x16_bf16 a[208:223], v[68:71], v[144:147], a[208:223]
v_fma_f32 v160, v160, s60, -v29
v_fma_f32 v161, v161, s60, -v29
v_exp_f32 v160, v160
v_exp_f32 v161, v161
v_fma_f32 v162, v162, s60, -v29
v_fma_f32 v163, v163, s60, -v29
v_exp_f32 v162, v162
v_exp_f32 v163, v163
ds_read_b64_tr_b16 v[64:65], v20 offset:6272
ds_read_b64_tr_b16 v[66:67], v24 offset:9344
s_waitcnt lgkmcnt(8)
v_mfma_f32_32x32x16_bf16 a[224:239], v[72:75], v[144:147], a[224:239]
v_add_f32 v30, v30, v160
v_add_f32 v30, v30, v161
v_cvt_pk_bf16_f32 v160, v160, v161
v_fma_f32 v164, v164, s60, -v29
v_fma_f32 v165, v165, s60, -v29
v_exp_f32 v164, v164
v_exp_f32 v165, v165
ds_read_b64_tr_b16 v[68:69], v22 offset:6144
ds_read_b64_tr_b16 v[70:71], v26 offset:9216
s_waitcnt lgkmcnt(8)
v_mfma_f32_32x32x16_bf16 a[240:255], v[76:79], v[144:147], a[240:255]
v_add_f32 v30, v30, v162
v_add_f32 v30, v30, v163
v_cvt_pk_bf16_f32 v161, v162, v163
ds_read_b64_tr_b16 v[72:73], v23 offset:6144
ds_read_b64_tr_b16 v[74:75], v27 offset:9216
s_waitcnt lgkmcnt(8)
v_mfma_f32_32x32x16_bf16 a[160:175], v[56:59], v[148:151], a[160:175]
v_fma_f32 v166, v166, s60, -v29
v_fma_f32 v167, v167, s60, -v29
v_exp_f32 v166, v166
v_exp_f32 v167, v167
v_add_f32 v30, v30, v164
v_add_f32 v30, v30, v165
v_cvt_pk_bf16_f32 v162, v164, v165
ds_read_b64_tr_b16 v[76:77], v22 offset:6272
ds_read_b64_tr_b16 v[78:79], v26 offset:9344
s_waitcnt lgkmcnt(8)
v_mfma_f32_32x32x16_bf16 a[176:191], v[60:63], v[148:151], a[176:191]
v_fma_f32 v168, v168, s60, -v29
v_fma_f32 v169, v169, s60, -v29
v_exp_f32 v168, v168
v_exp_f32 v169, v169
v_add_f32 v30, v30, v166
v_add_f32 v30, v30, v167
v_cvt_pk_bf16_f32 v163, v166, v167
v_add_u32 v20, 49152, v19
v_xor_b32 v21, 16, v20
ds_read_b64_tr_b16 v[56:57], v20
ds_read_b64_tr_b16 v[58:59], v21 offset:1024
s_waitcnt lgkmcnt(8)
v_mfma_f32_32x32x16_bf16 a[192:207], v[64:67], v[148:151], a[192:207]
v_fma_f32 v170, v170, s60, -v29
v_fma_f32 v171, v171, s60, -v29
v_exp_f32 v170, v170
v_exp_f32 v171, v171
v_add_f32 v30, v30, v168
v_add_f32 v30, v30, v169
v_cvt_pk_bf16_f32 v164, v168, v169
ds_read_b64_tr_b16 v[60:61], v20 offset:2048
ds_read_b64_tr_b16 v[62:63], v21 offset:3072
s_waitcnt lgkmcnt(8)
v_mfma_f32_32x32x16_bf16 a[208:223], v[68:71], v[148:151], a[208:223]
v_fma_f32 v172, v172, s60, -v29
v_fma_f32 v173, v173, s60, -v29
v_exp_f32 v172, v172
v_exp_f32 v173, v173
v_add_f32 v30, v30, v170
v_add_f32 v30, v30, v171
v_cvt_pk_bf16_f32 v165, v170, v171
ds_read_b64_tr_b16 v[64:65], v20 offset:4096
ds_read_b64_tr_b16 v[66:67], v21 offset:5120
s_waitcnt lgkmcnt(8)
v_mfma_f32_32x32x16_bf16 a[224:239], v[72:75], v[148:151], a[224:239]
v_fma_f32 v174, v174, s60, -v29
v_fma_f32 v175, v175, s60, -v29
v_exp_f32 v174, v174
v_exp_f32 v175, v175
v_add_f32 v30, v30, v172
v_add_f32 v30, v30, v173
v_cvt_pk_bf16_f32 v166, v172, v173
ds_read_b64_tr_b16 v[68:69], v20 offset:6144
ds_read_b64_tr_b16 v[70:71], v21 offset:7168
s_waitcnt lgkmcnt(8)
v_mfma_f32_32x32x16_bf16 a[240:255], v[76:79], v[148:151], a[240:255]
v_add_f32 v30, v30, v174
v_add_f32 v30, v30, v175
v_cvt_pk_bf16_f32 v167, v174, v175
s_waitcnt vmcnt(18)
s_barrier
ds_read_b64_tr_b16 v[72:73], v20 offset:8192
ds_read_b64_tr_b16 v[74:75], v21 offset:9216
s_waitcnt lgkmcnt(8)
v_mfma_f32_32x32x16_bf16 a[96:111], v[56:59], v[80:83], 0
s_add_u32 s61, s67, 4
s_and_b32 s61, s61, 7
s_mul_i32 s61, s61, 24576
s_add_u32 s61, s61, s83
s_add_u32 s61, s61, 196608
s_add_u32 m0, s83, 122880
s_nop 0
buffer_load_dwordx4 v1, s[24:27], s61 offen nt lds
ds_read_b64_tr_b16 v[76:77], v20 offset:10240
ds_read_b64_tr_b16 v[78:79], v21 offset:11264
s_waitcnt lgkmcnt(8)
v_mfma_f32_32x32x16_bf16 a[96:111], v[60:63], v[84:87], a[96:111]
buffer_load_dwordx4 v2, s[24:27], s61 offen offset:1024 nt lds
ds_read_b64_tr_b16 v[56:57], v20 offset:12288
ds_read_b64_tr_b16 v[58:59], v21 offset:13312
s_waitcnt lgkmcnt(8)
v_mfma_f32_32x32x16_bf16 a[96:111], v[64:67], v[88:91], a[96:111]
buffer_load_dwordx4 v3, s[24:27], s61 offen offset:2048 nt lds
ds_read_b64_tr_b16 v[60:61], v20 offset:14336
ds_read_b64_tr_b16 v[62:63], v21 offset:15360
s_waitcnt lgkmcnt(8)
v_mfma_f32_32x32x16_bf16 a[96:111], v[68:71], v[92:95], a[96:111]
buffer_load_dwordx4 v4, s[24:27], s61 offen offset:3072 nt lds
ds_read_b64_tr_b16 v[64:65], v20 offset:16384
ds_read_b64_tr_b16 v[66:67], v21 offset:17408
s_waitcnt lgkmcnt(8)
v_mfma_f32_32x32x16_bf16 a[96:111], v[72:75], v[96:99], a[96:111]
s_add_u32 m0, s83, 126976
s_nop 0
buffer_load_dwordx4 v5, s[24:27], s61 offen nt lds
ds_read_b64_tr_b16 v[68:69], v20 offset:18432
ds_read_b64_tr_b16 v[70:71], v21 offset:19456
s_waitcnt lgkmcnt(8)
v_mfma_f32_32x32x16_bf16 a[96:111], v[76:79], v[100:103], a[96:111]
buffer_load_dwordx4 v6, s[24:27], s61 offen offset:1024 nt lds
ds_read_b64_tr_b16 v[72:73], v20 offset:20480
ds_read_b64_tr_b16 v[74:75], v21 offset:21504
s_waitcnt lgkmcnt(8)
v_mfma_f32_32x32x16_bf16 a[96:111], v[56:59], v[104:107], a[96:111]
ds_read_b64_tr_b16 v[76:77], v20 offset:22528
ds_read_b64_tr_b16 v[78:79], v21 offset:23552
s_waitcnt lgkmcnt(8)
v_mfma_f32_32x32x16_bf16 a[96:111], v[60:63], v[108:111], a[96:111]
v_add_u32 v20, 73728, v16
v_xad_u32 v21, v20, 64, s74
v_xad_u32 v22, v20, 64, s75
v_add_u32 v23, s81, v20
v_xor_b32 v24, 16, v20
v_xor_b32 v25, 16, v21
v_xor_b32 v26, 16, v22
v_xor_b32 v27, 16, v23
ds_read_b64_tr_b16 v[56:57], v20
ds_read_b64_tr_b16 v[58:59], v24 offset:3072
s_waitcnt lgkmcnt(8)
v_mfma_f32_32x32x16_bf16 a[96:111], v[64:67], v[112:115], a[96:111]
ds_read_b64_tr_b16 v[60:61], v21
ds_read_b64_tr_b16 v[62:63], v25 offset:3072
s_waitcnt lgkmcnt(8)
v_mfma_f32_32x32x16_bf16 a[96:111], v[68:71], v[116:119], a[96:111]
ds_read_b64_tr_b16 v[64:65], v20 offset:128
ds_read_b64_tr_b16 v[66:67], v24 offset:3200
s_waitcnt lgkmcnt(8)
v_mfma_f32_32x32x16_bf16 a[96:111], v[72:75], v[120:123], a[96:111]
ds_read_b64_tr_b16 v[68:69], v22
ds_read_b64_tr_b16 v[70:71], v26 offset:3072
s_waitcnt lgkmcnt(8)
v_mfma_f32_32x32x16_bf16 a[96:111], v[76:79], v[124:127], a[96:111]
s_waitcnt vmcnt(18)
s_barrier
ds_read_b64_tr_b16 v[72:73], v23
ds_read_b64_tr_b16 v[74:75], v27 offset:3072
s_waitcnt lgkmcnt(8)
v_mfma_f32_32x32x16_bf16 a[160:175], v[56:59], v[160:163], a[160:175]
s_add_u32 s61, s59, 9
s_cmp_ge_u32 s61, 10
s_cselect_b32 s73, 10, 0
s_sub_u32 s61, s61, s73
s_lshl_b32 s61, s61, 7
s_add_u32 s61, s61, s88
s_add_u32 m0, s83, 49152
s_nop 0
buffer_load_dwordx4 v13, s[32:35], s61 offen lds
buffer_load_dwordx4 v14, s[32:35], s61 offen offset:1024 lds
ds_read_b64_tr_b16 v[76:77], v22 offset:128
ds_read_b64_tr_b16 v[78:79], v26 offset:3200
s_waitcnt lgkmcnt(8)
v_mfma_f32_32x32x16_bf16 a[176:191], v[60:63], v[160:163], a[176:191]
s_add_u32 s72, s61, 18432
buffer_load_dwordx4 v13, s[32:35], s72 offen offset:2048 lds
s_add_u32 s72, s61, 18432
buffer_load_dwordx4 v14, s[32:35], s72 offen offset:3072 lds
ds_read_b64_tr_b16 v[56:57], v20 offset:6144
ds_read_b64_tr_b16 v[58:59], v24 offset:9216
s_waitcnt lgkmcnt(8)
v_mfma_f32_32x32x16_bf16 a[192:207], v[64:67], v[160:163], a[192:207]
s_add_u32 m0, s83, 53248
s_add_u32 s72, s61, 40960
buffer_load_dwordx4 v13, s[32:35], s72 offen lds
s_add_u32 s72, s61, 40960
buffer_load_dwordx4 v14, s[32:35], s72 offen offset:1024 lds
ds_read_b64_tr_b16 v[60:61], v21 offset:6144
ds_read_b64_tr_b16 v[62:63], v25 offset:9216
s_waitcnt lgkmcnt(8)
v_mfma_f32_32x32x16_bf16 a[208:223], v[68:71], v[160:163], a[208:223]
v_fma_f32 v176, v176, s60, -v29
v_fma_f32 v177, v177, s60, -v29
v_exp_f32 v176, v176
v_exp_f32 v177, v177
v_fma_f32 v178, v178, s60, -v29
v_fma_f32 v179, v179, s60, -v29
v_exp_f32 v178, v178
v_exp_f32 v179, v179
ds_read_b64_tr_b16 v[64:65], v20 offset:6272
ds_read_b64_tr_b16 v[66:67], v24 offset:9344
s_waitcnt lgkmcnt(8)
v_mfma_f32_32x32x16_bf16 a[224:239], v[72:75], v[160:163], a[224:239]
v_add_f32 v30, v30, v176
v_add_f32 v30, v30, v177
v_cvt_pk_bf16_f32 v176, v176, v177
v_fma_f32 v180, v180, s60, -v29
v_fma_f32 v181, v181, s60, -v29
v_exp_f32 v180, v180
v_exp_f32 v181, v181
ds_read_b64_tr_b16 v[68:69], v22 offset:6144
ds_read_b64_tr_b16 v[70:71], v26 offset:9216
s_waitcnt lgkmcnt(8)
v_mfma_f32_32x32x16_bf16 a[240:255], v[76:79], v[160:163], a[240:255]
v_add_f32 v30, v30, v178
v_add_f32 v30, v30, v179
v_cvt_pk_bf16_f32 v177, v178, v179
ds_read_b64_tr_b16 v[72:73], v23 offset:6144
ds_read_b64_tr_b16 v[74:75], v27 offset:9216
s_waitcnt lgkmcnt(8)
v_mfma_f32_32x32x16_bf16 a[160:175], v[56:59], v[164:167], a[160:175]
v_fma_f32 v182, v182, s60, -v29
v_fma_f32 v183, v183, s60, -v29
v_exp_f32 v182, v182
v_exp_f32 v183, v183
v_add_f32 v30, v30, v180
v_add_f32 v30, v30, v181
v_cvt_pk_bf16_f32 v178, v180, v181
ds_read_b64_tr_b16 v[76:77], v22 offset:6272
ds_read_b64_tr_b16 v[78:79], v26 offset:9344
s_waitcnt lgkmcnt(8)
v_mfma_f32_32x32x16_bf16 a[176:191], v[60:63], v[164:167], a[176:191]
v_fma_f32 v184, v184, s60, -v29
v_fma_f32 v185, v185, s60, -v29
v_exp_f32 v184, v184
v_exp_f32 v185, v185
v_add_f32 v30, v30, v182
v_add_f32 v30, v30, v183
v_cvt_pk_bf16_f32 v179, v182, v183
v_add_u32 v20, 0, v19
v_xor_b32 v21, 16, v20
ds_read_b64_tr_b16 v[56:57], v20
ds_read_b64_tr_b16 v[58:59], v21 offset:1024
s_waitcnt lgkmcnt(8)
v_mfma_f32_32x32x16_bf16 a[192:207], v[64:67], v[164:167], a[192:207]
v_fma_f32 v186, v186, s60, -v29
v_fma_f32 v187, v187, s60, -v29
v_exp_f32 v186, v186
v_exp_f32 v187, v187
v_add_f32 v30, v30, v184
v_add_f32 v30, v30, v185
v_cvt_pk_bf16_f32 v180, v184, v185
ds_read_b64_tr_b16 v[60:61], v20 offset:2048
ds_read_b64_tr_b16 v[62:63], v21 offset:3072
s_waitcnt lgkmcnt(8)
v_mfma_f32_32x32x16_bf16 a[208:223], v[68:71], v[164:167], a[208:223]
v_fma_f32 v188, v188, s60, -v29
v_fma_f32 v189, v189, s60, -v29
v_exp_f32 v188, v188
v_exp_f32 v189, v189
v_add_f32 v30, v30, v186
v_add_f32 v30, v30, v187
v_cvt_pk_bf16_f32 v181, v186, v187
ds_read_b64_tr_b16 v[64:65], v20 offset:4096
ds_read_b64_tr_b16 v[66:67], v21 offset:5120
s_waitcnt lgkmcnt(8)
v_mfma_f32_32x32x16_bf16 a[224:239], v[72:75], v[164:167], a[224:239]
v_fma_f32 v190, v190, s60, -v29
v_fma_f32 v191, v191, s60, -v29
v_exp_f32 v190, v190
v_exp_f32 v191, v191
v_add_f32 v30, v30, v188
v_add_f32 v30, v30, v189
v_cvt_pk_bf16_f32 v182, v188, v189
ds_read_b64_tr_b16 v[68:69], v20 offset:6144
ds_read_b64_tr_b16 v[70:71], v21 offset:7168
s_waitcnt lgkmcnt(8)
v_mfma_f32_32x32x16_bf16 a[240:255], v[76:79], v[164:167], a[240:255]
v_add_f32 v30, v30, v190
v_add_f32 v30, v30, v191
v_cvt_pk_bf16_f32 v183, v190, v191
s_waitcnt vmcnt(18)
s_barrier
ds_read_b64_tr_b16 v[72:73], v20 offset:8192
ds_read_b64_tr_b16 v[74:75], v21 offset:9216
s_waitcnt lgkmcnt(8)
v_mfma_f32_32x32x16_bf16 a[112:127], v[56:59], v[80:83], 0
s_add_u32 s61, s67, 5
s_and_b32 s61, s61, 7
s_mul_i32 s61, s61, 24576
s_add_u32 s61, s61, s83
s_add_u32 s61, s61, 196608
s_add_u32 m0, s83, 73728
s_nop 0
buffer_load_dwordx4 v1, s[24:27], s61 offen nt lds
ds_read_b64_tr_b16 v[76:77], v20 offset:10240
ds_read_b64_tr_b16 v[78:79], v21 offset:11264
s_waitcnt lgkmcnt(8)
v_mfma_f32_32x32x16_bf16 a[112:127], v[60:63], v[84:87], a[112:127]
buffer_load_dwordx4 v2, s[24:27], s61 offen offset:1024 nt lds
ds_read_b64_tr_b16 v[56:57], v20 offset:12288
ds_read_b64_tr_b16 v[58:59], v21 offset:13312
s_waitcnt lgkmcnt(8)
v_mfma_f32_32x32x16_bf16 a[112:127], v[64:67], v[88:91], a[112:127]
buffer_load_dwordx4 v3, s[24:27], s61 offen offset:2048 nt lds
ds_read_b64_tr_b16 v[60:61], v20 offset:14336
ds_read_b64_tr_b16 v[62:63], v21 offset:15360
s_waitcnt lgkmcnt(8)
v_mfma_f32_32x32x16_bf16 a[112:127], v[68:71], v[92:95], a[112:127]
buffer_load_dwordx4 v4, s[24:27], s61 offen offset:3072 nt lds
ds_read_b64_tr_b16 v[64:65], v20 offset:16384
ds_read_b64_tr_b16 v[66:67], v21 offset:17408
s_waitcnt lgkmcnt(8)
v_mfma_f32_32x32x16_bf16 a[112:127], v[72:75], v[96:99], a[112:127]
s_add_u32 m0, s83, 77824
s_nop 0
buffer_load_dwordx4 v5, s[24:27], s61 offen nt lds
ds_read_b64_tr_b16 v[68:69], v20 offset:18432
ds_read_b64_tr_b16 v[70:71], v21 offset:19456
s_waitcnt lgkmcnt(8)
v_mfma_f32_32x32x16_bf16 a[112:127], v[76:79], v[100:103], a[112:127]
buffer_load_dwordx4 v6, s[24:27], s61 offen offset:1024 nt lds
ds_read_b64_tr_b16 v[72:73], v20 offset:20480
ds_read_b64_tr_b16 v[74:75], v21 offset:21504
s_waitcnt lgkmcnt(8)
v_mfma_f32_32x32x16_bf16 a[112:127], v[56:59], v[104:107], a[112:127]
ds_read_b64_tr_b16 v[76:77], v20 offset:22528
ds_read_b64_tr_b16 v[78:79], v21 offset:23552
s_waitcnt lgkmcnt(8)
v_mfma_f32_32x32x16_bf16 a[112:127], v[60:63], v[108:111], a[112:127]
v_add_u32 v20, 24576, v16
v_xad_u32 v21, v20, 64, s74
v_xad_u32 v22, v20, 64, s75
v_add_u32 v23, s81, v20
v_xor_b32 v24, 16, v20
v_xor_b32 v25, 16, v21
v_xor_b32 v26, 16, v22
v_xor_b32 v27, 16, v23
ds_read_b64_tr_b16 v[56:57], v20
ds_read_b64_tr_b16 v[58:59], v24 offset:3072
s_waitcnt lgkmcnt(8)
v_mfma_f32_32x32x16_bf16 a[112:127], v[64:67], v[112:115], a[112:127]
ds_read_b64_tr_b16 v[60:61], v21
ds_read_b64_tr_b16 v[62:63], v25 offset:3072
s_waitcnt lgkmcnt(8)
v_mfma_f32_32x32x16_bf16 a[112:127], v[68:71], v[116:119], a[112:127]
ds_read_b64_tr_b16 v[64:65], v20 offset:128
ds_read_b64_tr_b16 v[66:67], v24 offset:3200
s_waitcnt lgkmcnt(8)
v_mfma_f32_32x32x16_bf16 a[112:127], v[72:75], v[120:123], a[112:127]
ds_read_b64_tr_b16 v[68:69], v22
ds_read_b64_tr_b16 v[70:71], v26 offset:3072
s_waitcnt lgkmcnt(8)
v_mfma_f32_32x32x16_bf16 a[112:127], v[76:79], v[124:127], a[112:127]
s_waitcnt vmcnt(18)
s_barrier
ds_read_b64_tr_b16 v[72:73], v23
ds_read_b64_tr_b16 v[74:75], v27 offset:3072
s_waitcnt lgkmcnt(8)
v_mfma_f32_32x32x16_bf16 a[160:175], v[56:59], v[176:179], a[160:175]
s_add_u32 s61, s67, 6
s_and_b32 s61, s61, 7
s_mul_i32 s61, s61, 24576
s_add_u32 s61, s61, s83
s_add_u32 s61, s61, 196608
s_add_u32 m0, s83, 0
s_nop 0
buffer_load_dwordx4 v1, s[24:27], s61 offen nt lds
buffer_load_dwordx4 v2, s[24:27], s61 offen offset:1024 nt lds
ds_read_b64_tr_b16 v[76:77], v22 offset:128
ds_read_b64_tr_b16 v[78:79], v26 offset:3200
s_waitcnt lgkmcnt(8)
v_mfma_f32_32x32x16_bf16 a[176:191], v[60:63], v[176:179], a[176:191]
buffer_load_dwordx4 v3, s[24:27], s61 offen offset:2048 nt lds
buffer_load_dwordx4 v4, s[24:27], s61 offen offset:3072 nt lds
ds_read_b64_tr_b16 v[56:57], v20 offset:6144
ds_read_b64_tr_b16 v[58:59], v24 offset:9216
s_waitcnt lgkmcnt(8)
v_mfma_f32_32x32x16_bf16 a[192:207], v[64:67], v[176:179], a[192:207]
s_add_u32 m0, s83, 4096
s_nop 0
buffer_load_dwordx4 v5, s[24:27], s61 offen nt lds
buffer_load_dwordx4 v6, s[24:27], s61 offen offset:1024 nt lds
ds_read_b64_tr_b16 v[60:61], v21 offset:6144
ds_read_b64_tr_b16 v[62:63], v25 offset:9216
s_waitcnt lgkmcnt(8)
v_mfma_f32_32x32x16_bf16 a[208:223], v[68:71], v[176:179], a[208:223]
v_fma_f32 v192, v192, s60, -v29
v_fma_f32 v193, v193, s60, -v29
v_exp_f32 v192, v192
v_exp_f32 v193, v193
v_fma_f32 v194, v194, s60, -v29
v_fma_f32 v195, v195, s60, -v29
v_exp_f32 v194, v194
v_exp_f32 v195, v195
ds_read_b64_tr_b16 v[64:65], v20 offset:6272
ds_read_b64_tr_b16 v[66:67], v24 offset:9344
s_waitcnt lgkmcnt(8)
v_mfma_f32_32x32x16_bf16 a[224:239], v[72:75], v[176:179], a[224:239]
v_add_f32 v30, v30, v192
v_add_f32 v30, v30, v193
v_cvt_pk_bf16_f32 v192, v192, v193
v_fma_f32 v196, v196, s60, -v29
v_fma_f32 v197, v197, s60, -v29
v_exp_f32 v196, v196
v_exp_f32 v197, v197
ds_read_b64_tr_b16 v[68:69], v22 offset:6144
ds_read_b64_tr_b16 v[70:71], v26 offset:9216
s_waitcnt lgkmcnt(8)
v_mfma_f32_32x32x16_bf16 a[240:255], v[76:79], v[176:179], a[240:255]
v_add_f32 v30, v30, v194
v_add_f32 v30, v30, v195
v_cvt_pk_bf16_f32 v193, v194, v195
ds_read_b64_tr_b16 v[72:73], v23 offset:6144
ds_read_b64_tr_b16 v[74:75], v27 offset:9216
s_waitcnt lgkmcnt(8)
v_mfma_f32_32x32x16_bf16 a[160:175], v[56:59], v[180:183], a[160:175]
v_fma_f32 v198, v198, s60, -v29
v_fma_f32 v199, v199, s60, -v29
v_exp_f32 v198, v198
v_exp_f32 v199, v199
v_add_f32 v30, v30, v196
v_add_f32 v30, v30, v197
v_cvt_pk_bf16_f32 v194, v196, v197
ds_read_b64_tr_b16 v[76:77], v22 offset:6272
ds_read_b64_tr_b16 v[78:79], v26 offset:9344
s_waitcnt lgkmcnt(8)
v_mfma_f32_32x32x16_bf16 a[176:191], v[60:63], v[180:183], a[176:191]
v_fma_f32 v200, v200, s60, -v29
v_fma_f32 v201, v201, s60, -v29
v_exp_f32 v200, v200
v_exp_f32 v201, v201
v_add_f32 v30, v30, v198
v_add_f32 v30, v30, v199
v_cvt_pk_bf16_f32 v195, v198, v199
v_add_u32 v20, 98304, v19
v_xor_b32 v21, 16, v20
ds_read_b64_tr_b16 v[56:57], v20
ds_read_b64_tr_b16 v[58:59], v21 offset:1024
s_waitcnt lgkmcnt(8)
v_mfma_f32_32x32x16_bf16 a[192:207], v[64:67], v[180:183], a[192:207]
v_fma_f32 v202, v202, s60, -v29
v_fma_f32 v203, v203, s60, -v29
v_exp_f32 v202, v202
v_exp_f32 v203, v203
v_add_f32 v30, v30, v200
v_add_f32 v30, v30, v201
v_cvt_pk_bf16_f32 v196, v200, v201
ds_read_b64_tr_b16 v[60:61], v20 offset:2048
ds_read_b64_tr_b16 v[62:63], v21 offset:3072
s_waitcnt lgkmcnt(8)
v_mfma_f32_32x32x16_bf16 a[208:223], v[68:71], v[180:183], a[208:223]
v_fma_f32 v204, v204, s60, -v29
v_fma_f32 v205, v205, s60, -v29
v_exp_f32 v204, v204
v_exp_f32 v205, v205
v_add_f32 v30, v30, v202
v_add_f32 v30, v30, v203
v_cvt_pk_bf16_f32 v197, v202, v203
ds_read_b64_tr_b16 v[64:65], v20 offset:4096
ds_read_b64_tr_b16 v[66:67], v21 offset:5120
s_waitcnt lgkmcnt(8)
v_mfma_f32_32x32x16_bf16 a[224:239], v[72:75], v[180:183], a[224:239]
v_fma_f32 v206, v206, s60, -v29
v_fma_f32 v207, v207, s60, -v29
v_exp_f32 v206, v206
v_exp_f32 v207, v207
v_add_f32 v30, v30, v204
v_add_f32 v30, v30, v205
v_cvt_pk_bf16_f32 v198, v204, v205
ds_read_b64_tr_b16 v[68:69], v20 offset:6144
ds_read_b64_tr_b16 v[70:71], v21 offset:7168
s_waitcnt lgkmcnt(8)
v_mfma_f32_32x32x16_bf16 a[240:255], v[76:79], v[180:183], a[240:255]
v_add_f32 v30, v30, v206
v_add_f32 v30, v30, v207
v_cvt_pk_bf16_f32 v199, v206, v207
s_waitcnt vmcnt(18)
s_barrier
ds_read_b64_tr_b16 v[72:73], v20 offset:8192
ds_read_b64_tr_b16 v[74:75], v21 offset:9216
s_waitcnt lgkmcnt(8)
v_mfma_f32_32x32x16_bf16 a[128:143], v[56:59], v[80:83], 0
s_add_u32 s61, s67, 7
s_and_b32 s61, s61, 7
s_mul_i32 s61, s61, 24576
s_add_u32 s61, s61, s83
s_add_u32 s61, s61, 196608
s_add_u32 m0, s83, 24576
s_nop 0
buffer_load_dwordx4 v1, s[24:27], s61 offen nt lds
ds_read_b64_tr_b16 v[76:77], v20 offset:10240
ds_read_b64_tr_b16 v[78:79], v21 offset:11264
s_waitcnt lgkmcnt(8)
v_mfma_f32_32x32x16_bf16 a[128:143], v[60:63], v[84:87], a[128:143]
buffer_load_dwordx4 v2, s[24:27], s61 offen offset:1024 nt lds
ds_read_b64_tr_b16 v[56:57], v20 offset:12288
ds_read_b64_tr_b16 v[58:59], v21 offset:13312
s_waitcnt lgkmcnt(8)
v_mfma_f32_32x32x16_bf16 a[128:143], v[64:67], v[88:91], a[128:143]
buffer_load_dwordx4 v3, s[24:27], s61 offen offset:2048 nt lds
ds_read_b64_tr_b16 v[60:61], v20 offset:14336
ds_read_b64_tr_b16 v[62:63], v21 offset:15360
s_waitcnt lgkmcnt(8)
v_mfma_f32_32x32x16_bf16 a[128:143], v[68:71], v[92:95], a[128:143]
buffer_load_dwordx4 v4, s[24:27], s61 offen offset:3072 nt lds
ds_read_b64_tr_b16 v[64:65], v20 offset:16384
ds_read_b64_tr_b16 v[66:67], v21 offset:17408
s_waitcnt lgkmcnt(8)
v_mfma_f32_32x32x16_bf16 a[128:143], v[72:75], v[96:99], a[128:143]
s_add_u32 m0, s83, 28672
s_nop 0
buffer_load_dwordx4 v5, s[24:27], s61 offen nt lds
ds_read_b64_tr_b16 v[68:69], v20 offset:18432
ds_read_b64_tr_b16 v[70:71], v21 offset:19456
s_waitcnt lgkmcnt(8)
v_mfma_f32_32x32x16_bf16 a[128:143], v[76:79], v[100:103], a[128:143]
buffer_load_dwordx4 v6, s[24:27], s61 offen offset:1024 nt lds
ds_read_b64_tr_b16 v[72:73], v20 offset:20480
ds_read_b64_tr_b16 v[74:75], v21 offset:21504
s_waitcnt lgkmcnt(8)
v_mfma_f32_32x32x16_bf16 a[128:143], v[56:59], v[104:107], a[128:143]
ds_read_b64_tr_b16 v[76:77], v20 offset:22528
ds_read_b64_tr_b16 v[78:79], v21 offset:23552
s_waitcnt lgkmcnt(8)
v_mfma_f32_32x32x16_bf16 a[128:143], v[60:63], v[108:111], a[128:143]
v_add_u32 v20, 122880, v16
v_xad_u32 v21, v20, 64, s74
v_xad_u32 v22, v20, 64, s75
v_add_u32 v23, s81, v20
v_xor_b32 v24, 16, v20
v_xor_b32 v25, 16, v21
v_xor_b32 v26, 16, v22
v_xor_b32 v27, 16, v23
ds_read_b64_tr_b16 v[56:57], v20
ds_read_b64_tr_b16 v[58:59], v24 offset:3072
s_waitcnt lgkmcnt(8)
v_mfma_f32_32x32x16_bf16 a[128:143], v[64:67], v[112:115], a[128:143]
ds_read_b64_tr_b16 v[60:61], v21
ds_read_b64_tr_b16 v[62:63], v25 offset:3072
s_waitcnt lgkmcnt(8)
v_mfma_f32_32x32x16_bf16 a[128:143], v[68:71], v[116:119], a[128:143]
ds_read_b64_tr_b16 v[64:65], v20 offset:128
ds_read_b64_tr_b16 v[66:67], v24 offset:3200
s_waitcnt lgkmcnt(8)
v_mfma_f32_32x32x16_bf16 a[128:143], v[72:75], v[120:123], a[128:143]
ds_read_b64_tr_b16 v[68:69], v22
ds_read_b64_tr_b16 v[70:71], v26 offset:3072
s_waitcnt lgkmcnt(8)
v_mfma_f32_32x32x16_bf16 a[128:143], v[76:79], v[124:127], a[128:143]
s_waitcnt vmcnt(18)
s_barrier
ds_read_b64_tr_b16 v[72:73], v23
ds_read_b64_tr_b16 v[74:75], v27 offset:3072
s_waitcnt lgkmcnt(8)
v_mfma_f32_32x32x16_bf16 a[160:175], v[56:59], v[192:195], a[160:175]
v_fma_f32 v208, v208, s60, -v29
v_fma_f32 v209, v209, s60, -v29
v_exp_f32 v208, v208
v_exp_f32 v209, v209
v_fma_f32 v210, v210, s60, -v29
v_fma_f32 v211, v211, s60, -v29
v_exp_f32 v210, v210
v_exp_f32 v211, v211
ds_read_b64_tr_b16 v[76:77], v22 offset:128
ds_read_b64_tr_b16 v[78:79], v26 offset:3200
s_waitcnt lgkmcnt(8)
v_mfma_f32_32x32x16_bf16 a[176:191], v[60:63], v[192:195], a[176:191]
v_add_f32 v30, v30, v208
v_add_f32 v30, v30, v209
v_cvt_pk_bf16_f32 v208, v208, v209
ds_read_b64_tr_b16 v[56:57], v20 offset:6144
ds_read_b64_tr_b16 v[58:59], v24 offset:9216
s_waitcnt lgkmcnt(8)
v_mfma_f32_32x32x16_bf16 a[192:207], v[64:67], v[192:195], a[192:207]
v_fma_f32 v212, v212, s60, -v29
v_fma_f32 v213, v213, s60, -v29
v_exp_f32 v212, v212
v_exp_f32 v213, v213
ds_read_b64_tr_b16 v[60:61], v21 offset:6144
ds_read_b64_tr_b16 v[62:63], v25 offset:9216
s_waitcnt lgkmcnt(8)
v_mfma_f32_32x32x16_bf16 a[208:223], v[68:71], v[192:195], a[208:223]
v_add_f32 v30, v30, v210
v_add_f32 v30, v30, v211
v_cvt_pk_bf16_f32 v209, v210, v211
v_fma_f32 v214, v214, s60, -v29
v_fma_f32 v215, v215, s60, -v29
v_exp_f32 v214, v214
v_exp_f32 v215, v215
ds_read_b64_tr_b16 v[64:65], v20 offset:6272
ds_read_b64_tr_b16 v[66:67], v24 offset:9344
s_waitcnt lgkmcnt(8)
v_mfma_f32_32x32x16_bf16 a[224:239], v[72:75], v[192:195], a[224:239]
v_add_f32 v30, v30, v212
v_add_f32 v30, v30, v213
v_cvt_pk_bf16_f32 v210, v212, v213
ds_read_b64_tr_b16 v[68:69], v22 offset:6144
ds_read_b64_tr_b16 v[70:71], v26 offset:9216
s_waitcnt lgkmcnt(8)
v_mfma_f32_32x32x16_bf16 a[240:255], v[76:79], v[192:195], a[240:255]
v_fma_f32 v216, v216, s60, -v29
v_fma_f32 v217, v217, s60, -v29
v_exp_f32 v216, v216
v_exp_f32 v217, v217
ds_read_b64_tr_b16 v[72:73], v23 offset:6144
ds_read_b64_tr_b16 v[74:75], v27 offset:9216
s_waitcnt lgkmcnt(8)
v_mfma_f32_32x32x16_bf16 a[160:175], v[56:59], v[196:199], a[160:175]
v_add_f32 v30, v30, v214
v_add_f32 v30, v30, v215
v_cvt_pk_bf16_f32 v211, v214, v215
v_fma_f32 v218, v218, s60, -v29
v_fma_f32 v219, v219, s60, -v29
v_exp_f32 v218, v218
v_exp_f32 v219, v219
ds_read_b64_tr_b16 v[76:77], v22 offset:6272
ds_read_b64_tr_b16 v[78:79], v26 offset:9344
s_waitcnt lgkmcnt(8)
v_mfma_f32_32x32x16_bf16 a[176:191], v[60:63], v[196:199], a[176:191]
v_add_f32 v30, v30, v216
v_add_f32 v30, v30, v217
v_cvt_pk_bf16_f32 v212, v216, v217
v_add_u32 v20, 49152, v19
v_xor_b32 v21, 16, v20
ds_read_b64_tr_b16 v[56:57], v20
ds_read_b64_tr_b16 v[58:59], v21 offset:1024
s_waitcnt lgkmcnt(8)
v_mfma_f32_32x32x16_bf16 a[192:207], v[64:67], v[196:199], a[192:207]
v_fma_f32 v220, v220, s60, -v29
v_fma_f32 v221, v221, s60, -v29
v_exp_f32 v220, v220
v_exp_f32 v221, v221
ds_read_b64_tr_b16 v[60:61], v20 offset:2048
ds_read_b64_tr_b16 v[62:63], v21 offset:3072
s_waitcnt lgkmcnt(8)
v_mfma_f32_32x32x16_bf16 a[208:223], v[68:71], v[196:199], a[208:223]
v_add_f32 v30, v30, v218
v_add_f32 v30, v30, v219
v_cvt_pk_bf16_f32 v213, v218, v219
v_fma_f32 v222, v222, s60, -v29
v_fma_f32 v223, v223, s60, -v29
v_exp_f32 v222, v222
v_exp_f32 v223, v223
ds_read_b64_tr_b16 v[64:65], v20 offset:4096
ds_read_b64_tr_b16 v[66:67], v21 offset:5120
s_waitcnt lgkmcnt(8)
v_mfma_f32_32x32x16_bf16 a[224:239], v[72:75], v[196:199], a[224:239]
v_add_f32 v30, v30, v220
v_add_f32 v30, v30, v221
v_cvt_pk_bf16_f32 v214, v220, v221
ds_read_b64_tr_b16 v[68:69], v20 offset:6144
ds_read_b64_tr_b16 v[70:71], v21 offset:7168
s_waitcnt lgkmcnt(8)
v_mfma_f32_32x32x16_bf16 a[240:255], v[76:79], v[196:199], a[240:255]
v_add_f32 v30, v30, v222
v_add_f32 v30, v30, v223
v_cvt_pk_bf16_f32 v215, v222, v223
s_waitcnt vmcnt(12)
s_barrier
ds_read_b64_tr_b16 v[72:73], v20 offset:8192
ds_read_b64_tr_b16 v[74:75], v21 offset:9216
s_waitcnt lgkmcnt(8)
v_mfma_f32_32x32x16_bf16 a[144:159], v[56:59], v[80:83], 0
ds_read_b64_tr_b16 v[76:77], v20 offset:10240
ds_read_b64_tr_b16 v[78:79], v21 offset:11264
s_waitcnt lgkmcnt(8)
v_mfma_f32_32x32x16_bf16 a[144:159], v[60:63], v[84:87], a[144:159]
ds_read_b64_tr_b16 v[56:57], v20 offset:12288
ds_read_b64_tr_b16 v[58:59], v21 offset:13312
s_waitcnt lgkmcnt(8)
v_mfma_f32_32x32x16_bf16 a[144:159], v[64:67], v[88:91], a[144:159]
ds_read_b64_tr_b16 v[60:61], v20 offset:14336
ds_read_b64_tr_b16 v[62:63], v21 offset:15360
s_waitcnt lgkmcnt(8)
v_mfma_f32_32x32x16_bf16 a[144:159], v[68:71], v[92:95], a[144:159]
ds_read_b64_tr_b16 v[64:65], v20 offset:16384
ds_read_b64_tr_b16 v[66:67], v21 offset:17408
s_waitcnt lgkmcnt(8)
v_mfma_f32_32x32x16_bf16 a[144:159], v[72:75], v[96:99], a[144:159]
ds_read_b64_tr_b16 v[68:69], v20 offset:18432
ds_read_b64_tr_b16 v[70:71], v21 offset:19456
s_waitcnt lgkmcnt(8)
v_mfma_f32_32x32x16_bf16 a[144:159], v[76:79], v[100:103], a[144:159]
ds_read_b64_tr_b16 v[72:73], v20 offset:20480
ds_read_b64_tr_b16 v[74:75], v21 offset:21504
s_waitcnt lgkmcnt(8)
v_mfma_f32_32x32x16_bf16 a[144:159], v[56:59], v[104:107], a[144:159]
ds_read_b64_tr_b16 v[76:77], v20 offset:22528
ds_read_b64_tr_b16 v[78:79], v21 offset:23552
s_waitcnt lgkmcnt(8)
v_mfma_f32_32x32x16_bf16 a[144:159], v[60:63], v[108:111], a[144:159]
v_add_u32 v20, 73728, v16
v_xad_u32 v21, v20, 64, s74
v_xad_u32 v22, v20, 64, s75
v_add_u32 v23, s81, v20
v_xor_b32 v24, 16, v20
v_xor_b32 v25, 16, v21
v_xor_b32 v26, 16, v22
v_xor_b32 v27, 16, v23
ds_read_b64_tr_b16 v[56:57], v20
ds_read_b64_tr_b16 v[58:59], v24 offset:3072
s_waitcnt lgkmcnt(8)
v_mfma_f32_32x32x16_bf16 a[144:159], v[64:67], v[112:115], a[144:159]
ds_read_b64_tr_b16 v[60:61], v21
ds_read_b64_tr_b16 v[62:63], v25 offset:3072
s_waitcnt lgkmcnt(8)
v_mfma_f32_32x32x16_bf16 a[144:159], v[68:71], v[116:119], a[144:159]
ds_read_b64_tr_b16 v[64:65], v20 offset:128
ds_read_b64_tr_b16 v[66:67], v24 offset:3200
s_waitcnt lgkmcnt(8)
v_mfma_f32_32x32x16_bf16 a[144:159], v[72:75], v[120:123], a[144:159]
ds_read_b64_tr_b16 v[68:69], v22
ds_read_b64_tr_b16 v[70:71], v26 offset:3072
s_waitcnt lgkmcnt(8)
v_mfma_f32_32x32x16_bf16 a[144:159], v[76:79], v[124:127], a[144:159]
s_waitcnt vmcnt(6)
s_barrier
ds_read_b64_tr_b16 v[72:73], v23
ds_read_b64_tr_b16 v[74:75], v27 offset:3072
s_waitcnt lgkmcnt(8)
v_mfma_f32_32x32x16_bf16 a[160:175], v[56:59], v[208:211], a[160:175]
s_add_u32 s61, s59, 0
s_cmp_ge_u32 s61, 10
s_cselect_b32 s73, 10, 0
s_sub_u32 s61, s61, s73
s_lshl_b32 s61, s61, 7
s_add_u32 s61, s61, s88
s_add_u32 s61, s61, 245760
s_add_u32 m0, s83, 49152
s_nop 0
buffer_load_dwordx4 v13, s[32:35], s61 offen lds
buffer_load_dwordx4 v14, s[32:35], s61 offen offset:1024 lds
ds_read_b64_tr_b16 v[76:77], v22 offset:128
ds_read_b64_tr_b16 v[78:79], v26 offset:3200
s_waitcnt lgkmcnt(8)
v_mfma_f32_32x32x16_bf16 a[176:191], v[60:63], v[208:211], a[176:191]
s_add_u32 s72, s61, 18432
buffer_load_dwordx4 v13, s[32:35], s72 offen offset:2048 lds
s_add_u32 s72, s61, 18432
buffer_load_dwordx4 v14, s[32:35], s72 offen offset:3072 lds
ds_read_b64_tr_b16 v[56:57], v20 offset:6144
ds_read_b64_tr_b16 v[58:59], v24 offset:9216
s_waitcnt lgkmcnt(8)
v_mfma_f32_32x32x16_bf16 a[192:207], v[64:67], v[208:211], a[192:207]
s_add_u32 m0, s83, 53248
s_add_u32 s72, s61, 40960
buffer_load_dwordx4 v13, s[32:35], s72 offen lds
s_add_u32 s72, s61, 40960
buffer_load_dwordx4 v14, s[32:35], s72 offen offset:1024 lds
ds_read_b64_tr_b16 v[60:61], v21 offset:6144
ds_read_b64_tr_b16 v[62:63], v25 offset:9216
s_waitcnt lgkmcnt(8)
v_mfma_f32_32x32x16_bf16 a[208:223], v[68:71], v[208:211], a[208:223]
v_fma_f32 v224, v224, s60, -v29
v_fma_f32 v225, v225, s60, -v29
v_exp_f32 v224, v224
v_exp_f32 v225, v225
v_fma_f32 v226, v226, s60, -v29
v_fma_f32 v227, v227, s60, -v29
v_exp_f32 v226, v226
v_exp_f32 v227, v227
ds_read_b64_tr_b16 v[64:65], v20 offset:6272
ds_read_b64_tr_b16 v[66:67], v24 offset:9344
s_waitcnt lgkmcnt(8)
v_mfma_f32_32x32x16_bf16 a[224:239], v[72:75], v[208:211], a[224:239]
v_add_f32 v30, v30, v224
v_add_f32 v30, v30, v225
v_cvt_pk_bf16_f32 v224, v224, v225
v_fma_f32 v228, v228, s60, -v29
v_fma_f32 v229, v229, s60, -v29
v_exp_f32 v228, v228
v_exp_f32 v229, v229
ds_read_b64_tr_b16 v[68:69], v22 offset:6144
ds_read_b64_tr_b16 v[70:71], v26 offset:9216
s_waitcnt lgkmcnt(8)
v_mfma_f32_32x32x16_bf16 a[240:255], v[76:79], v[208:211], a[240:255]
v_add_f32 v30, v30, v226
v_add_f32 v30, v30, v227
v_cvt_pk_bf16_f32 v225, v226, v227
ds_read_b64_tr_b16 v[72:73], v23 offset:6144
ds_read_b64_tr_b16 v[74:75], v27 offset:9216
s_waitcnt lgkmcnt(8)
v_mfma_f32_32x32x16_bf16 a[160:175], v[56:59], v[212:215], a[160:175]
v_fma_f32 v230, v230, s60, -v29
v_fma_f32 v231, v231, s60, -v29
v_exp_f32 v230, v230
v_exp_f32 v231, v231
v_add_f32 v30, v30, v228
v_add_f32 v30, v30, v229
v_cvt_pk_bf16_f32 v226, v228, v229
ds_read_b64_tr_b16 v[76:77], v22 offset:6272
ds_read_b64_tr_b16 v[78:79], v26 offset:9344
s_waitcnt lgkmcnt(8)
v_mfma_f32_32x32x16_bf16 a[176:191], v[60:63], v[212:215], a[176:191]
v_fma_f32 v232, v232, s60, -v29
v_fma_f32 v233, v233, s60, -v29
v_exp_f32 v232, v232
v_exp_f32 v233, v233
v_add_f32 v30, v30, v230
v_add_f32 v30, v30, v231
v_cvt_pk_bf16_f32 v227, v230, v231
v_add_u32 v20, 0, v16
v_xad_u32 v21, v20, 64, s74
v_xad_u32 v22, v20, 64, s75
v_add_u32 v23, s81, v20
v_xor_b32 v24, 16, v20
v_xor_b32 v25, 16, v21
v_xor_b32 v26, 16, v22
v_xor_b32 v27, 16, v23
ds_read_b64_tr_b16 v[56:57], v20
ds_read_b64_tr_b16 v[58:59], v24 offset:3072
s_waitcnt lgkmcnt(8)
v_mfma_f32_32x32x16_bf16 a[192:207], v[64:67], v[212:215], a[192:207]
v_fma_f32 v234, v234, s60, -v29
v_fma_f32 v235, v235, s60, -v29
v_exp_f32 v234, v234
v_exp_f32 v235, v235
v_add_f32 v30, v30, v232
v_add_f32 v30, v30, v233
v_cvt_pk_bf16_f32 v228, v232, v233
ds_read_b64_tr_b16 v[60:61], v21
ds_read_b64_tr_b16 v[62:63], v25 offset:3072
s_waitcnt lgkmcnt(8)
v_mfma_f32_32x32x16_bf16 a[208:223], v[68:71], v[212:215], a[208:223]
v_fma_f32 v236, v236, s60, -v29
v_fma_f32 v237, v237, s60, -v29
v_exp_f32 v236, v236
v_exp_f32 v237, v237
v_add_f32 v30, v30, v234
v_add_f32 v30, v30, v235
v_cvt_pk_bf16_f32 v229, v234, v235
ds_read_b64_tr_b16 v[64:65], v20 offset:128
ds_read_b64_tr_b16 v[66:67], v24 offset:3200
s_waitcnt lgkmcnt(8)
v_mfma_f32_32x32x16_bf16 a[224:239], v[72:75], v[212:215], a[224:239]
v_fma_f32 v238, v238, s60, -v29
v_fma_f32 v239, v239, s60, -v29
v_exp_f32 v238, v238
v_exp_f32 v239, v239
v_add_f32 v30, v30, v236
v_add_f32 v30, v30, v237
v_cvt_pk_bf16_f32 v230, v236, v237
ds_read_b64_tr_b16 v[68:69], v22
ds_read_b64_tr_b16 v[70:71], v26 offset:3072
s_waitcnt lgkmcnt(8)
v_mfma_f32_32x32x16_bf16 a[240:255], v[76:79], v[212:215], a[240:255]
v_add_f32 v30, v30, v238
v_add_f32 v30, v30, v239
v_cvt_pk_bf16_f32 v231, v238, v239
s_waitcnt vmcnt(6)
s_barrier
ds_read_b64_tr_b16 v[72:73], v23
ds_read_b64_tr_b16 v[74:75], v27 offset:3072
s_waitcnt lgkmcnt(8)
v_mfma_f32_32x32x16_bf16 a[160:175], v[56:59], v[224:227], a[160:175]
s_add_u32 s61, s59, 1
s_cmp_ge_u32 s61, 10
s_cselect_b32 s73, 10, 0
s_sub_u32 s61, s61, s73
s_lshl_b32 s61, s61, 7
s_add_u32 s61, s61, s88
s_add_u32 s61, s61, 245760
s_add_u32 m0, s83, 73728
s_nop 0
buffer_load_dwordx4 v13, s[32:35], s61 offen lds
buffer_load_dwordx4 v14, s[32:35], s61 offen offset:1024 lds
ds_read_b64_tr_b16 v[76:77], v22 offset:128
ds_read_b64_tr_b16 v[78:79], v26 offset:3200
s_waitcnt lgkmcnt(8)
v_mfma_f32_32x32x16_bf16 a[176:191], v[60:63], v[224:227], a[176:191]
s_add_u32 s72, s61, 18432
buffer_load_dwordx4 v13, s[32:35], s72 offen offset:2048 lds
s_add_u32 s72, s61, 18432
buffer_load_dwordx4 v14, s[32:35], s72 offen offset:3072 lds
ds_read_b64_tr_b16 v[56:57], v20 offset:6144
ds_read_b64_tr_b16 v[58:59], v24 offset:9216
s_waitcnt lgkmcnt(8)
v_mfma_f32_32x32x16_bf16 a[192:207], v[64:67], v[224:227], a[192:207]
s_add_u32 m0, s83, 77824
s_add_u32 s72, s61, 40960
buffer_load_dwordx4 v13, s[32:35], s72 offen lds
s_add_u32 s72, s61, 40960
buffer_load_dwordx4 v14, s[32:35], s72 offen offset:1024 lds
ds_read_b64_tr_b16 v[60:61], v21 offset:6144
ds_read_b64_tr_b16 v[62:63], v25 offset:9216
s_waitcnt lgkmcnt(8)
v_mfma_f32_32x32x16_bf16 a[208:223], v[68:71], v[224:227], a[208:223]
v_fma_f32 v240, v240, s60, -v29
v_fma_f32 v241, v241, s60, -v29
v_exp_f32 v240, v240
v_exp_f32 v241, v241
v_fma_f32 v242, v242, s60, -v29
v_fma_f32 v243, v243, s60, -v29
v_exp_f32 v242, v242
v_exp_f32 v243, v243
ds_read_b64_tr_b16 v[64:65], v20 offset:6272
ds_read_b64_tr_b16 v[66:67], v24 offset:9344
s_waitcnt lgkmcnt(8)
v_mfma_f32_32x32x16_bf16 a[224:239], v[72:75], v[224:227], a[224:239]
v_add_f32 v30, v30, v240
v_add_f32 v30, v30, v241
v_cvt_pk_bf16_f32 v240, v240, v241
v_fma_f32 v244, v244, s60, -v29
v_fma_f32 v245, v245, s60, -v29
v_exp_f32 v244, v244
v_exp_f32 v245, v245
ds_read_b64_tr_b16 v[68:69], v22 offset:6144
ds_read_b64_tr_b16 v[70:71], v26 offset:9216
s_waitcnt lgkmcnt(8)
v_mfma_f32_32x32x16_bf16 a[240:255], v[76:79], v[224:227], a[240:255]
v_add_f32 v30, v30, v242
v_add_f32 v30, v30, v243
v_cvt_pk_bf16_f32 v241, v242, v243
v_fma_f32 v246, v246, s60, -v29
v_fma_f32 v247, v247, s60, -v29
v_exp_f32 v246, v246
v_exp_f32 v247, v247
ds_read_b64_tr_b16 v[72:73], v23 offset:6144
ds_read_b64_tr_b16 v[74:75], v27 offset:9216
s_waitcnt lgkmcnt(8)
v_mfma_f32_32x32x16_bf16 a[160:175], v[56:59], v[228:231], a[160:175]
v_add_f32 v30, v30, v244
v_add_f32 v30, v30, v245
v_cvt_pk_bf16_f32 v242, v244, v245
v_fma_f32 v248, v248, s60, -v29
v_fma_f32 v249, v249, s60, -v29
v_exp_f32 v248, v248
v_exp_f32 v249, v249
ds_read_b64_tr_b16 v[76:77], v22 offset:6272
ds_read_b64_tr_b16 v[78:79], v26 offset:9344
s_waitcnt lgkmcnt(8)
v_mfma_f32_32x32x16_bf16 a[176:191], v[60:63], v[228:231], a[176:191]
v_add_f32 v30, v30, v246
v_add_f32 v30, v30, v247
v_cvt_pk_bf16_f32 v243, v246, v247
v_fma_f32 v250, v250, s60, -v29
v_fma_f32 v251, v251, s60, -v29
v_exp_f32 v250, v250
v_exp_f32 v251, v251
v_add_u32 v20, 24576, v16
v_xad_u32 v21, v20, 64, s74
v_xad_u32 v22, v20, 64, s75
v_add_u32 v23, s81, v20
v_xor_b32 v24, 16, v20
v_xor_b32 v25, 16, v21
v_xor_b32 v26, 16, v22
v_xor_b32 v27, 16, v23
ds_read_b64_tr_b16 v[56:57], v20
ds_read_b64_tr_b16 v[58:59], v24 offset:3072
s_waitcnt lgkmcnt(8)
v_mfma_f32_32x32x16_bf16 a[192:207], v[64:67], v[228:231], a[192:207]
v_add_f32 v30, v30, v248
v_add_f32 v30, v30, v249
v_cvt_pk_bf16_f32 v244, v248, v249
v_fma_f32 v252, v252, s60, -v29
v_fma_f32 v253, v253, s60, -v29
v_exp_f32 v252, v252
v_exp_f32 v253, v253
ds_read_b64_tr_b16 v[60:61], v21
ds_read_b64_tr_b16 v[62:63], v25 offset:3072
s_waitcnt lgkmcnt(8)
v_mfma_f32_32x32x16_bf16 a[208:223], v[68:71], v[228:231], a[208:223]
v_add_f32 v30, v30, v250
v_add_f32 v30, v30, v251
v_cvt_pk_bf16_f32 v245, v250, v251
v_fma_f32 v254, v254, s60, -v29
v_fma_f32 v255, v255, s60, -v29
v_exp_f32 v254, v254
v_exp_f32 v255, v255
ds_read_b64_tr_b16 v[64:65], v20 offset:128
ds_read_b64_tr_b16 v[66:67], v24 offset:3200
s_waitcnt lgkmcnt(8)
v_mfma_f32_32x32x16_bf16 a[224:239], v[72:75], v[228:231], a[224:239]
v_add_f32 v30, v30, v252
v_add_f32 v30, v30, v253
v_cvt_pk_bf16_f32 v246, v252, v253
v_add_f32 v30, v30, v254
v_add_f32 v30, v30, v255
v_cvt_pk_bf16_f32 v247, v254, v255
ds_read_b64_tr_b16 v[68:69], v22
ds_read_b64_tr_b16 v[70:71], v26 offset:3072
s_waitcnt lgkmcnt(8)
v_mfma_f32_32x32x16_bf16 a[240:255], v[76:79], v[228:231], a[240:255]
v_mov_b32 v32, v30
v_mov_b32 v33, v30
s_nop 1
v_permlane32_swap_b32 v32, v33
v_add_f32 v30, v32, v33
v_lshrrev_b32 v34, 2, v48
s_lshl_b32 s72, s58, 8
s_add_u32 s72, s72, 161792
v_add_u32 v34, s72, v34
ds_write_b32 v34, v30
s_waitcnt lgkmcnt(0)
s_barrier
ds_read_b64_tr_b16 v[72:73], v23
ds_read_b64_tr_b16 v[74:75], v27 offset:3072
v_mfma_f32_32x32x16_bf16 a[160:175], v[56:59], v[240:243], a[160:175]
s_add_u32 s61, s59, 2
s_cmp_ge_u32 s61, 10
s_cselect_b32 s73, 10, 0
s_sub_u32 s61, s61, s73
s_lshl_b32 s61, s61, 7
s_add_u32 s61, s61, s88
s_add_u32 s61, s61, 245760
s_add_u32 m0, s83, 98304
s_nop 0
buffer_load_dwordx4 v13, s[32:35], s61 offen lds
ds_read_b64_tr_b16 v[76:77], v22 offset:128
ds_read_b64_tr_b16 v[78:79], v26 offset:3200
v_mfma_f32_32x32x16_bf16 a[176:191], v[60:63], v[240:243], a[176:191]
buffer_load_dwordx4 v14, s[32:35], s61 offen offset:1024 lds
ds_read_b64_tr_b16 v[56:57], v20 offset:6144
ds_read_b64_tr_b16 v[58:59], v24 offset:9216
v_mfma_f32_32x32x16_bf16 a[192:207], v[64:67], v[240:243], a[192:207]
s_add_u32 s72, s61, 18432
buffer_load_dwordx4 v13, s[32:35], s72 offen offset:2048 lds
ds_read_b64_tr_b16 v[60:61], v21 offset:6144
ds_read_b64_tr_b16 v[62:63], v25 offset:9216
v_mfma_f32_32x32x16_bf16 a[208:223], v[68:71], v[240:243], a[208:223]
s_add_u32 s72, s61, 18432
buffer_load_dwordx4 v14, s[32:35], s72 offen offset:3072 lds
ds_read_b64_tr_b16 v[64:65], v20 offset:6272
ds_read_b64_tr_b16 v[66:67], v24 offset:9344
s_waitcnt lgkmcnt(8)
v_mfma_f32_32x32x16_bf16 a[224:239], v[72:75], v[240:243], a[224:239]
s_add_u32 m0, s83, 102400
s_add_u32 s72, s61, 40960
buffer_load_dwordx4 v13, s[32:35], s72 offen lds
ds_read_b64_tr_b16 v[68:69], v22 offset:6144
ds_read_b64_tr_b16 v[70:71], v26 offset:9216
s_waitcnt lgkmcnt(8)
v_mfma_f32_32x32x16_bf16 a[240:255], v[76:79], v[240:243], a[240:255]
s_add_u32 s72, s61, 40960
buffer_load_dwordx4 v14, s[32:35], s72 offen offset:1024 lds
ds_read_b64_tr_b16 v[72:73], v23 offset:6144
ds_read_b64_tr_b16 v[74:75], v27 offset:9216
s_waitcnt lgkmcnt(8)
v_mfma_f32_32x32x16_bf16 a[160:175], v[56:59], v[244:247], a[160:175]
ds_read_b64_tr_b16 v[76:77], v22 offset:6272
ds_read_b64_tr_b16 v[78:79], v26 offset:9344
s_waitcnt lgkmcnt(8)
v_mfma_f32_32x32x16_bf16 a[176:191], v[60:63], v[244:247], a[176:191]
s_waitcnt lgkmcnt(6)
v_mfma_f32_32x32x16_bf16 a[192:207], v[64:67], v[244:247], a[192:207]
s_waitcnt lgkmcnt(4)
v_mfma_f32_32x32x16_bf16 a[208:223], v[68:71], v[244:247], a[208:223]
s_waitcnt lgkmcnt(2)
v_mfma_f32_32x32x16_bf16 a[224:239], v[72:75], v[244:247], a[224:239]
s_waitcnt lgkmcnt(0)
v_mfma_f32_32x32x16_bf16 a[240:255], v[76:79], v[244:247], a[240:255]
s_barrier
v_add_u32 v44, 0, v51
s_nop 5
ds_write_b128 v44, a[208:211]
ds_write_b128 v44, a[212:215] offset:1024
ds_write_b128 v44, a[216:219] offset:2048
ds_write_b128 v44, a[220:223] offset:3072
ds_write_b128 v44, a[224:227] offset:4096
ds_write_b128 v44, a[228:231] offset:5120
ds_write_b128 v44, a[232:235] offset:6144
ds_write_b128 v44, a[236:239] offset:7168
ds_write_b128 v44, a[240:243] offset:8192
ds_write_b128 v44, a[244:247] offset:9216
ds_write_b128 v44, a[248:251] offset:10240
ds_write_b128 v44, a[252:255] offset:11264
s_waitcnt lgkmcnt(0)
s_barrier
v_add_u32 v44, 0, v55
v_lshrrev_b32 v45, 2, v48
s_lshl_b32 s72, s58, 8
s_xor_b32 s72, s72, 512
s_add_u32 s72, s72, 161792
v_add_u32 v45, s72, v45
ds_read_b32 v46, v45
ds_read_b128 v[192:195], v44
ds_read_b128 v[196:199], v44 offset:1024
ds_read_b128 v[200:203], v44 offset:2048
ds_read_b128 v[204:207], v44 offset:3072
ds_read_b128 v[208:211], v44 offset:4096
ds_read_b128 v[212:215], v44 offset:5120
ds_read_b128 v[216:219], v44 offset:6144
ds_read_b128 v[220:223], v44 offset:7168
ds_read_b128 v[224:227], v44 offset:8192
ds_read_b128 v[228:231], v44 offset:9216
ds_read_b128 v[232:235], v44 offset:10240
ds_read_b128 v[236:239], v44 offset:11264
s_waitcnt lgkmcnt(12)
v_add_f32 v31, v30, v46
v_rcp_f32 v31, v31
v_accvgpr_read_b32 v32, a160
v_accvgpr_read_b32 v33, a161
v_accvgpr_read_b32 v34, a162
v_accvgpr_read_b32 v35, a163
v_accvgpr_read_b32 v36, a164
v_accvgpr_read_b32 v37, a165
v_accvgpr_read_b32 v38, a166
v_accvgpr_read_b32 v39, a167
s_waitcnt lgkmcnt(10)
v_pk_add_f32 v[32:33], v[32:33], v[192:193]
v_pk_add_f32 v[34:35], v[34:35], v[194:195]
v_pk_add_f32 v[36:37], v[36:37], v[196:197]
v_pk_add_f32 v[38:39], v[38:39], v[198:199]
v_pk_mul_f32 v[32:33], v[32:33], v[30:31] op_sel:[0,1] op_sel_hi:[1,1]
v_pk_mul_f32 v[34:35], v[34:35], v[30:31] op_sel:[0,1] op_sel_hi:[1,1]
v_pk_mul_f32 v[36:37], v[36:37], v[30:31] op_sel:[0,1] op_sel_hi:[1,1]
v_pk_mul_f32 v[38:39], v[38:39], v[30:31] op_sel:[0,1] op_sel_hi:[1,1]
v_cvt_pk_bf16_f32 v40, v32, v33
v_cvt_pk_bf16_f32 v41, v34, v35
v_cvt_pk_bf16_f32 v42, v36, v37
v_cvt_pk_bf16_f32 v43, v38, v39
ds_write_b128 v44, v[40:43]
v_accvgpr_read_b32 v32, a168
v_accvgpr_read_b32 v33, a169
v_accvgpr_read_b32 v34, a170
v_accvgpr_read_b32 v35, a171
v_accvgpr_read_b32 v36, a172
v_accvgpr_read_b32 v37, a173
v_accvgpr_read_b32 v38, a174
v_accvgpr_read_b32 v39, a175
s_waitcnt lgkmcnt(9)
v_pk_add_f32 v[32:33], v[32:33], v[200:201]
v_pk_add_f32 v[34:35], v[34:35], v[202:203]
v_pk_add_f32 v[36:37], v[36:37], v[204:205]
v_pk_add_f32 v[38:39], v[38:39], v[206:207]
v_pk_mul_f32 v[32:33], v[32:33], v[30:31] op_sel:[0,1] op_sel_hi:[1,1]
v_pk_mul_f32 v[34:35], v[34:35], v[30:31] op_sel:[0,1] op_sel_hi:[1,1]
v_pk_mul_f32 v[36:37], v[36:37], v[30:31] op_sel:[0,1] op_sel_hi:[1,1]
v_pk_mul_f32 v[38:39], v[38:39], v[30:31] op_sel:[0,1] op_sel_hi:[1,1]
v_cvt_pk_bf16_f32 v40, v32, v33
v_cvt_pk_bf16_f32 v41, v34, v35
v_cvt_pk_bf16_f32 v42, v36, v37
v_cvt_pk_bf16_f32 v43, v38, v39
ds_write_b128 v44, v[40:43] offset:1024
v_accvgpr_read_b32 v32, a176
v_accvgpr_read_b32 v33, a177
v_accvgpr_read_b32 v34, a178
v_accvgpr_read_b32 v35, a179
v_accvgpr_read_b32 v36, a180
v_accvgpr_read_b32 v37, a181
v_accvgpr_read_b32 v38, a182
v_accvgpr_read_b32 v39, a183
s_waitcnt lgkmcnt(8)
v_pk_add_f32 v[32:33], v[32:33], v[208:209]
v_pk_add_f32 v[34:35], v[34:35], v[210:211]
v_pk_add_f32 v[36:37], v[36:37], v[212:213]
v_pk_add_f32 v[38:39], v[38:39], v[214:215]
v_pk_mul_f32 v[32:33], v[32:33], v[30:31] op_sel:[0,1] op_sel_hi:[1,1]
v_pk_mul_f32 v[34:35], v[34:35], v[30:31] op_sel:[0,1] op_sel_hi:[1,1]
v_pk_mul_f32 v[36:37], v[36:37], v[30:31] op_sel:[0,1] op_sel_hi:[1,1]
v_pk_mul_f32 v[38:39], v[38:39], v[30:31] op_sel:[0,1] op_sel_hi:[1,1]
v_cvt_pk_bf16_f32 v40, v32, v33
v_cvt_pk_bf16_f32 v41, v34, v35
v_cvt_pk_bf16_f32 v42, v36, v37
v_cvt_pk_bf16_f32 v43, v38, v39
ds_write_b128 v44, v[40:43] offset:2048
v_accvgpr_read_b32 v32, a184
v_accvgpr_read_b32 v33, a185
v_accvgpr_read_b32 v34, a186
v_accvgpr_read_b32 v35, a187
v_accvgpr_read_b32 v36, a188
v_accvgpr_read_b32 v37, a189
v_accvgpr_read_b32 v38, a190
v_accvgpr_read_b32 v39, a191
s_waitcnt lgkmcnt(7)
v_pk_add_f32 v[32:33], v[32:33], v[216:217]
v_pk_add_f32 v[34:35], v[34:35], v[218:219]
v_pk_add_f32 v[36:37], v[36:37], v[220:221]
v_pk_add_f32 v[38:39], v[38:39], v[222:223]
v_pk_mul_f32 v[32:33], v[32:33], v[30:31] op_sel:[0,1] op_sel_hi:[1,1]
v_pk_mul_f32 v[34:35], v[34:35], v[30:31] op_sel:[0,1] op_sel_hi:[1,1]
v_pk_mul_f32 v[36:37], v[36:37], v[30:31] op_sel:[0,1] op_sel_hi:[1,1]
v_pk_mul_f32 v[38:39], v[38:39], v[30:31] op_sel:[0,1] op_sel_hi:[1,1]
v_cvt_pk_bf16_f32 v40, v32, v33
v_cvt_pk_bf16_f32 v41, v34, v35
v_cvt_pk_bf16_f32 v42, v36, v37
v_cvt_pk_bf16_f32 v43, v38, v39
ds_write_b128 v44, v[40:43] offset:3072
v_accvgpr_read_b32 v32, a192
v_accvgpr_read_b32 v33, a193
v_accvgpr_read_b32 v34, a194
v_accvgpr_read_b32 v35, a195
v_accvgpr_read_b32 v36, a196
v_accvgpr_read_b32 v37, a197
v_accvgpr_read_b32 v38, a198
v_accvgpr_read_b32 v39, a199
s_waitcnt lgkmcnt(6)
v_pk_add_f32 v[32:33], v[32:33], v[224:225]
v_pk_add_f32 v[34:35], v[34:35], v[226:227]
v_pk_add_f32 v[36:37], v[36:37], v[228:229]
v_pk_add_f32 v[38:39], v[38:39], v[230:231]
v_pk_mul_f32 v[32:33], v[32:33], v[30:31] op_sel:[0,1] op_sel_hi:[1,1]
v_pk_mul_f32 v[34:35], v[34:35], v[30:31] op_sel:[0,1] op_sel_hi:[1,1]
v_pk_mul_f32 v[36:37], v[36:37], v[30:31] op_sel:[0,1] op_sel_hi:[1,1]
v_pk_mul_f32 v[38:39], v[38:39], v[30:31] op_sel:[0,1] op_sel_hi:[1,1]
v_cvt_pk_bf16_f32 v40, v32, v33
v_cvt_pk_bf16_f32 v41, v34, v35
v_cvt_pk_bf16_f32 v42, v36, v37
v_cvt_pk_bf16_f32 v43, v38, v39
ds_write_b128 v44, v[40:43] offset:4096
v_accvgpr_read_b32 v32, a200
v_accvgpr_read_b32 v33, a201
v_accvgpr_read_b32 v34, a202
v_accvgpr_read_b32 v35, a203
v_accvgpr_read_b32 v36, a204
v_accvgpr_read_b32 v37, a205
v_accvgpr_read_b32 v38, a206
v_accvgpr_read_b32 v39, a207
s_waitcnt lgkmcnt(5)
v_pk_add_f32 v[32:33], v[32:33], v[232:233]
v_pk_add_f32 v[34:35], v[34:35], v[234:235]
v_pk_add_f32 v[36:37], v[36:37], v[236:237]
v_pk_add_f32 v[38:39], v[38:39], v[238:239]
v_pk_mul_f32 v[32:33], v[32:33], v[30:31] op_sel:[0,1] op_sel_hi:[1,1]
v_pk_mul_f32 v[34:35], v[34:35], v[30:31] op_sel:[0,1] op_sel_hi:[1,1]
v_pk_mul_f32 v[36:37], v[36:37], v[30:31] op_sel:[0,1] op_sel_hi:[1,1]
v_pk_mul_f32 v[38:39], v[38:39], v[30:31] op_sel:[0,1] op_sel_hi:[1,1]
v_cvt_pk_bf16_f32 v40, v32, v33
v_cvt_pk_bf16_f32 v41, v34, v35
v_cvt_pk_bf16_f32 v42, v36, v37
v_cvt_pk_bf16_f32 v43, v38, v39
ds_write_b128 v44, v[40:43] offset:5120
s_waitcnt lgkmcnt(0)
s_waitcnt vmcnt(12)
s_waitcnt vmcnt(6)
s_barrier
v_add_u32 v44, 0, v50
ds_read_b128 v[80:83], v44 offset:24576
ds_read_b128 v[84:87], v44 offset:25600
ds_read_b128 v[88:91], v44 offset:26624
ds_read_b128 v[92:95], v44 offset:27648
ds_read_b128 v[96:99], v44 offset:28672
ds_read_b128 v[100:103], v44 offset:29696
ds_read_b128 v[104:107], v44
ds_read_b128 v[108:111], v44 offset:1024
ds_read_b128 v[112:115], v44 offset:2048
ds_read_b128 v[116:119], v44 offset:3072
ds_read_b128 v[120:123], v44 offset:4096
ds_read_b128 v[124:127], v44 offset:5120
v_add_u32 v20, 49152, v19
v_xor_b32 v21, 16, v20
ds_read_b64_tr_b16 v[56:57], v20
ds_read_b64_tr_b16 v[58:59], v21 offset:1024
ds_read_b64_tr_b16 v[60:61], v20 offset:2048
ds_read_b64_tr_b16 v[62:63], v21 offset:3072
ds_read_b64_tr_b16 v[64:65], v20 offset:4096
ds_read_b64_tr_b16 v[66:67], v21 offset:5120
ds_read_b64_tr_b16 v[68:69], v20 offset:6144
ds_read_b64_tr_b16 v[70:71], v21 offset:7168
ds_read_b64_tr_b16 v[72:73], v20 offset:8192
ds_read_b64_tr_b16 v[74:75], v21 offset:9216
s_waitcnt lgkmcnt(8)
v_mfma_f32_32x32x16_bf16 a[0:15], v[56:59], v[80:83], a[0:15]
s_add_u32 s61, s59, 3
s_cmp_ge_u32 s61, 10
s_cselect_b32 s73, 10, 0
s_sub_u32 s61, s61, s73
s_lshl_b32 s61, s61, 7
s_add_u32 s61, s61, s88
s_add_u32 s61, s61, 245760
s_add_u32 m0, s83, 122880
s_nop 0
buffer_load_dwordx4 v13, s[32:35], s61 offen lds
ds_read_b64_tr_b16 v[76:77], v20 offset:10240
ds_read_b64_tr_b16 v[78:79], v21 offset:11264
s_waitcnt lgkmcnt(8)
v_mfma_f32_32x32x16_bf16 a[0:15], v[60:63], v[84:87], a[0:15]
buffer_load_dwordx4 v14, s[32:35], s61 offen offset:1024 lds
ds_read_b64_tr_b16 v[56:57], v20 offset:12288
ds_read_b64_tr_b16 v[58:59], v21 offset:13312
s_waitcnt lgkmcnt(8)
v_mfma_f32_32x32x16_bf16 a[0:15], v[64:67], v[88:91], a[0:15]
ds_read_b64_tr_b16 v[60:61], v20 offset:14336
ds_read_b64_tr_b16 v[62:63], v21 offset:15360
s_waitcnt lgkmcnt(8)
v_mfma_f32_32x32x16_bf16 a[0:15], v[68:71], v[92:95], a[0:15]
s_add_u32 s72, s61, 18432
buffer_load_dwordx4 v13, s[32:35], s72 offen offset:2048 lds
ds_read_b64_tr_b16 v[64:65], v20 offset:16384
ds_read_b64_tr_b16 v[66:67], v21 offset:17408
s_waitcnt lgkmcnt(8)
v_mfma_f32_32x32x16_bf16 a[0:15], v[72:75], v[96:99], a[0:15]
ds_read_b64_tr_b16 v[68:69], v20 offset:18432
ds_read_b64_tr_b16 v[70:71], v21 offset:19456
s_waitcnt lgkmcnt(8)
v_mfma_f32_32x32x16_bf16 a[0:15], v[76:79], v[100:103], a[0:15]
s_add_u32 s72, s61, 18432
buffer_load_dwordx4 v14, s[32:35], s72 offen offset:3072 lds
ds_read_b64_tr_b16 v[72:73], v20 offset:20480
ds_read_b64_tr_b16 v[74:75], v21 offset:21504
s_waitcnt lgkmcnt(8)
v_mfma_f32_32x32x16_bf16 a[0:15], v[56:59], v[104:107], a[0:15]
s_add_u32 m0, s83, 126976
s_add_u32 s72, s61, 40960
buffer_load_dwordx4 v13, s[32:35], s72 offen lds
ds_read_b64_tr_b16 v[76:77], v20 offset:22528
ds_read_b64_tr_b16 v[78:79], v21 offset:23552
s_waitcnt lgkmcnt(8)
v_mfma_f32_32x32x16_bf16 a[0:15], v[60:63], v[108:111], a[0:15]
v_add_u32 v20, 73728, v19
v_xor_b32 v21, 16, v20
ds_read_b64_tr_b16 v[56:57], v20
ds_read_b64_tr_b16 v[58:59], v21 offset:1024
s_waitcnt lgkmcnt(8)
v_mfma_f32_32x32x16_bf16 a[0:15], v[64:67], v[112:115], a[0:15]
s_add_u32 s72, s61, 40960
buffer_load_dwordx4 v14, s[32:35], s72 offen offset:1024 lds
ds_read_b64_tr_b16 v[60:61], v20 offset:2048
ds_read_b64_tr_b16 v[62:63], v21 offset:3072
s_waitcnt lgkmcnt(8)
v_mfma_f32_32x32x16_bf16 a[0:15], v[68:71], v[116:119], a[0:15]
ds_read_b64_tr_b16 v[64:65], v20 offset:4096
ds_read_b64_tr_b16 v[66:67], v21 offset:5120
s_waitcnt lgkmcnt(8)
v_mfma_f32_32x32x16_bf16 a[0:15], v[72:75], v[120:123], a[0:15]
v_mov_b32 v249, 0
buffer_load_dwordx2 v[254:255], v249, s[52:55], 0 offen sc1
ds_read_b64_tr_b16 v[68:69], v20 offset:6144
ds_read_b64_tr_b16 v[70:71], v21 offset:7168
s_waitcnt lgkmcnt(8)
v_mfma_f32_32x32x16_bf16 a[0:15], v[76:79], v[124:127], a[0:15]
s_waitcnt vmcnt(7)
s_barrier
ds_read_b64_tr_b16 v[72:73], v20 offset:8192
ds_read_b64_tr_b16 v[74:75], v21 offset:9216
s_waitcnt lgkmcnt(8)
v_mfma_f32_32x32x16_bf16 a[16:31], v[56:59], v[80:83], a[16:31]
s_add_u32 s61, s59, 4
s_cmp_ge_u32 s61, 10
s_cselect_b32 s73, 10, 0
s_sub_u32 s61, s61, s73
s_lshl_b32 s61, s61, 7
s_add_u32 s61, s61, s88
s_add_u32 s61, s61, 245760
s_add_u32 m0, s83, 0
s_nop 0
buffer_load_dwordx4 v13, s[32:35], s61 offen lds
buffer_load_dwordx4 v14, s[32:35], s61 offen offset:1024 lds
ds_read_b64_tr_b16 v[76:77], v20 offset:10240
ds_read_b64_tr_b16 v[78:79], v21 offset:11264
s_waitcnt lgkmcnt(8)
v_mfma_f32_32x32x16_bf16 a[16:31], v[60:63], v[84:87], a[16:31]
s_add_u32 s72, s61, 18432
buffer_load_dwordx4 v13, s[32:35], s72 offen offset:2048 lds
s_add_u32 s72, s61, 18432
buffer_load_dwordx4 v14, s[32:35], s72 offen offset:3072 lds
ds_read_b64_tr_b16 v[56:57], v20 offset:12288
ds_read_b64_tr_b16 v[58:59], v21 offset:13312
s_waitcnt lgkmcnt(8)
v_mfma_f32_32x32x16_bf16 a[16:31], v[64:67], v[88:91], a[16:31]
s_add_u32 m0, s83, 4096
s_add_u32 s72, s61, 40960
buffer_load_dwordx4 v13, s[32:35], s72 offen lds
ds_read_b64_tr_b16 v[60:61], v20 offset:14336
ds_read_b64_tr_b16 v[62:63], v21 offset:15360
s_waitcnt lgkmcnt(8)
v_mfma_f32_32x32x16_bf16 a[16:31], v[68:71], v[92:95], a[16:31]
s_add_u32 s72, s61, 40960
buffer_load_dwordx4 v14, s[32:35], s72 offen offset:1024 lds
s_add_u32 s61, s59, 5
s_cmp_ge_u32 s61, 10
s_cselect_b32 s73, 10, 0
s_sub_u32 s61, s61, s73
s_lshl_b32 s61, s61, 7
s_add_u32 s61, s61, s88
s_add_u32 s61, s61, 245760
s_add_u32 m0, s83, 24576
s_nop 0
buffer_load_dwordx4 v13, s[32:35], s61 offen lds
ds_read_b64_tr_b16 v[64:65], v20 offset:16384
ds_read_b64_tr_b16 v[66:67], v21 offset:17408
s_waitcnt lgkmcnt(8)
v_mfma_f32_32x32x16_bf16 a[16:31], v[72:75], v[96:99], a[16:31]
buffer_load_dwordx4 v14, s[32:35], s61 offen offset:1024 lds
s_add_u32 s72, s61, 18432
buffer_load_dwordx4 v13, s[32:35], s72 offen offset:2048 lds
ds_read_b64_tr_b16 v[68:69], v20 offset:18432
ds_read_b64_tr_b16 v[70:71], v21 offset:19456
s_waitcnt lgkmcnt(8)
v_mfma_f32_32x32x16_bf16 a[16:31], v[76:79], v[100:103], a[16:31]
s_add_u32 s72, s61, 18432
buffer_load_dwordx4 v14, s[32:35], s72 offen offset:3072 lds
ds_read_b64_tr_b16 v[72:73], v20 offset:20480
ds_read_b64_tr_b16 v[74:75], v21 offset:21504
s_waitcnt lgkmcnt(8)
v_mfma_f32_32x32x16_bf16 a[16:31], v[56:59], v[104:107], a[16:31]
s_add_u32 m0, s83, 28672
s_add_u32 s72, s61, 40960
buffer_load_dwordx4 v13, s[32:35], s72 offen lds
s_add_u32 s72, s61, 40960
buffer_load_dwordx4 v14, s[32:35], s72 offen offset:1024 lds
ds_read_b64_tr_b16 v[76:77], v20 offset:22528
ds_read_b64_tr_b16 v[78:79], v21 offset:23552
s_waitcnt lgkmcnt(8)
v_mfma_f32_32x32x16_bf16 a[16:31], v[60:63], v[108:111], a[16:31]
s_add_u32 s61, s59, 6
s_cmp_ge_u32 s61, 10
s_cselect_b32 s73, 10, 0
s_sub_u32 s61, s61, s73
s_lshl_b32 s61, s61, 7
s_add_u32 s61, s61, s88
s_add_u32 s61, s61, 245760
s_add_u32 m0, s83, 49152
s_nop 0
buffer_load_dwordx4 v13, s[32:35], s61 offen lds
buffer_load_dwordx4 v14, s[32:35], s61 offen offset:1024 lds
v_add_u32 v20, 98304, v19
v_xor_b32 v21, 16, v20
ds_read_b64_tr_b16 v[56:57], v20
ds_read_b64_tr_b16 v[58:59], v21 offset:1024
s_waitcnt lgkmcnt(8)
v_mfma_f32_32x32x16_bf16 a[16:31], v[64:67], v[112:115], a[16:31]
s_add_u32 s72, s61, 18432
buffer_load_dwordx4 v13, s[32:35], s72 offen offset:2048 lds
ds_read_b64_tr_b16 v[60:61], v20 offset:2048
ds_read_b64_tr_b16 v[62:63], v21 offset:3072
s_waitcnt lgkmcnt(8)
v_mfma_f32_32x32x16_bf16 a[16:31], v[68:71], v[116:119], a[16:31]
s_add_u32 s72, s61, 18432
buffer_load_dwordx4 v14, s[32:35], s72 offen offset:3072 lds
s_add_u32 m0, s83, 53248
s_add_u32 s72, s61, 40960
buffer_load_dwordx4 v13, s[32:35], s72 offen lds
ds_read_b64_tr_b16 v[64:65], v20 offset:4096
ds_read_b64_tr_b16 v[66:67], v21 offset:5120
s_waitcnt lgkmcnt(8)
v_mfma_f32_32x32x16_bf16 a[16:31], v[72:75], v[120:123], a[16:31]
s_add_u32 s72, s61, 40960
buffer_load_dwordx4 v14, s[32:35], s72 offen offset:1024 lds
v_accvgpr_read_b32 v208, a0
v_accvgpr_read_b32 v209, a1
v_accvgpr_read_b32 v210, a2
v_accvgpr_read_b32 v211, a3
v_accvgpr_read_b32 v212, a4
v_accvgpr_read_b32 v213, a5
v_accvgpr_read_b32 v214, a6
v_accvgpr_read_b32 v215, a7
v_accvgpr_read_b32 v216, a8
v_accvgpr_read_b32 v217, a9
v_accvgpr_read_b32 v218, a10
v_accvgpr_read_b32 v219, a11
v_accvgpr_read_b32 v220, a12
v_accvgpr_read_b32 v221, a13
v_accvgpr_read_b32 v222, a14
v_accvgpr_read_b32 v223, a15
ds_read_b64_tr_b16 v[68:69], v20 offset:6144
ds_read_b64_tr_b16 v[70:71], v21 offset:7168
s_waitcnt lgkmcnt(8)
v_mfma_f32_32x32x16_bf16 a[16:31], v[76:79], v[124:127], a[16:31]
v_cvt_pk_bf16_f32 v128, v208, v209
v_cvt_pk_bf16_f32 v129, v210, v211
v_cvt_pk_bf16_f32 v130, v212, v213
v_cvt_pk_bf16_f32 v131, v214, v215
v_cvt_pk_bf16_f32 v132, v216, v217
v_cvt_pk_bf16_f32 v133, v218, v219
v_cvt_pk_bf16_f32 v134, v220, v221
v_cvt_pk_bf16_f32 v135, v222, v223
s_waitcnt vmcnt(19)
s_barrier
ds_read_b64_tr_b16 v[72:73], v20 offset:8192
ds_read_b64_tr_b16 v[74:75], v21 offset:9216
s_waitcnt lgkmcnt(8)
v_mfma_f32_32x32x16_bf16 a[32:47], v[56:59], v[80:83], a[32:47]
s_add_u32 s61, s59, 7
s_cmp_ge_u32 s61, 10
s_cselect_b32 s73, 10, 0
s_sub_u32 s61, s61, s73
s_lshl_b32 s61, s61, 7
s_add_u32 s61, s61, s88
s_add_u32 s61, s61, 245760
s_add_u32 m0, s83, 73728
s_nop 0
buffer_load_dwordx4 v13, s[32:35], s61 offen lds
ds_read_b64_tr_b16 v[76:77], v20 offset:10240
ds_read_b64_tr_b16 v[78:79], v21 offset:11264
s_waitcnt lgkmcnt(8)
v_mfma_f32_32x32x16_bf16 a[32:47], v[60:63], v[84:87], a[32:47]
buffer_load_dwordx4 v14, s[32:35], s61 offen offset:1024 lds
ds_read_b64_tr_b16 v[56:57], v20 offset:12288
ds_read_b64_tr_b16 v[58:59], v21 offset:13312
s_waitcnt lgkmcnt(8)
v_mfma_f32_32x32x16_bf16 a[32:47], v[64:67], v[88:91], a[32:47]
ds_read_b64_tr_b16 v[60:61], v20 offset:14336
ds_read_b64_tr_b16 v[62:63], v21 offset:15360
s_waitcnt lgkmcnt(8)
v_mfma_f32_32x32x16_bf16 a[32:47], v[68:71], v[92:95], a[32:47]
s_add_u32 s72, s61, 18432
buffer_load_dwordx4 v13, s[32:35], s72 offen offset:2048 lds
ds_read_b64_tr_b16 v[64:65], v20 offset:16384
ds_read_b64_tr_b16 v[66:67], v21 offset:17408
s_waitcnt lgkmcnt(8)
v_mfma_f32_32x32x16_bf16 a[32:47], v[72:75], v[96:99], a[32:47]
s_add_u32 s72, s61, 18432
buffer_load_dwordx4 v14, s[32:35], s72 offen offset:3072 lds
ds_read_b64_tr_b16 v[68:69], v20 offset:18432
ds_read_b64_tr_b16 v[70:71], v21 offset:19456
s_waitcnt lgkmcnt(8)
v_mfma_f32_32x32x16_bf16 a[32:47], v[76:79], v[100:103], a[32:47]
ds_read_b64_tr_b16 v[72:73], v20 offset:20480
ds_read_b64_tr_b16 v[74:75], v21 offset:21504
s_waitcnt lgkmcnt(8)
v_mfma_f32_32x32x16_bf16 a[32:47], v[56:59], v[104:107], a[32:47]
s_add_u32 m0, s83, 77824
s_add_u32 s72, s61, 40960
buffer_load_dwordx4 v13, s[32:35], s72 offen lds
ds_read_b64_tr_b16 v[76:77], v20 offset:22528
ds_read_b64_tr_b16 v[78:79], v21 offset:23552
s_waitcnt lgkmcnt(8)
v_mfma_f32_32x32x16_bf16 a[32:47], v[60:63], v[108:111], a[32:47]
s_add_u32 s72, s61, 40960
buffer_load_dwordx4 v14, s[32:35], s72 offen offset:1024 lds
v_add_u32 v20, 122880, v19
v_xor_b32 v21, 16, v20
ds_read_b64_tr_b16 v[56:57], v20
ds_read_b64_tr_b16 v[58:59], v21 offset:1024
s_waitcnt lgkmcnt(8)
v_mfma_f32_32x32x16_bf16 a[32:47], v[64:67], v[112:115], a[32:47]
ds_read_b64_tr_b16 v[60:61], v20 offset:2048
ds_read_b64_tr_b16 v[62:63], v21 offset:3072
s_waitcnt lgkmcnt(8)
v_mfma_f32_32x32x16_bf16 a[32:47], v[68:71], v[116:119], a[32:47]
v_accvgpr_read_b32 v224, a16
v_accvgpr_read_b32 v225, a17
v_accvgpr_read_b32 v226, a18
v_accvgpr_read_b32 v227, a19
v_accvgpr_read_b32 v228, a20
v_accvgpr_read_b32 v229, a21
v_accvgpr_read_b32 v230, a22
v_accvgpr_read_b32 v231, a23
v_accvgpr_read_b32 v232, a24
v_accvgpr_read_b32 v233, a25
v_accvgpr_read_b32 v234, a26
v_accvgpr_read_b32 v235, a27
v_accvgpr_read_b32 v236, a28
v_accvgpr_read_b32 v237, a29
v_accvgpr_read_b32 v238, a30
v_accvgpr_read_b32 v239, a31
ds_read_b64_tr_b16 v[64:65], v20 offset:4096
ds_read_b64_tr_b16 v[66:67], v21 offset:5120
s_waitcnt lgkmcnt(8)
v_mfma_f32_32x32x16_bf16 a[32:47], v[72:75], v[120:123], a[32:47]
v_cvt_pk_bf16_f32 v136, v224, v225
v_cvt_pk_bf16_f32 v137, v226, v227
v_cvt_pk_bf16_f32 v138, v228, v229
v_cvt_pk_bf16_f32 v139, v230, v231
v_cvt_pk_bf16_f32 v140, v232, v233
v_cvt_pk_bf16_f32 v141, v234, v235
v_cvt_pk_bf16_f32 v142, v236, v237
v_cvt_pk_bf16_f32 v143, v238, v239
ds_read_b64_tr_b16 v[68:69], v20 offset:6144
ds_read_b64_tr_b16 v[70:71], v21 offset:7168
s_waitcnt lgkmcnt(8)
v_mfma_f32_32x32x16_bf16 a[32:47], v[76:79], v[124:127], a[32:47]
s_waitcnt vmcnt(18)
s_barrier
ds_read_b64_tr_b16 v[72:73], v20 offset:8192
ds_read_b64_tr_b16 v[74:75], v21 offset:9216
s_waitcnt lgkmcnt(8)
v_mfma_f32_32x32x16_bf16 a[48:63], v[56:59], v[80:83], a[48:63]
s_add_u32 s61, s59, 8
s_cmp_ge_u32 s61, 10
s_cselect_b32 s73, 10, 0
s_sub_u32 s61, s61, s73
s_lshl_b32 s61, s61, 7
s_add_u32 s61, s61, s88
s_add_u32 s61, s61, 245760
s_add_u32 m0, s83, 98304
s_nop 0
buffer_load_dwordx4 v13, s[32:35], s61 offen lds
ds_read_b64_tr_b16 v[76:77], v20 offset:10240
ds_read_b64_tr_b16 v[78:79], v21 offset:11264
s_waitcnt lgkmcnt(8)
v_mfma_f32_32x32x16_bf16 a[48:63], v[60:63], v[84:87], a[48:63]
buffer_load_dwordx4 v14, s[32:35], s61 offen offset:1024 lds
ds_read_b64_tr_b16 v[56:57], v20 offset:12288
ds_read_b64_tr_b16 v[58:59], v21 offset:13312
s_waitcnt lgkmcnt(8)
v_mfma_f32_32x32x16_bf16 a[48:63], v[64:67], v[88:91], a[48:63]
s_add_u32 s72, s61, 18432
buffer_load_dwordx4 v13, s[32:35], s72 offen offset:2048 lds
ds_read_b64_tr_b16 v[60:61], v20 offset:14336
ds_read_b64_tr_b16 v[62:63], v21 offset:15360
s_waitcnt lgkmcnt(8)
v_mfma_f32_32x32x16_bf16 a[48:63], v[68:71], v[92:95], a[48:63]
s_add_u32 s72, s61, 18432
buffer_load_dwordx4 v14, s[32:35], s72 offen offset:3072 lds
ds_read_b64_tr_b16 v[64:65], v20 offset:16384
ds_read_b64_tr_b16 v[66:67], v21 offset:17408
s_waitcnt lgkmcnt(8)
v_mfma_f32_32x32x16_bf16 a[48:63], v[72:75], v[96:99], a[48:63]
s_add_u32 m0, s83, 102400
s_add_u32 s72, s61, 40960
buffer_load_dwordx4 v13, s[32:35], s72 offen lds
ds_read_b64_tr_b16 v[68:69], v20 offset:18432
ds_read_b64_tr_b16 v[70:71], v21 offset:19456
s_waitcnt lgkmcnt(8)
v_mfma_f32_32x32x16_bf16 a[48:63], v[76:79], v[100:103], a[48:63]
s_add_u32 s72, s61, 40960
buffer_load_dwordx4 v14, s[32:35], s72 offen offset:1024 lds
ds_read_b64_tr_b16 v[72:73], v20 offset:20480
ds_read_b64_tr_b16 v[74:75], v21 offset:21504
s_waitcnt lgkmcnt(8)
v_mfma_f32_32x32x16_bf16 a[48:63], v[56:59], v[104:107], a[48:63]
v_readfirstlane_b32 s62, v254
s_nop 1
s_cmp_lg_u32 s62, 0
s_cbranch_scc1 L_nok
s_mov_b32 s63, 0
v_mov_b32 v32, 0
L_nonce:
s_add_u32 s63, s63, 1
s_cmp_gt_u32 s63, 100000
s_cbranch_scc1 L_nok
buffer_load_dwordx2 v[254:255], v32, s[52:55], 0 offen sc1
s_waitcnt vmcnt(0)
v_readfirstlane_b32 s62, v254
s_nop 1
s_cmp_eq_u32 s62, 0
s_cbranch_scc1 L_nonce
L_nok:
s_mov_b32 s64, s62
ds_read_b64_tr_b16 v[76:77], v20 offset:22528
ds_read_b64_tr_b16 v[78:79], v21 offset:23552
s_waitcnt lgkmcnt(8)
v_mfma_f32_32x32x16_bf16 a[48:63], v[60:63], v[108:111], a[48:63]
v_accvgpr_read_b32 v208, a32
v_accvgpr_read_b32 v209, a33
v_accvgpr_read_b32 v210, a34
v_accvgpr_read_b32 v211, a35
v_accvgpr_read_b32 v212, a36
v_accvgpr_read_b32 v213, a37
v_accvgpr_read_b32 v214, a38
v_accvgpr_read_b32 v215, a39
v_accvgpr_read_b32 v216, a40
v_accvgpr_read_b32 v217, a41
v_accvgpr_read_b32 v218, a42
v_accvgpr_read_b32 v219, a43
v_accvgpr_read_b32 v220, a44
v_accvgpr_read_b32 v221, a45
v_accvgpr_read_b32 v222, a46
v_accvgpr_read_b32 v223, a47
v_add_u32 v20, 0, v19
v_xor_b32 v21, 16, v20
ds_read_b64_tr_b16 v[56:57], v20
ds_read_b64_tr_b16 v[58:59], v21 offset:1024
s_waitcnt lgkmcnt(8)
v_mfma_f32_32x32x16_bf16 a[48:63], v[64:67], v[112:115], a[48:63]
v_cvt_pk_bf16_f32 v144, v208, v209
v_cvt_pk_bf16_f32 v145, v210, v211
v_cvt_pk_bf16_f32 v146, v212, v213
v_cvt_pk_bf16_f32 v147, v214, v215
v_cvt_pk_bf16_f32 v148, v216, v217
v_cvt_pk_bf16_f32 v149, v218, v219
v_cvt_pk_bf16_f32 v150, v220, v221
v_cvt_pk_bf16_f32 v151, v222, v223
ds_read_b64_tr_b16 v[60:61], v20 offset:2048
ds_read_b64_tr_b16 v[62:63], v21 offset:3072
s_waitcnt lgkmcnt(8)
v_mfma_f32_32x32x16_bf16 a[48:63], v[68:71], v[116:119], a[48:63]
s_add_u32 s72, s59, 0
s_cmp_ge_u32 s72, 10
s_cselect_b32 s73, 10, 0
s_sub_u32 s72, s72, s73
s_lshl_b32 s72, s72, 13
s_add_u32 s72, s72, s66
buffer_store_dwordx4 v[128:131], v48, s[40:43], s72 offen sc1
buffer_store_dwordx4 v[132:135], v48, s[40:43], s72 offen offset:1024 sc1
ds_read_b64_tr_b16 v[64:65], v20 offset:4096
ds_read_b64_tr_b16 v[66:67], v21 offset:5120
s_waitcnt lgkmcnt(8)
v_mfma_f32_32x32x16_bf16 a[48:63], v[72:75], v[120:123], a[48:63]
s_add_u32 s72, s59, 1
s_cmp_ge_u32 s72, 10
s_cselect_b32 s73, 10, 0
s_sub_u32 s72, s72, s73
s_lshl_b32 s72, s72, 13
s_add_u32 s72, s72, s66
buffer_store_dwordx4 v[136:139], v48, s[40:43], s72 offen sc1
buffer_store_dwordx4 v[140:143], v48, s[40:43], s72 offen offset:1024 sc1
ds_read_b64_tr_b16 v[68:69], v20 offset:6144
ds_read_b64_tr_b16 v[70:71], v21 offset:7168
s_waitcnt lgkmcnt(8)
v_mfma_f32_32x32x16_bf16 a[48:63], v[76:79], v[124:127], a[48:63]
s_waitcnt vmcnt(22)
s_barrier
ds_read_b64_tr_b16 v[72:73], v20 offset:8192
ds_read_b64_tr_b16 v[74:75], v21 offset:9216
s_waitcnt lgkmcnt(8)
v_mfma_f32_32x32x16_bf16 a[64:79], v[56:59], v[80:83], a[64:79]
s_add_u32 s61, s59, 9
s_cmp_ge_u32 s61, 10
s_cselect_b32 s73, 10, 0
s_sub_u32 s61, s61, s73
s_lshl_b32 s61, s61, 7
s_add_u32 s61, s61, s88
s_add_u32 s61, s61, 245760
s_add_u32 m0, s83, 122880
s_nop 0
buffer_load_dwordx4 v13, s[32:35], s61 offen lds
ds_read_b64_tr_b16 v[76:77], v20 offset:10240
ds_read_b64_tr_b16 v[78:79], v21 offset:11264
s_waitcnt lgkmcnt(8)
v_mfma_f32_32x32x16_bf16 a[64:79], v[60:63], v[84:87], a[64:79]
buffer_load_dwordx4 v14, s[32:35], s61 offen offset:1024 lds
ds_read_b64_tr_b16 v[56:57], v20 offset:12288
ds_read_b64_tr_b16 v[58:59], v21 offset:13312
s_waitcnt lgkmcnt(8)
v_mfma_f32_32x32x16_bf16 a[64:79], v[64:67], v[88:91], a[64:79]
s_add_u32 s72, s61, 18432
buffer_load_dwordx4 v13, s[32:35], s72 offen offset:2048 lds
ds_read_b64_tr_b16 v[60:61], v20 offset:14336
ds_read_b64_tr_b16 v[62:63], v21 offset:15360
s_waitcnt lgkmcnt(8)
v_mfma_f32_32x32x16_bf16 a[64:79], v[68:71], v[92:95], a[64:79]
s_add_u32 s72, s61, 18432
buffer_load_dwordx4 v14, s[32:35], s72 offen offset:3072 lds
ds_read_b64_tr_b16 v[64:65], v20 offset:16384
ds_read_b64_tr_b16 v[66:67], v21 offset:17408
s_waitcnt lgkmcnt(8)
v_mfma_f32_32x32x16_bf16 a[64:79], v[72:75], v[96:99], a[64:79]
s_add_u32 m0, s83, 126976
s_add_u32 s72, s61, 40960
buffer_load_dwordx4 v13, s[32:35], s72 offen lds
ds_read_b64_tr_b16 v[68:69], v20 offset:18432
ds_read_b64_tr_b16 v[70:71], v21 offset:19456
s_waitcnt lgkmcnt(8)
v_mfma_f32_32x32x16_bf16 a[64:79], v[76:79], v[100:103], a[64:79]
ds_read_b64_tr_b16 v[72:73], v20 offset:20480
ds_read_b64_tr_b16 v[74:75], v21 offset:21504
s_waitcnt lgkmcnt(8)
v_mfma_f32_32x32x16_bf16 a[64:79], v[56:59], v[104:107], a[64:79]
s_add_u32 s72, s61, 40960
buffer_load_dwordx4 v14, s[32:35], s72 offen offset:1024 lds
ds_read_b64_tr_b16 v[76:77], v20 offset:22528
ds_read_b64_tr_b16 v[78:79], v21 offset:23552
s_waitcnt lgkmcnt(8)
v_mfma_f32_32x32x16_bf16 a[64:79], v[60:63], v[108:111], a[64:79]
v_accvgpr_read_b32 v224, a48
v_accvgpr_read_b32 v225, a49
v_accvgpr_read_b32 v226, a50
v_accvgpr_read_b32 v227, a51
v_accvgpr_read_b32 v228, a52
v_accvgpr_read_b32 v229, a53
v_accvgpr_read_b32 v230, a54
v_accvgpr_read_b32 v231, a55
v_accvgpr_read_b32 v232, a56
v_accvgpr_read_b32 v233, a57
v_accvgpr_read_b32 v234, a58
v_accvgpr_read_b32 v235, a59
v_accvgpr_read_b32 v236, a60
v_accvgpr_read_b32 v237, a61
v_accvgpr_read_b32 v238, a62
v_accvgpr_read_b32 v239, a63
v_add_u32 v20, 24576, v19
v_xor_b32 v21, 16, v20
ds_read_b64_tr_b16 v[56:57], v20
ds_read_b64_tr_b16 v[58:59], v21 offset:1024
s_waitcnt lgkmcnt(8)
v_mfma_f32_32x32x16_bf16 a[64:79], v[64:67], v[112:115], a[64:79]
v_cvt_pk_bf16_f32 v152, v224, v225
v_cvt_pk_bf16_f32 v153, v226, v227
v_cvt_pk_bf16_f32 v154, v228, v229
v_cvt_pk_bf16_f32 v155, v230, v231
v_cvt_pk_bf16_f32 v156, v232, v233
v_cvt_pk_bf16_f32 v157, v234, v235
v_cvt_pk_bf16_f32 v158, v236, v237
v_cvt_pk_bf16_f32 v159, v238, v239
ds_read_b64_tr_b16 v[60:61], v20 offset:2048
ds_read_b64_tr_b16 v[62:63], v21 offset:3072
s_waitcnt lgkmcnt(8)
v_mfma_f32_32x32x16_bf16 a[64:79], v[68:71], v[116:119], a[64:79]
s_add_u32 s72, s59, 2
s_cmp_ge_u32 s72, 10
s_cselect_b32 s73, 10, 0
s_sub_u32 s72, s72, s73
s_lshl_b32 s72, s72, 13
s_add_u32 s72, s72, s66
buffer_store_dwordx4 v[144:147], v48, s[40:43], s72 offen sc1
buffer_store_dwordx4 v[148:151], v48, s[40:43], s72 offen offset:1024 sc1
ds_read_b64_tr_b16 v[64:65], v20 offset:4096
ds_read_b64_tr_b16 v[66:67], v21 offset:5120
s_waitcnt lgkmcnt(8)
v_mfma_f32_32x32x16_bf16 a[64:79], v[72:75], v[120:123], a[64:79]
s_add_u32 s72, s59, 3
s_cmp_ge_u32 s72, 10
s_cselect_b32 s73, 10, 0
s_sub_u32 s72, s72, s73
s_lshl_b32 s72, s72, 13
s_add_u32 s72, s72, s66
buffer_store_dwordx4 v[152:155], v48, s[40:43], s72 offen sc1
buffer_store_dwordx4 v[156:159], v48, s[40:43], s72 offen offset:1024 sc1
ds_read_b64_tr_b16 v[68:69], v20 offset:6144
ds_read_b64_tr_b16 v[70:71], v21 offset:7168
s_waitcnt lgkmcnt(8)
v_mfma_f32_32x32x16_bf16 a[64:79], v[76:79], v[124:127], a[64:79]
s_waitcnt vmcnt(26)
s_barrier
ds_read_b64_tr_b16 v[72:73], v20 offset:8192
ds_read_b64_tr_b16 v[74:75], v21 offset:9216
s_waitcnt lgkmcnt(8)
v_mfma_f32_32x32x16_bf16 a[80:95], v[56:59], v[80:83], a[80:95]
s_nop 5
v_accvgpr_read_b32 v208, a64
v_accvgpr_read_b32 v209, a65
v_accvgpr_read_b32 v210, a66
v_accvgpr_read_b32 v211, a67
v_accvgpr_read_b32 v212, a68
v_accvgpr_read_b32 v213, a69
v_accvgpr_read_b32 v214, a70
v_accvgpr_read_b32 v215, a71
v_accvgpr_read_b32 v216, a72
v_accvgpr_read_b32 v217, a73
v_accvgpr_read_b32 v218, a74
v_accvgpr_read_b32 v219, a75
v_accvgpr_read_b32 v220, a76
v_accvgpr_read_b32 v221, a77
v_accvgpr_read_b32 v222, a78
v_accvgpr_read_b32 v223, a79
ds_read_b64_tr_b16 v[76:77], v20 offset:10240
ds_read_b64_tr_b16 v[78:79], v21 offset:11264
s_waitcnt lgkmcnt(8)
v_mfma_f32_32x32x16_bf16 a[80:95], v[60:63], v[84:87], a[80:95]
ds_read_b64_tr_b16 v[56:57], v20 offset:12288
ds_read_b64_tr_b16 v[58:59], v21 offset:13312
s_waitcnt lgkmcnt(8)
v_mfma_f32_32x32x16_bf16 a[80:95], v[64:67], v[88:91], a[80:95]
ds_read_b64_tr_b16 v[60:61], v20 offset:14336
ds_read_b64_tr_b16 v[62:63], v21 offset:15360
s_waitcnt lgkmcnt(8)
v_mfma_f32_32x32x16_bf16 a[80:95], v[68:71], v[92:95], a[80:95]
ds_read_b64_tr_b16 v[64:65], v20 offset:16384
ds_read_b64_tr_b16 v[66:67], v21 offset:17408
s_waitcnt lgkmcnt(8)
v_mfma_f32_32x32x16_bf16 a[80:95], v[72:75], v[96:99], a[80:95]
v_cvt_pk_bf16_f32 v160, v208, v209
v_cvt_pk_bf16_f32 v161, v210, v211
v_cvt_pk_bf16_f32 v162, v212, v213
v_cvt_pk_bf16_f32 v163, v214, v215
v_cvt_pk_bf16_f32 v164, v216, v217
v_cvt_pk_bf16_f32 v165, v218, v219
v_cvt_pk_bf16_f32 v166, v220, v221
v_cvt_pk_bf16_f32 v167, v222, v223
ds_read_b64_tr_b16 v[68:69], v20 offset:18432
ds_read_b64_tr_b16 v[70:71], v21 offset:19456
s_waitcnt lgkmcnt(8)
v_mfma_f32_32x32x16_bf16 a[80:95], v[76:79], v[100:103], a[80:95]
ds_read_b64_tr_b16 v[72:73], v20 offset:20480
ds_read_b64_tr_b16 v[74:75], v21 offset:21504
s_waitcnt lgkmcnt(8)
v_mfma_f32_32x32x16_bf16 a[80:95], v[56:59], v[104:107], a[80:95]
ds_read_b64_tr_b16 v[76:77], v20 offset:22528
ds_read_b64_tr_b16 v[78:79], v21 offset:23552
s_waitcnt lgkmcnt(8)
v_mfma_f32_32x32x16_bf16 a[80:95], v[60:63], v[108:111], a[80:95]
v_add_u32 v20, 49152, v19
v_xor_b32 v21, 16, v20
ds_read_b64_tr_b16 v[56:57], v20
ds_read_b64_tr_b16 v[58:59], v21 offset:1024
s_waitcnt lgkmcnt(8)
v_mfma_f32_32x32x16_bf16 a[80:95], v[64:67], v[112:115], a[80:95]
s_add_u32 s72, s59, 4
s_cmp_ge_u32 s72, 10
s_cselect_b32 s73, 10, 0
s_sub_u32 s72, s72, s73
s_lshl_b32 s72, s72, 13
s_add_u32 s72, s72, s66
buffer_store_dwordx4 v[160:163], v48, s[40:43], s72 offen sc1
buffer_store_dwordx4 v[164:167], v48, s[40:43], s72 offen offset:1024 sc1
ds_read_b64_tr_b16 v[60:61], v20 offset:2048
ds_read_b64_tr_b16 v[62:63], v21 offset:3072
s_waitcnt lgkmcnt(8)
v_mfma_f32_32x32x16_bf16 a[80:95], v[68:71], v[116:119], a[80:95]
ds_read_b64_tr_b16 v[64:65], v20 offset:4096
ds_read_b64_tr_b16 v[66:67], v21 offset:5120
s_waitcnt lgkmcnt(8)
v_mfma_f32_32x32x16_bf16 a[80:95], v[72:75], v[120:123], a[80:95]
ds_read_b64_tr_b16 v[68:69], v20 offset:6144
ds_read_b64_tr_b16 v[70:71], v21 offset:7168
s_waitcnt lgkmcnt(8)
v_mfma_f32_32x32x16_bf16 a[80:95], v[76:79], v[124:127], a[80:95]
s_waitcnt vmcnt(22)
s_barrier
ds_read_b64_tr_b16 v[72:73], v20 offset:8192
ds_read_b64_tr_b16 v[74:75], v21 offset:9216
s_waitcnt lgkmcnt(8)
v_mfma_f32_32x32x16_bf16 a[96:111], v[56:59], v[80:83], a[96:111]
s_nop 5
v_accvgpr_read_b32 v224, a80
v_accvgpr_read_b32 v225, a81
v_accvgpr_read_b32 v226, a82
v_accvgpr_read_b32 v227, a83
v_accvgpr_read_b32 v228, a84
v_accvgpr_read_b32 v229, a85
v_accvgpr_read_b32 v230, a86
v_accvgpr_read_b32 v231, a87
v_accvgpr_read_b32 v232, a88
v_accvgpr_read_b32 v233, a89
v_accvgpr_read_b32 v234, a90
v_accvgpr_read_b32 v235, a91
v_accvgpr_read_b32 v236, a92
v_accvgpr_read_b32 v237, a93
v_accvgpr_read_b32 v238, a94
v_accvgpr_read_b32 v239, a95
ds_read_b64_tr_b16 v[76:77], v20 offset:10240
ds_read_b64_tr_b16 v[78:79], v21 offset:11264
s_waitcnt lgkmcnt(8)
v_mfma_f32_32x32x16_bf16 a[96:111], v[60:63], v[84:87], a[96:111]
ds_read_b64_tr_b16 v[56:57], v20 offset:12288
ds_read_b64_tr_b16 v[58:59], v21 offset:13312
s_waitcnt lgkmcnt(8)
v_mfma_f32_32x32x16_bf16 a[96:111], v[64:67], v[88:91], a[96:111]
ds_read_b64_tr_b16 v[60:61], v20 offset:14336
ds_read_b64_tr_b16 v[62:63], v21 offset:15360
s_waitcnt lgkmcnt(8)
v_mfma_f32_32x32x16_bf16 a[96:111], v[68:71], v[92:95], a[96:111]
ds_read_b64_tr_b16 v[64:65], v20 offset:16384
ds_read_b64_tr_b16 v[66:67], v21 offset:17408
s_waitcnt lgkmcnt(8)
v_mfma_f32_32x32x16_bf16 a[96:111], v[72:75], v[96:99], a[96:111]
v_cvt_pk_bf16_f32 v168, v224, v225
v_cvt_pk_bf16_f32 v169, v226, v227
v_cvt_pk_bf16_f32 v170, v228, v229
v_cvt_pk_bf16_f32 v171, v230, v231
v_cvt_pk_bf16_f32 v172, v232, v233
v_cvt_pk_bf16_f32 v173, v234, v235
v_cvt_pk_bf16_f32 v174, v236, v237
v_cvt_pk_bf16_f32 v175, v238, v239
ds_read_b64_tr_b16 v[68:69], v20 offset:18432
ds_read_b64_tr_b16 v[70:71], v21 offset:19456
s_waitcnt lgkmcnt(8)
v_mfma_f32_32x32x16_bf16 a[96:111], v[76:79], v[100:103], a[96:111]
ds_read_b64_tr_b16 v[72:73], v20 offset:20480
ds_read_b64_tr_b16 v[74:75], v21 offset:21504
s_waitcnt lgkmcnt(8)
v_mfma_f32_32x32x16_bf16 a[96:111], v[56:59], v[104:107], a[96:111]
ds_read_b64_tr_b16 v[76:77], v20 offset:22528
ds_read_b64_tr_b16 v[78:79], v21 offset:23552
s_waitcnt lgkmcnt(8)
v_mfma_f32_32x32x16_bf16 a[96:111], v[60:63], v[108:111], a[96:111]
v_add_u32 v20, 73728, v19
v_xor_b32 v21, 16, v20
ds_read_b64_tr_b16 v[56:57], v20
ds_read_b64_tr_b16 v[58:59], v21 offset:1024
s_waitcnt lgkmcnt(8)
v_mfma_f32_32x32x16_bf16 a[96:111], v[64:67], v[112:115], a[96:111]
s_add_u32 s72, s59, 5
s_cmp_ge_u32 s72, 10
s_cselect_b32 s73, 10, 0
s_sub_u32 s72, s72, s73
s_lshl_b32 s72, s72, 13
s_add_u32 s72, s72, s66
buffer_store_dwordx4 v[168:171], v48, s[40:43], s72 offen sc1
buffer_store_dwordx4 v[172:175], v48, s[40:43], s72 offen offset:1024 sc1
ds_read_b64_tr_b16 v[60:61], v20 offset:2048
ds_read_b64_tr_b16 v[62:63], v21 offset:3072
s_waitcnt lgkmcnt(8)
v_mfma_f32_32x32x16_bf16 a[96:111], v[68:71], v[116:119], a[96:111]
ds_read_b64_tr_b16 v[64:65], v20 offset:4096
ds_read_b64_tr_b16 v[66:67], v21 offset:5120
s_waitcnt lgkmcnt(8)
v_mfma_f32_32x32x16_bf16 a[96:111], v[72:75], v[120:123], a[96:111]
ds_read_b64_tr_b16 v[68:69], v20 offset:6144
ds_read_b64_tr_b16 v[70:71], v21 offset:7168
s_waitcnt lgkmcnt(8)
v_mfma_f32_32x32x16_bf16 a[96:111], v[76:79], v[124:127], a[96:111]
s_waitcnt vmcnt(18)
s_barrier
ds_read_b64_tr_b16 v[72:73], v20 offset:8192
ds_read_b64_tr_b16 v[74:75], v21 offset:9216
s_waitcnt lgkmcnt(8)
v_mfma_f32_32x32x16_bf16 a[112:127], v[56:59], v[80:83], a[112:127]
s_nop 5
v_accvgpr_read_b32 v208, a96
v_accvgpr_read_b32 v209, a97
v_accvgpr_read_b32 v210, a98
v_accvgpr_read_b32 v211, a99
v_accvgpr_read_b32 v212, a100
v_accvgpr_read_b32 v213, a101
v_accvgpr_read_b32 v214, a102
v_accvgpr_read_b32 v215, a103
v_accvgpr_read_b32 v216, a104
v_accvgpr_read_b32 v217, a105
v_accvgpr_read_b32 v218, a106
v_accvgpr_read_b32 v219, a107
v_accvgpr_read_b32 v220, a108
v_accvgpr_read_b32 v221, a109
v_accvgpr_read_b32 v222, a110
v_accvgpr_read_b32 v223, a111
ds_read_b64_tr_b16 v[76:77], v20 offset:10240
ds_read_b64_tr_b16 v[78:79], v21 offset:11264
s_waitcnt lgkmcnt(8)
v_mfma_f32_32x32x16_bf16 a[112:127], v[60:63], v[84:87], a[112:127]
ds_read_b64_tr_b16 v[56:57], v20 offset:12288
ds_read_b64_tr_b16 v[58:59], v21 offset:13312
s_waitcnt lgkmcnt(8)
v_mfma_f32_32x32x16_bf16 a[112:127], v[64:67], v[88:91], a[112:127]
ds_read_b64_tr_b16 v[60:61], v20 offset:14336
ds_read_b64_tr_b16 v[62:63], v21 offset:15360
s_waitcnt lgkmcnt(8)
v_mfma_f32_32x32x16_bf16 a[112:127], v[68:71], v[92:95], a[112:127]
ds_read_b64_tr_b16 v[64:65], v20 offset:16384
ds_read_b64_tr_b16 v[66:67], v21 offset:17408
s_waitcnt lgkmcnt(8)
v_mfma_f32_32x32x16_bf16 a[112:127], v[72:75], v[96:99], a[112:127]
v_cvt_pk_bf16_f32 v176, v208, v209
v_cvt_pk_bf16_f32 v177, v210, v211
v_cvt_pk_bf16_f32 v178, v212, v213
v_cvt_pk_bf16_f32 v179, v214, v215
v_cvt_pk_bf16_f32 v180, v216, v217
v_cvt_pk_bf16_f32 v181, v218, v219
v_cvt_pk_bf16_f32 v182, v220, v221
v_cvt_pk_bf16_f32 v183, v222, v223
ds_read_b64_tr_b16 v[68:69], v20 offset:18432
ds_read_b64_tr_b16 v[70:71], v21 offset:19456
s_waitcnt lgkmcnt(8)
v_mfma_f32_32x32x16_bf16 a[112:127], v[76:79], v[100:103], a[112:127]
ds_read_b64_tr_b16 v[72:73], v20 offset:20480
ds_read_b64_tr_b16 v[74:75], v21 offset:21504
s_waitcnt lgkmcnt(8)
v_mfma_f32_32x32x16_bf16 a[112:127], v[56:59], v[104:107], a[112:127]
ds_read_b64_tr_b16 v[76:77], v20 offset:22528
ds_read_b64_tr_b16 v[78:79], v21 offset:23552
s_waitcnt lgkmcnt(8)
v_mfma_f32_32x32x16_bf16 a[112:127], v[60:63], v[108:111], a[112:127]
v_add_u32 v20, 98304, v19
v_xor_b32 v21, 16, v20
ds_read_b64_tr_b16 v[56:57], v20
ds_read_b64_tr_b16 v[58:59], v21 offset:1024
s_waitcnt lgkmcnt(8)
v_mfma_f32_32x32x16_bf16 a[112:127], v[64:67], v[112:115], a[112:127]
s_add_u32 s72, s59, 6
s_cmp_ge_u32 s72, 10
s_cselect_b32 s73, 10, 0
s_sub_u32 s72, s72, s73
s_lshl_b32 s72, s72, 13
s_add_u32 s72, s72, s66
buffer_store_dwordx4 v[176:179], v48, s[40:43], s72 offen sc1
buffer_store_dwordx4 v[180:183], v48, s[40:43], s72 offen offset:1024 sc1
ds_read_b64_tr_b16 v[60:61], v20 offset:2048
ds_read_b64_tr_b16 v[62:63], v21 offset:3072
s_waitcnt lgkmcnt(8)
v_mfma_f32_32x32x16_bf16 a[112:127], v[68:71], v[116:119], a[112:127]
ds_read_b64_tr_b16 v[64:65], v20 offset:4096
ds_read_b64_tr_b16 v[66:67], v21 offset:5120
s_waitcnt lgkmcnt(8)
v_mfma_f32_32x32x16_bf16 a[112:127], v[72:75], v[120:123], a[112:127]
ds_read_b64_tr_b16 v[68:69], v20 offset:6144
ds_read_b64_tr_b16 v[70:71], v21 offset:7168
s_waitcnt lgkmcnt(8)
v_mfma_f32_32x32x16_bf16 a[112:127], v[76:79], v[124:127], a[112:127]
s_waitcnt vmcnt(10)
s_barrier
ds_read_b64_tr_b16 v[72:73], v20 offset:8192
ds_read_b64_tr_b16 v[74:75], v21 offset:9216
s_waitcnt lgkmcnt(8)
v_mfma_f32_32x32x16_bf16 a[128:143], v[56:59], v[80:83], a[128:143]
s_nop 5
v_accvgpr_read_b32 v224, a112
v_accvgpr_read_b32 v225, a113
v_accvgpr_read_b32 v226, a114
v_accvgpr_read_b32 v227, a115
v_accvgpr_read_b32 v228, a116
v_accvgpr_read_b32 v229, a117
v_accvgpr_read_b32 v230, a118
v_accvgpr_read_b32 v231, a119
v_accvgpr_read_b32 v232, a120
v_accvgpr_read_b32 v233, a121
v_accvgpr_read_b32 v234, a122
v_accvgpr_read_b32 v235, a123
v_accvgpr_read_b32 v236, a124
v_accvgpr_read_b32 v237, a125
v_accvgpr_read_b32 v238, a126
v_accvgpr_read_b32 v239, a127
ds_read_b64_tr_b16 v[76:77], v20 offset:10240
ds_read_b64_tr_b16 v[78:79], v21 offset:11264
s_waitcnt lgkmcnt(8)
v_mfma_f32_32x32x16_bf16 a[128:143], v[60:63], v[84:87], a[128:143]
ds_read_b64_tr_b16 v[56:57], v20 offset:12288
ds_read_b64_tr_b16 v[58:59], v21 offset:13312
s_waitcnt lgkmcnt(8)
v_mfma_f32_32x32x16_bf16 a[128:143], v[64:67], v[88:91], a[128:143]
ds_read_b64_tr_b16 v[60:61], v20 offset:14336
ds_read_b64_tr_b16 v[62:63], v21 offset:15360
s_waitcnt lgkmcnt(8)
v_mfma_f32_32x32x16_bf16 a[128:143], v[68:71], v[92:95], a[128:143]
ds_read_b64_tr_b16 v[64:65], v20 offset:16384
ds_read_b64_tr_b16 v[66:67], v21 offset:17408
s_waitcnt lgkmcnt(8)
v_mfma_f32_32x32x16_bf16 a[128:143], v[72:75], v[96:99], a[128:143]
v_cvt_pk_bf16_f32 v184, v224, v225
v_cvt_pk_bf16_f32 v185, v226, v227
v_cvt_pk_bf16_f32 v186, v228, v229
v_cvt_pk_bf16_f32 v187, v230, v231
v_cvt_pk_bf16_f32 v188, v232, v233
v_cvt_pk_bf16_f32 v189, v234, v235
v_cvt_pk_bf16_f32 v190, v236, v237
v_cvt_pk_bf16_f32 v191, v238, v239
ds_read_b64_tr_b16 v[68:69], v20 offset:18432
ds_read_b64_tr_b16 v[70:71], v21 offset:19456
s_waitcnt lgkmcnt(8)
v_mfma_f32_32x32x16_bf16 a[128:143], v[76:79], v[100:103], a[128:143]
ds_read_b64_tr_b16 v[72:73], v20 offset:20480
ds_read_b64_tr_b16 v[74:75], v21 offset:21504
s_waitcnt lgkmcnt(8)
v_mfma_f32_32x32x16_bf16 a[128:143], v[56:59], v[104:107], a[128:143]
ds_read_b64_tr_b16 v[76:77], v20 offset:22528
ds_read_b64_tr_b16 v[78:79], v21 offset:23552
s_waitcnt lgkmcnt(8)
v_mfma_f32_32x32x16_bf16 a[128:143], v[60:63], v[108:111], a[128:143]
v_add_u32 v20, 122880, v19
v_xor_b32 v21, 16, v20
ds_read_b64_tr_b16 v[56:57], v20
ds_read_b64_tr_b16 v[58:59], v21 offset:1024
s_waitcnt lgkmcnt(8)
v_mfma_f32_32x32x16_bf16 a[128:143], v[64:67], v[112:115], a[128:143]
s_add_u32 s72, s59, 7
s_cmp_ge_u32 s72, 10
s_cselect_b32 s73, 10, 0
s_sub_u32 s72, s72, s73
s_lshl_b32 s72, s72, 13
s_add_u32 s72, s72, s66
buffer_store_dwordx4 v[184:187], v48, s[40:43], s72 offen sc1
buffer_store_dwordx4 v[188:191], v48, s[40:43], s72 offen offset:1024 sc1
ds_read_b64_tr_b16 v[60:61], v20 offset:2048
ds_read_b64_tr_b16 v[62:63], v21 offset:3072
s_waitcnt lgkmcnt(8)
v_mfma_f32_32x32x16_bf16 a[128:143], v[68:71], v[116:119], a[128:143]
ds_read_b64_tr_b16 v[64:65], v20 offset:4096
ds_read_b64_tr_b16 v[66:67], v21 offset:5120
s_waitcnt lgkmcnt(8)
v_mfma_f32_32x32x16_bf16 a[128:143], v[72:75], v[120:123], a[128:143]
ds_read_b64_tr_b16 v[68:69], v20 offset:6144
ds_read_b64_tr_b16 v[70:71], v21 offset:7168
s_waitcnt lgkmcnt(8)
v_mfma_f32_32x32x16_bf16 a[128:143], v[76:79], v[124:127], a[128:143]
s_barrier
ds_read_b64_tr_b16 v[72:73], v20 offset:8192
ds_read_b64_tr_b16 v[74:75], v21 offset:9216
s_waitcnt lgkmcnt(8)
v_mfma_f32_32x32x16_bf16 a[144:159], v[56:59], v[80:83], a[144:159]
s_nop 6
v_accvgpr_read_b32 v208, a128
v_accvgpr_read_b32 v209, a129
v_accvgpr_read_b32 v210, a130
v_accvgpr_read_b32 v211, a131
v_accvgpr_read_b32 v212, a132
v_accvgpr_read_b32 v213, a133
v_accvgpr_read_b32 v214, a134
v_accvgpr_read_b32 v215, a135
v_accvgpr_read_b32 v216, a136
v_accvgpr_read_b32 v217, a137
v_accvgpr_read_b32 v218, a138
v_accvgpr_read_b32 v219, a139
v_accvgpr_read_b32 v220, a140
v_accvgpr_read_b32 v221, a141
v_accvgpr_read_b32 v222, a142
v_accvgpr_read_b32 v223, a143
ds_read_b64_tr_b16 v[76:77], v20 offset:10240
ds_read_b64_tr_b16 v[78:79], v21 offset:11264
s_waitcnt lgkmcnt(8)
v_mfma_f32_32x32x16_bf16 a[144:159], v[60:63], v[84:87], a[144:159]
ds_read_b64_tr_b16 v[56:57], v20 offset:12288
ds_read_b64_tr_b16 v[58:59], v21 offset:13312
s_waitcnt lgkmcnt(8)
v_mfma_f32_32x32x16_bf16 a[144:159], v[64:67], v[88:91], a[144:159]
ds_read_b64_tr_b16 v[60:61], v20 offset:14336
ds_read_b64_tr_b16 v[62:63], v21 offset:15360
s_waitcnt lgkmcnt(8)
v_mfma_f32_32x32x16_bf16 a[144:159], v[68:71], v[92:95], a[144:159]
v_cvt_pk_bf16_f32 v192, v208, v209
v_cvt_pk_bf16_f32 v193, v210, v211
v_cvt_pk_bf16_f32 v194, v212, v213
v_cvt_pk_bf16_f32 v195, v214, v215
v_cvt_pk_bf16_f32 v196, v216, v217
v_cvt_pk_bf16_f32 v197, v218, v219
v_cvt_pk_bf16_f32 v198, v220, v221
v_cvt_pk_bf16_f32 v199, v222, v223
ds_read_b64_tr_b16 v[64:65], v20 offset:16384
ds_read_b64_tr_b16 v[66:67], v21 offset:17408
s_waitcnt lgkmcnt(8)
v_mfma_f32_32x32x16_bf16 a[144:159], v[72:75], v[96:99], a[144:159]
ds_read_b64_tr_b16 v[68:69], v20 offset:18432
ds_read_b64_tr_b16 v[70:71], v21 offset:19456
s_waitcnt lgkmcnt(8)
v_mfma_f32_32x32x16_bf16 a[144:159], v[76:79], v[100:103], a[144:159]
ds_read_b64_tr_b16 v[72:73], v20 offset:20480
ds_read_b64_tr_b16 v[74:75], v21 offset:21504
s_waitcnt lgkmcnt(8)
v_mfma_f32_32x32x16_bf16 a[144:159], v[56:59], v[104:107], a[144:159]
s_add_u32 s72, s59, 8
s_cmp_ge_u32 s72, 10
s_cselect_b32 s73, 10, 0
s_sub_u32 s72, s72, s73
s_lshl_b32 s72, s72, 13
s_add_u32 s72, s72, s66
buffer_store_dwordx4 v[192:195], v48, s[40:43], s72 offen sc1
buffer_store_dwordx4 v[196:199], v48, s[40:43], s72 offen offset:1024 sc1
ds_read_b64_tr_b16 v[76:77], v20 offset:22528
ds_read_b64_tr_b16 v[78:79], v21 offset:23552
s_waitcnt lgkmcnt(8)
v_mfma_f32_32x32x16_bf16 a[144:159], v[60:63], v[108:111], a[144:159]
s_waitcnt lgkmcnt(6)
v_mfma_f32_32x32x16_bf16 a[144:159], v[64:67], v[112:115], a[144:159]
s_waitcnt lgkmcnt(4)
v_mfma_f32_32x32x16_bf16 a[144:159], v[68:71], v[116:119], a[144:159]
s_waitcnt vmcnt(6)
s_lshl_b32 s62, s57, 3
s_lshl_b32 s63, s58, 7
s_add_u32 s62, s62, s63
v_mov_b32 v32, s62
buffer_store_dwordx2 v[254:255], v32, s[44:47], 0 offen sc1
s_waitcnt lgkmcnt(2)
v_mfma_f32_32x32x16_bf16 a[144:159], v[72:75], v[120:123], a[144:159]
s_waitcnt lgkmcnt(0)
v_mfma_f32_32x32x16_bf16 a[144:159], v[76:79], v[124:127], a[144:159]
s_nop 11
v_accvgpr_read_b32 v224, a144
v_accvgpr_read_b32 v225, a145
v_accvgpr_read_b32 v226, a146
v_accvgpr_read_b32 v227, a147
v_accvgpr_read_b32 v228, a148
v_accvgpr_read_b32 v229, a149
v_accvgpr_read_b32 v230, a150
v_accvgpr_read_b32 v231, a151
v_accvgpr_read_b32 v232, a152
v_accvgpr_read_b32 v233, a153
v_accvgpr_read_b32 v234, a154
v_accvgpr_read_b32 v235, a155
v_accvgpr_read_b32 v236, a156
v_accvgpr_read_b32 v237, a157
v_accvgpr_read_b32 v238, a158
v_accvgpr_read_b32 v239, a159
v_cvt_pk_bf16_f32 v200, v224, v225
v_cvt_pk_bf16_f32 v201, v226, v227
v_cvt_pk_bf16_f32 v202, v228, v229
v_cvt_pk_bf16_f32 v203, v230, v231
v_cvt_pk_bf16_f32 v204, v232, v233
v_cvt_pk_bf16_f32 v205, v234, v235
v_cvt_pk_bf16_f32 v206, v236, v237
v_cvt_pk_bf16_f32 v207, v238, v239
s_add_u32 s72, s59, 9
s_cmp_ge_u32 s72, 10
s_cselect_b32 s73, 10, 0
s_sub_u32 s72, s72, s73
s_lshl_b32 s72, s72, 13
s_add_u32 s72, s72, s66
buffer_store_dwordx4 v[200:203], v48, s[40:43], s72 offen sc1
buffer_store_dwordx4 v[204:207], v48, s[40:43], s72 offen offset:1024 sc1
s_waitcnt vmcnt(0)
s_lshl_b32 s62, s57, 3
s_lshl_b32 s63, s58, 7
s_add_u32 s62, s62, s63
v_mov_b32 v32, s62
buffer_store_dwordx2 v[254:255], v32, s[44:47], 0 offen offset:512 sc1
s_cmp_ge_u32 s58, 2
s_cbranch_scc1 L_tB
s_cmp_eq_u32 s58, 1
s_cbranch_scc1 L_tA1
s_lshl_b32 s62, s57, 1
s_lshr_b32 s72, s62, 3
s_add_u32 s72, s72, s59
s_cmp_ge_u32 s72, 10
s_cselect_b32 s73, 10, 0
s_sub_u32 s72, s72, s73
s_lshl_b32 s72, s72, 3
s_and_b32 s73, s62, 7
s_add_u32 s91, s72, s73
s_lshl_b32 s72, s91, 10
s_mov_b32 s80, s72
s_bfe_u32 s62, s91, 0x20001
s_lshl_b32 s62, s62, 7
s_add_u32 s76, s62, 0
v_lshrrev_b32 v249, 1, v48
v_and_b32 v249, 127, v249
s_mov_b32 s63, 0
L_pollA2:
s_add_u32 s63, s63, 1
s_cmp_gt_u32 s63, 200000
s_cbranch_scc1 L_pokA2
buffer_load_dwordx2 v[250:251], v249, s[44:47], s76 offen sc1
s_waitcnt vmcnt(0)
v_cmp_eq_u32 vcc, v250, v254
v_cmp_eq_u32 s[68:69], v251, v255
s_nop 1
s_and_b64 s[68:69], s[68:69], vcc
s_cmp_eq_u64 s[68:69], -1
s_cbranch_scc0 L_pollA2
L_pokA2:
s_mov_b32 s72, s80
s_add_u32 s73, s72, 0
buffer_load_dwordx4 v[128:131], v48, s[40:43], s73 offen sc1
s_add_u32 s73, s72, 81920
buffer_load_dwordx4 v[132:135], v48, s[40:43], s73 offen sc1
s_add_u32 s73, s72, 163840
buffer_load_dwordx4 v[136:139], v48, s[40:43], s73 offen sc1
s_add_u32 s73, s72, 245760
buffer_load_dwordx4 v[140:143], v48, s[40:43], s73 offen sc1
s_add_u32 s73, s72, 327680
buffer_load_dwordx4 v[144:147], v48, s[40:43], s73 offen sc1
s_add_u32 s73, s72, 409600
buffer_load_dwordx4 v[148:151], v48, s[40:43], s73 offen sc1
s_add_u32 s73, s72, 491520
buffer_load_dwordx4 v[152:155], v48, s[40:43], s73 offen sc1
s_add_u32 s73, s72, 573440
buffer_load_dwordx4 v[156:159], v48, s[40:43], s73 offen sc1
s_add_u32 s73, s72, 655360
buffer_load_dwordx4 v[160:163], v48, s[40:43], s73 offen sc1
s_add_u32 s73, s72, 737280
buffer_load_dwordx4 v[164:167], v48, s[40:43], s73 offen sc1
s_add_u32 s73, s72, 819200
buffer_load_dwordx4 v[168:171], v48, s[40:43], s73 offen sc1
s_add_u32 s73, s72, 901120
buffer_load_dwordx4 v[172:175], v48, s[40:43], s73 offen sc1
s_add_u32 s73, s72, 983040
buffer_load_dwordx4 v[176:179], v48, s[40:43], s73 offen sc1
s_add_u32 s73, s72, 1064960
buffer_load_dwordx4 v[180:183], v48, s[40:43], s73 offen sc1
s_add_u32 s73, s72, 1146880
buffer_load_dwordx4 v[184:187], v48, s[40:43], s73 offen sc1
s_add_u32 s73, s72, 1228800
buffer_load_dwordx4 v[188:191], v48, s[40:43], s73 offen sc1
s_add_u32 s72, s80, 1024
s_add_u32 s73, s72, 0
buffer_load_dwordx4 v[56:59], v48, s[40:43], s73 offen sc1
s_add_u32 s73, s72, 81920
buffer_load_dwordx4 v[60:63], v48, s[40:43], s73 offen sc1
s_add_u32 s73, s72, 163840
buffer_load_dwordx4 v[64:67], v48, s[40:43], s73 offen sc1
s_add_u32 s73, s72, 245760
buffer_load_dwordx4 v[68:71], v48, s[40:43], s73 offen sc1
s_add_u32 s73, s72, 327680
buffer_load_dwordx4 v[72:75], v48, s[40:43], s73 offen sc1
s_add_u32 s73, s72, 409600
buffer_load_dwordx4 v[76:79], v48, s[40:43], s73 offen sc1
s_add_u32 s73, s72, 491520
buffer_load_dwordx4 v[80:83], v48, s[40:43], s73 offen sc1
s_add_u32 s73, s72, 573440
buffer_load_dwordx4 v[84:87], v48, s[40:43], s73 offen sc1
s_add_u32 s73, s72, 655360
buffer_load_dwordx4 v[88:91], v48, s[40:43], s73 offen sc1
s_add_u32 s73, s72, 737280
buffer_load_dwordx4 v[92:95], v48, s[40:43], s73 offen sc1
s_add_u32 s73, s72, 819200
buffer_load_dwordx4 v[96:99], v48, s[40:43], s73 offen sc1
s_add_u32 s73, s72, 901120
buffer_load_dwordx4 v[100:103], v48, s[40:43], s73 offen sc1
s_add_u32 s73, s72, 983040
buffer_load_dwordx4 v[104:107], v48, s[40:43], s73 offen sc1
s_add_u32 s73, s72, 1064960
buffer_load_dwordx4 v[108:111], v48, s[40:43], s73 offen sc1
s_add_u32 s73, s72, 1146880
buffer_load_dwordx4 v[112:115], v48, s[40:43], s73 offen sc1
s_add_u32 s73, s72, 1228800
buffer_load_dwordx4 v[116:119], v48, s[40:43], s73 offen sc1
s_mov_b32 s68, 0x3f80
s_mov_b32 s69, 0x3f800000
s_waitcnt vmcnt(31)
v_lshlrev_b32 v240, 16, v128
v_and_b32 v241, 0xffff0000, v128
v_lshlrev_b32 v242, 16, v129
v_and_b32 v243, 0xffff0000, v129
v_lshlrev_b32 v244, 16, v130
v_and_b32 v245, 0xffff0000, v130
v_lshlrev_b32 v246, 16, v131
v_and_b32 v247, 0xffff0000, v131
s_waitcnt vmcnt(30)
v_dot2c_f32_bf16 v240, s68, v132
v_dot2c_f32_bf16 v241, s69, v132
v_dot2c_f32_bf16 v242, s68, v133
v_dot2c_f32_bf16 v243, s69, v133
v_dot2c_f32_bf16 v244, s68, v134
v_dot2c_f32_bf16 v245, s69, v134
v_dot2c_f32_bf16 v246, s68, v135
v_dot2c_f32_bf16 v247, s69, v135
s_waitcnt vmcnt(29)
v_dot2c_f32_bf16 v240, s68, v136
v_dot2c_f32_bf16 v241, s69, v136
v_dot2c_f32_bf16 v242, s68, v137
v_dot2c_f32_bf16 v243, s69, v137
v_dot2c_f32_bf16 v244, s68, v138
v_dot2c_f32_bf16 v245, s69, v138
v_dot2c_f32_bf16 v246, s68, v139
v_dot2c_f32_bf16 v247, s69, v139
s_waitcnt vmcnt(28)
v_dot2c_f32_bf16 v240, s68, v140
v_dot2c_f32_bf16 v241, s69, v140
v_dot2c_f32_bf16 v242, s68, v141
v_dot2c_f32_bf16 v243, s69, v141
v_dot2c_f32_bf16 v244, s68, v142
v_dot2c_f32_bf16 v245, s69, v142
v_dot2c_f32_bf16 v246, s68, v143
v_dot2c_f32_bf16 v247, s69, v143
s_waitcnt vmcnt(27)
v_dot2c_f32_bf16 v240, s68, v144
v_dot2c_f32_bf16 v241, s69, v144
v_dot2c_f32_bf16 v242, s68, v145
v_dot2c_f32_bf16 v243, s69, v145
v_dot2c_f32_bf16 v244, s68, v146
v_dot2c_f32_bf16 v245, s69, v146
v_dot2c_f32_bf16 v246, s68, v147
v_dot2c_f32_bf16 v247, s69, v147
s_waitcnt vmcnt(26)
v_dot2c_f32_bf16 v240, s68, v148
v_dot2c_f32_bf16 v241, s69, v148
v_dot2c_f32_bf16 v242, s68, v149
v_dot2c_f32_bf16 v243, s69, v149
v_dot2c_f32_bf16 v244, s68, v150
v_dot2c_f32_bf16 v245, s69, v150
v_dot2c_f32_bf16 v246, s68, v151
v_dot2c_f32_bf16 v247, s69, v151
s_waitcnt vmcnt(25)
v_dot2c_f32_bf16 v240, s68, v152
v_dot2c_f32_bf16 v241, s69, v152
v_dot2c_f32_bf16 v242, s68, v153
v_dot2c_f32_bf16 v243, s69, v153
v_dot2c_f32_bf16 v244, s68, v154
v_dot2c_f32_bf16 v245, s69, v154
v_dot2c_f32_bf16 v246, s68, v155
v_dot2c_f32_bf16 v247, s69, v155
s_waitcnt vmcnt(24)
v_dot2c_f32_bf16 v240, s68, v156
v_dot2c_f32_bf16 v241, s69, v156
v_dot2c_f32_bf16 v242, s68, v157
v_dot2c_f32_bf16 v243, s69, v157
v_dot2c_f32_bf16 v244, s68, v158
v_dot2c_f32_bf16 v245, s69, v158
v_dot2c_f32_bf16 v246, s68, v159
v_dot2c_f32_bf16 v247, s69, v159
s_waitcnt vmcnt(23)
v_dot2c_f32_bf16 v240, s68, v160
v_dot2c_f32_bf16 v241, s69, v160
v_dot2c_f32_bf16 v242, s68, v161
v_dot2c_f32_bf16 v243, s69, v161
v_dot2c_f32_bf16 v244, s68, v162
v_dot2c_f32_bf16 v245, s69, v162
v_dot2c_f32_bf16 v246, s68, v163
v_dot2c_f32_bf16 v247, s69, v163
s_waitcnt vmcnt(22)
v_dot2c_f32_bf16 v240, s68, v164
v_dot2c_f32_bf16 v241, s69, v164
v_dot2c_f32_bf16 v242, s68, v165
v_dot2c_f32_bf16 v243, s69, v165
v_dot2c_f32_bf16 v244, s68, v166
v_dot2c_f32_bf16 v245, s69, v166
v_dot2c_f32_bf16 v246, s68, v167
v_dot2c_f32_bf16 v247, s69, v167
s_waitcnt vmcnt(21)
v_dot2c_f32_bf16 v240, s68, v168
v_dot2c_f32_bf16 v241, s69, v168
v_dot2c_f32_bf16 v242, s68, v169
v_dot2c_f32_bf16 v243, s69, v169
v_dot2c_f32_bf16 v244, s68, v170
v_dot2c_f32_bf16 v245, s69, v170
v_dot2c_f32_bf16 v246, s68, v171
v_dot2c_f32_bf16 v247, s69, v171
s_waitcnt vmcnt(20)
v_dot2c_f32_bf16 v240, s68, v172
v_dot2c_f32_bf16 v241, s69, v172
v_dot2c_f32_bf16 v242, s68, v173
v_dot2c_f32_bf16 v243, s69, v173
v_dot2c_f32_bf16 v244, s68, v174
v_dot2c_f32_bf16 v245, s69, v174
v_dot2c_f32_bf16 v246, s68, v175
v_dot2c_f32_bf16 v247, s69, v175
s_waitcnt vmcnt(19)
v_dot2c_f32_bf16 v240, s68, v176
v_dot2c_f32_bf16 v241, s69, v176
v_dot2c_f32_bf16 v242, s68, v177
v_dot2c_f32_bf16 v243, s69, v177
v_dot2c_f32_bf16 v244, s68, v178
v_dot2c_f32_bf16 v245, s69, v178
v_dot2c_f32_bf16 v246, s68, v179
v_dot2c_f32_bf16 v247, s69, v179
s_waitcnt vmcnt(18)
v_dot2c_f32_bf16 v240, s68, v180
v_dot2c_f32_bf16 v241, s69, v180
v_dot2c_f32_bf16 v242, s68, v181
v_dot2c_f32_bf16 v243, s69, v181
v_dot2c_f32_bf16 v244, s68, v182
v_dot2c_f32_bf16 v245, s69, v182
v_dot2c_f32_bf16 v246, s68, v183
v_dot2c_f32_bf16 v247, s69, v183
s_waitcnt vmcnt(17)
v_dot2c_f32_bf16 v240, s68, v184
v_dot2c_f32_bf16 v241, s69, v184
v_dot2c_f32_bf16 v242, s68, v185
v_dot2c_f32_bf16 v243, s69, v185
v_dot2c_f32_bf16 v244, s68, v186
v_dot2c_f32_bf16 v245, s69, v186
v_dot2c_f32_bf16 v246, s68, v187
v_dot2c_f32_bf16 v247, s69, v187
s_waitcnt vmcnt(16)
v_dot2c_f32_bf16 v240, s68, v188
v_dot2c_f32_bf16 v241, s69, v188
v_dot2c_f32_bf16 v242, s68, v189
v_dot2c_f32_bf16 v243, s69, v189
v_dot2c_f32_bf16 v244, s68, v190
v_dot2c_f32_bf16 v245, s69, v190
v_dot2c_f32_bf16 v246, s68, v191
v_dot2c_f32_bf16 v247, s69, v191
s_lshr_b32 s72, s91, 3
s_lshl_b32 s72, s72, 7
s_bfe_u32 s73, s91, 0x10002
s_lshl_b32 s73, s73, 6
s_add_u32 s72, s72, s73
s_and_b32 s73, s91, 1
s_lshl_b32 s73, s73, 5
s_add_u32 s72, s72, s73
s_bfe_u32 s73, s91, 0x10001
s_mul_i32 s73, s73, 40960
s_add_u32 s72, s72, s73
v_cvt_pk_bf16_f32 v40, v240, v241
v_cvt_pk_bf16_f32 v41, v242, v243
v_cvt_pk_bf16_f32 v42, v244, v245
v_cvt_pk_bf16_f32 v43, v246, v247
s_nop 0
v_permlane32_swap_b32 v40, v42
v_permlane32_swap_b32 v41, v43
v_and_b32 v36, 31, v0
v_mul_u32_u24 v36, 1280, v36
v_bfe_u32 v37, v0, 5, 1
v_lshlrev_b32 v37, 4, v37
v_add_u32 v36, v36, v37
buffer_store_dwordx4 v[40:43], v36, s[48:51], s72 offen
s_add_u32 s91, s91, 1
s_mov_b32 s68, 0x3f80
s_mov_b32 s69, 0x3f800000
s_waitcnt vmcnt(16)
v_lshlrev_b32 v240, 16, v56
v_and_b32 v241, 0xffff0000, v56
v_lshlrev_b32 v242, 16, v57
v_and_b32 v243, 0xffff0000, v57
v_lshlrev_b32 v244, 16, v58
v_and_b32 v245, 0xffff0000, v58
v_lshlrev_b32 v246, 16, v59
v_and_b32 v247, 0xffff0000, v59
s_waitcnt vmcnt(15)
v_dot2c_f32_bf16 v240, s68, v60
v_dot2c_f32_bf16 v241, s69, v60
v_dot2c_f32_bf16 v242, s68, v61
v_dot2c_f32_bf16 v243, s69, v61
v_dot2c_f32_bf16 v244, s68, v62
v_dot2c_f32_bf16 v245, s69, v62
v_dot2c_f32_bf16 v246, s68, v63
v_dot2c_f32_bf16 v247, s69, v63
s_waitcnt vmcnt(14)
v_dot2c_f32_bf16 v240, s68, v64
v_dot2c_f32_bf16 v241, s69, v64
v_dot2c_f32_bf16 v242, s68, v65
v_dot2c_f32_bf16 v243, s69, v65
v_dot2c_f32_bf16 v244, s68, v66
v_dot2c_f32_bf16 v245, s69, v66
v_dot2c_f32_bf16 v246, s68, v67
v_dot2c_f32_bf16 v247, s69, v67
s_waitcnt vmcnt(13)
v_dot2c_f32_bf16 v240, s68, v68
v_dot2c_f32_bf16 v241, s69, v68
v_dot2c_f32_bf16 v242, s68, v69
v_dot2c_f32_bf16 v243, s69, v69
v_dot2c_f32_bf16 v244, s68, v70
v_dot2c_f32_bf16 v245, s69, v70
v_dot2c_f32_bf16 v246, s68, v71
v_dot2c_f32_bf16 v247, s69, v71
s_waitcnt vmcnt(12)
v_dot2c_f32_bf16 v240, s68, v72
v_dot2c_f32_bf16 v241, s69, v72
v_dot2c_f32_bf16 v242, s68, v73
v_dot2c_f32_bf16 v243, s69, v73
v_dot2c_f32_bf16 v244, s68, v74
v_dot2c_f32_bf16 v245, s69, v74
v_dot2c_f32_bf16 v246, s68, v75
v_dot2c_f32_bf16 v247, s69, v75
s_waitcnt vmcnt(11)
v_dot2c_f32_bf16 v240, s68, v76
v_dot2c_f32_bf16 v241, s69, v76
v_dot2c_f32_bf16 v242, s68, v77
v_dot2c_f32_bf16 v243, s69, v77
v_dot2c_f32_bf16 v244, s68, v78
v_dot2c_f32_bf16 v245, s69, v78
v_dot2c_f32_bf16 v246, s68, v79
v_dot2c_f32_bf16 v247, s69, v79
s_waitcnt vmcnt(10)
v_dot2c_f32_bf16 v240, s68, v80
v_dot2c_f32_bf16 v241, s69, v80
v_dot2c_f32_bf16 v242, s68, v81
v_dot2c_f32_bf16 v243, s69, v81
v_dot2c_f32_bf16 v244, s68, v82
v_dot2c_f32_bf16 v245, s69, v82
v_dot2c_f32_bf16 v246, s68, v83
v_dot2c_f32_bf16 v247, s69, v83
s_waitcnt vmcnt(9)
v_dot2c_f32_bf16 v240, s68, v84
v_dot2c_f32_bf16 v241, s69, v84
v_dot2c_f32_bf16 v242, s68, v85
v_dot2c_f32_bf16 v243, s69, v85
v_dot2c_f32_bf16 v244, s68, v86
v_dot2c_f32_bf16 v245, s69, v86
v_dot2c_f32_bf16 v246, s68, v87
v_dot2c_f32_bf16 v247, s69, v87
s_waitcnt vmcnt(8)
v_dot2c_f32_bf16 v240, s68, v88
v_dot2c_f32_bf16 v241, s69, v88
v_dot2c_f32_bf16 v242, s68, v89
v_dot2c_f32_bf16 v243, s69, v89
v_dot2c_f32_bf16 v244, s68, v90
v_dot2c_f32_bf16 v245, s69, v90
v_dot2c_f32_bf16 v246, s68, v91
v_dot2c_f32_bf16 v247, s69, v91
s_waitcnt vmcnt(7)
v_dot2c_f32_bf16 v240, s68, v92
v_dot2c_f32_bf16 v241, s69, v92
v_dot2c_f32_bf16 v242, s68, v93
v_dot2c_f32_bf16 v243, s69, v93
v_dot2c_f32_bf16 v244, s68, v94
v_dot2c_f32_bf16 v245, s69, v94
v_dot2c_f32_bf16 v246, s68, v95
v_dot2c_f32_bf16 v247, s69, v95
s_waitcnt vmcnt(6)
v_dot2c_f32_bf16 v240, s68, v96
v_dot2c_f32_bf16 v241, s69, v96
v_dot2c_f32_bf16 v242, s68, v97
v_dot2c_f32_bf16 v243, s69, v97
v_dot2c_f32_bf16 v244, s68, v98
v_dot2c_f32_bf16 v245, s69, v98
v_dot2c_f32_bf16 v246, s68, v99
v_dot2c_f32_bf16 v247, s69, v99
s_waitcnt vmcnt(5)
v_dot2c_f32_bf16 v240, s68, v100
v_dot2c_f32_bf16 v241, s69, v100
v_dot2c_f32_bf16 v242, s68, v101
v_dot2c_f32_bf16 v243, s69, v101
v_dot2c_f32_bf16 v244, s68, v102
v_dot2c_f32_bf16 v245, s69, v102
v_dot2c_f32_bf16 v246, s68, v103
v_dot2c_f32_bf16 v247, s69, v103
s_waitcnt vmcnt(4)
v_dot2c_f32_bf16 v240, s68, v104
v_dot2c_f32_bf16 v241, s69, v104
v_dot2c_f32_bf16 v242, s68, v105
v_dot2c_f32_bf16 v243, s69, v105
v_dot2c_f32_bf16 v244, s68, v106
v_dot2c_f32_bf16 v245, s69, v106
v_dot2c_f32_bf16 v246, s68, v107
v_dot2c_f32_bf16 v247, s69, v107
s_waitcnt vmcnt(3)
v_dot2c_f32_bf16 v240, s68, v108
v_dot2c_f32_bf16 v241, s69, v108
v_dot2c_f32_bf16 v242, s68, v109
v_dot2c_f32_bf16 v243, s69, v109
v_dot2c_f32_bf16 v244, s68, v110
v_dot2c_f32_bf16 v245, s69, v110
v_dot2c_f32_bf16 v246, s68, v111
v_dot2c_f32_bf16 v247, s69, v111
s_waitcnt vmcnt(2)
v_dot2c_f32_bf16 v240, s68, v112
v_dot2c_f32_bf16 v241, s69, v112
v_dot2c_f32_bf16 v242, s68, v113
v_dot2c_f32_bf16 v243, s69, v113
v_dot2c_f32_bf16 v244, s68, v114
v_dot2c_f32_bf16 v245, s69, v114
v_dot2c_f32_bf16 v246, s68, v115
v_dot2c_f32_bf16 v247, s69, v115
s_waitcnt vmcnt(1)
v_dot2c_f32_bf16 v240, s68, v116
v_dot2c_f32_bf16 v241, s69, v116
v_dot2c_f32_bf16 v242, s68, v117
v_dot2c_f32_bf16 v243, s69, v117
v_dot2c_f32_bf16 v244, s68, v118
v_dot2c_f32_bf16 v245, s69, v118
v_dot2c_f32_bf16 v246, s68, v119
v_dot2c_f32_bf16 v247, s69, v119
s_lshr_b32 s72, s91, 3
s_lshl_b32 s72, s72, 7
s_bfe_u32 s73, s91, 0x10002
s_lshl_b32 s73, s73, 6
s_add_u32 s72, s72, s73
s_and_b32 s73, s91, 1
s_lshl_b32 s73, s73, 5
s_add_u32 s72, s72, s73
s_bfe_u32 s73, s91, 0x10001
s_mul_i32 s73, s73, 40960
s_add_u32 s72, s72, s73
v_cvt_pk_bf16_f32 v40, v240, v241
v_cvt_pk_bf16_f32 v41, v242, v243
v_cvt_pk_bf16_f32 v42, v244, v245
v_cvt_pk_bf16_f32 v43, v246, v247
s_nop 0
v_permlane32_swap_b32 v40, v42
v_permlane32_swap_b32 v41, v43
v_and_b32 v36, 31, v0
v_mul_u32_u24 v36, 1280, v36
v_bfe_u32 v37, v0, 5, 1
v_lshlrev_b32 v37, 4, v37
v_add_u32 v36, v36, v37
buffer_store_dwordx4 v[40:43], v36, s[48:51], s72 offen
s_branch L_fin
L_tA1:
s_add_u32 s62, s57, 32
s_lshr_b32 s72, s62, 3
s_add_u32 s72, s72, s59
s_cmp_ge_u32 s72, 10
s_cselect_b32 s73, 10, 0
s_sub_u32 s72, s72, s73
s_lshl_b32 s72, s72, 3
s_and_b32 s73, s62, 7
s_add_u32 s91, s72, s73
s_lshl_b32 s72, s91, 10
s_mov_b32 s80, s72
s_bfe_u32 s62, s91, 0x20001
s_lshl_b32 s62, s62, 7
s_add_u32 s76, s62, 0
v_lshrrev_b32 v249, 1, v48
v_and_b32 v249, 127, v249
s_mov_b32 s63, 0
L_pollA1:
s_add_u32 s63, s63, 1
s_cmp_gt_u32 s63, 200000
s_cbranch_scc1 L_pokA1
buffer_load_dwordx2 v[250:251], v249, s[44:47], s76 offen sc1
s_waitcnt vmcnt(0)
v_cmp_eq_u32 vcc, v250, v254
v_cmp_eq_u32 s[68:69], v251, v255
s_nop 1
s_and_b64 s[68:69], s[68:69], vcc
s_cmp_eq_u64 s[68:69], -1
s_cbranch_scc0 L_pollA1
L_pokA1:
s_mov_b32 s72, s80
s_add_u32 s73, s72, 0
buffer_load_dwordx4 v[128:131], v48, s[40:43], s73 offen sc1
s_add_u32 s73, s72, 81920
buffer_load_dwordx4 v[132:135], v48, s[40:43], s73 offen sc1
s_add_u32 s73, s72, 163840
buffer_load_dwordx4 v[136:139], v48, s[40:43], s73 offen sc1
s_add_u32 s73, s72, 245760
buffer_load_dwordx4 v[140:143], v48, s[40:43], s73 offen sc1
s_add_u32 s73, s72, 327680
buffer_load_dwordx4 v[144:147], v48, s[40:43], s73 offen sc1
s_add_u32 s73, s72, 409600
buffer_load_dwordx4 v[148:151], v48, s[40:43], s73 offen sc1
s_add_u32 s73, s72, 491520
buffer_load_dwordx4 v[152:155], v48, s[40:43], s73 offen sc1
s_add_u32 s73, s72, 573440
buffer_load_dwordx4 v[156:159], v48, s[40:43], s73 offen sc1
s_add_u32 s73, s72, 655360
buffer_load_dwordx4 v[160:163], v48, s[40:43], s73 offen sc1
s_add_u32 s73, s72, 737280
buffer_load_dwordx4 v[164:167], v48, s[40:43], s73 offen sc1
s_add_u32 s73, s72, 819200
buffer_load_dwordx4 v[168:171], v48, s[40:43], s73 offen sc1
s_add_u32 s73, s72, 901120
buffer_load_dwordx4 v[172:175], v48, s[40:43], s73 offen sc1
s_add_u32 s73, s72, 983040
buffer_load_dwordx4 v[176:179], v48, s[40:43], s73 offen sc1
s_add_u32 s73, s72, 1064960
buffer_load_dwordx4 v[180:183], v48, s[40:43], s73 offen sc1
s_add_u32 s73, s72, 1146880
buffer_load_dwordx4 v[184:187], v48, s[40:43], s73 offen sc1
s_add_u32 s73, s72, 1228800
buffer_load_dwordx4 v[188:191], v48, s[40:43], s73 offen sc1
s_mov_b32 s68, 0x3f80
s_mov_b32 s69, 0x3f800000
s_waitcnt vmcnt(15)
v_lshlrev_b32 v240, 16, v128
v_and_b32 v241, 0xffff0000, v128
v_lshlrev_b32 v242, 16, v129
v_and_b32 v243, 0xffff0000, v129
v_lshlrev_b32 v244, 16, v130
v_and_b32 v245, 0xffff0000, v130
v_lshlrev_b32 v246, 16, v131
v_and_b32 v247, 0xffff0000, v131
s_waitcnt vmcnt(14)
v_dot2c_f32_bf16 v240, s68, v132
v_dot2c_f32_bf16 v241, s69, v132
v_dot2c_f32_bf16 v242, s68, v133
v_dot2c_f32_bf16 v243, s69, v133
v_dot2c_f32_bf16 v244, s68, v134
v_dot2c_f32_bf16 v245, s69, v134
v_dot2c_f32_bf16 v246, s68, v135
v_dot2c_f32_bf16 v247, s69, v135
s_waitcnt vmcnt(13)
v_dot2c_f32_bf16 v240, s68, v136
v_dot2c_f32_bf16 v241, s69, v136
v_dot2c_f32_bf16 v242, s68, v137
v_dot2c_f32_bf16 v243, s69, v137
v_dot2c_f32_bf16 v244, s68, v138
v_dot2c_f32_bf16 v245, s69, v138
v_dot2c_f32_bf16 v246, s68, v139
v_dot2c_f32_bf16 v247, s69, v139
s_waitcnt vmcnt(12)
v_dot2c_f32_bf16 v240, s68, v140
v_dot2c_f32_bf16 v241, s69, v140
v_dot2c_f32_bf16 v242, s68, v141
v_dot2c_f32_bf16 v243, s69, v141
v_dot2c_f32_bf16 v244, s68, v142
v_dot2c_f32_bf16 v245, s69, v142
v_dot2c_f32_bf16 v246, s68, v143
v_dot2c_f32_bf16 v247, s69, v143
s_waitcnt vmcnt(11)
v_dot2c_f32_bf16 v240, s68, v144
v_dot2c_f32_bf16 v241, s69, v144
v_dot2c_f32_bf16 v242, s68, v145
v_dot2c_f32_bf16 v243, s69, v145
v_dot2c_f32_bf16 v244, s68, v146
v_dot2c_f32_bf16 v245, s69, v146
v_dot2c_f32_bf16 v246, s68, v147
v_dot2c_f32_bf16 v247, s69, v147
s_waitcnt vmcnt(10)
v_dot2c_f32_bf16 v240, s68, v148
v_dot2c_f32_bf16 v241, s69, v148
v_dot2c_f32_bf16 v242, s68, v149
v_dot2c_f32_bf16 v243, s69, v149
v_dot2c_f32_bf16 v244, s68, v150
v_dot2c_f32_bf16 v245, s69, v150
v_dot2c_f32_bf16 v246, s68, v151
v_dot2c_f32_bf16 v247, s69, v151
s_waitcnt vmcnt(9)
v_dot2c_f32_bf16 v240, s68, v152
v_dot2c_f32_bf16 v241, s69, v152
v_dot2c_f32_bf16 v242, s68, v153
v_dot2c_f32_bf16 v243, s69, v153
v_dot2c_f32_bf16 v244, s68, v154
v_dot2c_f32_bf16 v245, s69, v154
v_dot2c_f32_bf16 v246, s68, v155
v_dot2c_f32_bf16 v247, s69, v155
s_waitcnt vmcnt(8)
v_dot2c_f32_bf16 v240, s68, v156
v_dot2c_f32_bf16 v241, s69, v156
v_dot2c_f32_bf16 v242, s68, v157
v_dot2c_f32_bf16 v243, s69, v157
v_dot2c_f32_bf16 v244, s68, v158
v_dot2c_f32_bf16 v245, s69, v158
v_dot2c_f32_bf16 v246, s68, v159
v_dot2c_f32_bf16 v247, s69, v159
s_waitcnt vmcnt(7)
v_dot2c_f32_bf16 v240, s68, v160
v_dot2c_f32_bf16 v241, s69, v160
v_dot2c_f32_bf16 v242, s68, v161
v_dot2c_f32_bf16 v243, s69, v161
v_dot2c_f32_bf16 v244, s68, v162
v_dot2c_f32_bf16 v245, s69, v162
v_dot2c_f32_bf16 v246, s68, v163
v_dot2c_f32_bf16 v247, s69, v163
s_waitcnt vmcnt(6)
v_dot2c_f32_bf16 v240, s68, v164
v_dot2c_f32_bf16 v241, s69, v164
v_dot2c_f32_bf16 v242, s68, v165
v_dot2c_f32_bf16 v243, s69, v165
v_dot2c_f32_bf16 v244, s68, v166
v_dot2c_f32_bf16 v245, s69, v166
v_dot2c_f32_bf16 v246, s68, v167
v_dot2c_f32_bf16 v247, s69, v167
s_waitcnt vmcnt(5)
v_dot2c_f32_bf16 v240, s68, v168
v_dot2c_f32_bf16 v241, s69, v168
v_dot2c_f32_bf16 v242, s68, v169
v_dot2c_f32_bf16 v243, s69, v169
v_dot2c_f32_bf16 v244, s68, v170
v_dot2c_f32_bf16 v245, s69, v170
v_dot2c_f32_bf16 v246, s68, v171
v_dot2c_f32_bf16 v247, s69, v171
s_waitcnt vmcnt(4)
v_dot2c_f32_bf16 v240, s68, v172
v_dot2c_f32_bf16 v241, s69, v172
v_dot2c_f32_bf16 v242, s68, v173
v_dot2c_f32_bf16 v243, s69, v173
v_dot2c_f32_bf16 v244, s68, v174
v_dot2c_f32_bf16 v245, s69, v174
v_dot2c_f32_bf16 v246, s68, v175
v_dot2c_f32_bf16 v247, s69, v175
s_waitcnt vmcnt(3)
v_dot2c_f32_bf16 v240, s68, v176
v_dot2c_f32_bf16 v241, s69, v176
v_dot2c_f32_bf16 v242, s68, v177
v_dot2c_f32_bf16 v243, s69, v177
v_dot2c_f32_bf16 v244, s68, v178
v_dot2c_f32_bf16 v245, s69, v178
v_dot2c_f32_bf16 v246, s68, v179
v_dot2c_f32_bf16 v247, s69, v179
s_waitcnt vmcnt(2)
v_dot2c_f32_bf16 v240, s68, v180
v_dot2c_f32_bf16 v241, s69, v180
v_dot2c_f32_bf16 v242, s68, v181
v_dot2c_f32_bf16 v243, s69, v181
v_dot2c_f32_bf16 v244, s68, v182
v_dot2c_f32_bf16 v245, s69, v182
v_dot2c_f32_bf16 v246, s68, v183
v_dot2c_f32_bf16 v247, s69, v183
s_waitcnt vmcnt(1)
v_dot2c_f32_bf16 v240, s68, v184
v_dot2c_f32_bf16 v241, s69, v184
v_dot2c_f32_bf16 v242, s68, v185
v_dot2c_f32_bf16 v243, s69, v185
v_dot2c_f32_bf16 v244, s68, v186
v_dot2c_f32_bf16 v245, s69, v186
v_dot2c_f32_bf16 v246, s68, v187
v_dot2c_f32_bf16 v247, s69, v187
s_waitcnt vmcnt(0)
v_dot2c_f32_bf16 v240, s68, v188
v_dot2c_f32_bf16 v241, s69, v188
v_dot2c_f32_bf16 v242, s68, v189
v_dot2c_f32_bf16 v243, s69, v189
v_dot2c_f32_bf16 v244, s68, v190
v_dot2c_f32_bf16 v245, s69, v190
v_dot2c_f32_bf16 v246, s68, v191
v_dot2c_f32_bf16 v247, s69, v191
s_lshr_b32 s72, s91, 3
s_lshl_b32 s72, s72, 7
s_bfe_u32 s73, s91, 0x10002
s_lshl_b32 s73, s73, 6
s_add_u32 s72, s72, s73
s_and_b32 s73, s91, 1
s_lshl_b32 s73, s73, 5
s_add_u32 s72, s72, s73
s_bfe_u32 s73, s91, 0x10001
s_mul_i32 s73, s73, 40960
s_add_u32 s72, s72, s73
v_cvt_pk_bf16_f32 v40, v240, v241
v_cvt_pk_bf16_f32 v41, v242, v243
v_cvt_pk_bf16_f32 v42, v244, v245
v_cvt_pk_bf16_f32 v43, v246, v247
s_nop 0
v_permlane32_swap_b32 v40, v42
v_permlane32_swap_b32 v41, v43
v_and_b32 v36, 31, v0
v_mul_u32_u24 v36, 1280, v36
v_bfe_u32 v37, v0, 5, 1
v_lshlrev_b32 v37, 4, v37
v_add_u32 v36, v36, v37
buffer_store_dwordx4 v[40:43], v36, s[48:51], s72 offen
s_branch L_fin
L_tB:
s_lshl_b32 s62, s57, 1
s_add_u32 s62, s62, s58
s_add_u32 s62, s62, 46
s_lshr_b32 s72, s62, 3
s_add_u32 s72, s72, s59
s_cmp_ge_u32 s72, 10
s_cselect_b32 s73, 10, 0
s_sub_u32 s72, s72, s73
s_lshl_b32 s72, s72, 3
s_and_b32 s73, s62, 7
s_add_u32 s91, s72, s73
s_lshl_b32 s72, s91, 10
s_mov_b32 s80, s72
s_bfe_u32 s62, s91, 0x20001
s_lshl_b32 s62, s62, 7
s_add_u32 s76, s62, 512
v_lshrrev_b32 v249, 1, v48
v_and_b32 v249, 127, v249
s_mov_b32 s63, 0
L_pollB:
s_add_u32 s63, s63, 1
s_cmp_gt_u32 s63, 200000
s_cbranch_scc1 L_pokB
buffer_load_dwordx2 v[250:251], v249, s[44:47], s76 offen sc1
s_waitcnt vmcnt(0)
v_cmp_eq_u32 vcc, v250, v254
v_cmp_eq_u32 s[68:69], v251, v255
s_nop 1
s_and_b64 s[68:69], s[68:69], vcc
s_cmp_eq_u64 s[68:69], -1
s_cbranch_scc0 L_pollB
L_pokB:
s_mov_b32 s72, s80
s_add_u32 s73, s72, 0
buffer_load_dwordx4 v[128:131], v48, s[40:43], s73 offen sc1
s_add_u32 s73, s72, 81920
buffer_load_dwordx4 v[132:135], v48, s[40:43], s73 offen sc1
s_add_u32 s73, s72, 163840
buffer_load_dwordx4 v[136:139], v48, s[40:43], s73 offen sc1
s_add_u32 s73, s72, 245760
buffer_load_dwordx4 v[140:143], v48, s[40:43], s73 offen sc1
s_add_u32 s73, s72, 327680
buffer_load_dwordx4 v[144:147], v48, s[40:43], s73 offen sc1
s_add_u32 s73, s72, 409600
buffer_load_dwordx4 v[148:151], v48, s[40:43], s73 offen sc1
s_add_u32 s73, s72, 491520
buffer_load_dwordx4 v[152:155], v48, s[40:43], s73 offen sc1
s_add_u32 s73, s72, 573440
buffer_load_dwordx4 v[156:159], v48, s[40:43], s73 offen sc1
s_add_u32 s73, s72, 655360
buffer_load_dwordx4 v[160:163], v48, s[40:43], s73 offen sc1
s_add_u32 s73, s72, 737280
buffer_load_dwordx4 v[164:167], v48, s[40:43], s73 offen sc1
s_add_u32 s73, s72, 819200
buffer_load_dwordx4 v[168:171], v48, s[40:43], s73 offen sc1
s_add_u32 s73, s72, 901120
buffer_load_dwordx4 v[172:175], v48, s[40:43], s73 offen sc1
s_add_u32 s73, s72, 983040
buffer_load_dwordx4 v[176:179], v48, s[40:43], s73 offen sc1
s_add_u32 s73, s72, 1064960
buffer_load_dwordx4 v[180:183], v48, s[40:43], s73 offen sc1
s_add_u32 s73, s72, 1146880
buffer_load_dwordx4 v[184:187], v48, s[40:43], s73 offen sc1
s_add_u32 s73, s72, 1228800
buffer_load_dwordx4 v[188:191], v48, s[40:43], s73 offen sc1
s_mov_b32 s68, 0x3f80
s_mov_b32 s69, 0x3f800000
s_waitcnt vmcnt(15)
v_lshlrev_b32 v240, 16, v128
v_and_b32 v241, 0xffff0000, v128
v_lshlrev_b32 v242, 16, v129
v_and_b32 v243, 0xffff0000, v129
v_lshlrev_b32 v244, 16, v130
v_and_b32 v245, 0xffff0000, v130
v_lshlrev_b32 v246, 16, v131
v_and_b32 v247, 0xffff0000, v131
s_waitcnt vmcnt(14)
v_dot2c_f32_bf16 v240, s68, v132
v_dot2c_f32_bf16 v241, s69, v132
v_dot2c_f32_bf16 v242, s68, v133
v_dot2c_f32_bf16 v243, s69, v133
v_dot2c_f32_bf16 v244, s68, v134
v_dot2c_f32_bf16 v245, s69, v134
v_dot2c_f32_bf16 v246, s68, v135
v_dot2c_f32_bf16 v247, s69, v135
s_waitcnt vmcnt(13)
v_dot2c_f32_bf16 v240, s68, v136
v_dot2c_f32_bf16 v241, s69, v136
v_dot2c_f32_bf16 v242, s68, v137
v_dot2c_f32_bf16 v243, s69, v137
v_dot2c_f32_bf16 v244, s68, v138
v_dot2c_f32_bf16 v245, s69, v138
v_dot2c_f32_bf16 v246, s68, v139
v_dot2c_f32_bf16 v247, s69, v139
s_waitcnt vmcnt(12)
v_dot2c_f32_bf16 v240, s68, v140
v_dot2c_f32_bf16 v241, s69, v140
v_dot2c_f32_bf16 v242, s68, v141
v_dot2c_f32_bf16 v243, s69, v141
v_dot2c_f32_bf16 v244, s68, v142
v_dot2c_f32_bf16 v245, s69, v142
v_dot2c_f32_bf16 v246, s68, v143
v_dot2c_f32_bf16 v247, s69, v143
s_waitcnt vmcnt(11)
v_dot2c_f32_bf16 v240, s68, v144
v_dot2c_f32_bf16 v241, s69, v144
v_dot2c_f32_bf16 v242, s68, v145
v_dot2c_f32_bf16 v243, s69, v145
v_dot2c_f32_bf16 v244, s68, v146
v_dot2c_f32_bf16 v245, s69, v146
v_dot2c_f32_bf16 v246, s68, v147
v_dot2c_f32_bf16 v247, s69, v147
s_waitcnt vmcnt(10)
v_dot2c_f32_bf16 v240, s68, v148
v_dot2c_f32_bf16 v241, s69, v148
v_dot2c_f32_bf16 v242, s68, v149
v_dot2c_f32_bf16 v243, s69, v149
v_dot2c_f32_bf16 v244, s68, v150
v_dot2c_f32_bf16 v245, s69, v150
v_dot2c_f32_bf16 v246, s68, v151
v_dot2c_f32_bf16 v247, s69, v151
s_waitcnt vmcnt(9)
v_dot2c_f32_bf16 v240, s68, v152
v_dot2c_f32_bf16 v241, s69, v152
v_dot2c_f32_bf16 v242, s68, v153
v_dot2c_f32_bf16 v243, s69, v153
v_dot2c_f32_bf16 v244, s68, v154
v_dot2c_f32_bf16 v245, s69, v154
v_dot2c_f32_bf16 v246, s68, v155
v_dot2c_f32_bf16 v247, s69, v155
s_waitcnt vmcnt(8)
v_dot2c_f32_bf16 v240, s68, v156
v_dot2c_f32_bf16 v241, s69, v156
v_dot2c_f32_bf16 v242, s68, v157
v_dot2c_f32_bf16 v243, s69, v157
v_dot2c_f32_bf16 v244, s68, v158
v_dot2c_f32_bf16 v245, s69, v158
v_dot2c_f32_bf16 v246, s68, v159
v_dot2c_f32_bf16 v247, s69, v159
s_waitcnt vmcnt(7)
v_dot2c_f32_bf16 v240, s68, v160
v_dot2c_f32_bf16 v241, s69, v160
v_dot2c_f32_bf16 v242, s68, v161
v_dot2c_f32_bf16 v243, s69, v161
v_dot2c_f32_bf16 v244, s68, v162
v_dot2c_f32_bf16 v245, s69, v162
v_dot2c_f32_bf16 v246, s68, v163
v_dot2c_f32_bf16 v247, s69, v163
s_waitcnt vmcnt(6)
v_dot2c_f32_bf16 v240, s68, v164
v_dot2c_f32_bf16 v241, s69, v164
v_dot2c_f32_bf16 v242, s68, v165
v_dot2c_f32_bf16 v243, s69, v165
v_dot2c_f32_bf16 v244, s68, v166
v_dot2c_f32_bf16 v245, s69, v166
v_dot2c_f32_bf16 v246, s68, v167
v_dot2c_f32_bf16 v247, s69, v167
s_waitcnt vmcnt(5)
v_dot2c_f32_bf16 v240, s68, v168
v_dot2c_f32_bf16 v241, s69, v168
v_dot2c_f32_bf16 v242, s68, v169
v_dot2c_f32_bf16 v243, s69, v169
v_dot2c_f32_bf16 v244, s68, v170
v_dot2c_f32_bf16 v245, s69, v170
v_dot2c_f32_bf16 v246, s68, v171
v_dot2c_f32_bf16 v247, s69, v171
s_waitcnt vmcnt(4)
v_dot2c_f32_bf16 v240, s68, v172
v_dot2c_f32_bf16 v241, s69, v172
v_dot2c_f32_bf16 v242, s68, v173
v_dot2c_f32_bf16 v243, s69, v173
v_dot2c_f32_bf16 v244, s68, v174
v_dot2c_f32_bf16 v245, s69, v174
v_dot2c_f32_bf16 v246, s68, v175
v_dot2c_f32_bf16 v247, s69, v175
s_waitcnt vmcnt(3)
v_dot2c_f32_bf16 v240, s68, v176
v_dot2c_f32_bf16 v241, s69, v176
v_dot2c_f32_bf16 v242, s68, v177
v_dot2c_f32_bf16 v243, s69, v177
v_dot2c_f32_bf16 v244, s68, v178
v_dot2c_f32_bf16 v245, s69, v178
v_dot2c_f32_bf16 v246, s68, v179
v_dot2c_f32_bf16 v247, s69, v179
s_waitcnt vmcnt(2)
v_dot2c_f32_bf16 v240, s68, v180
v_dot2c_f32_bf16 v241, s69, v180
v_dot2c_f32_bf16 v242, s68, v181
v_dot2c_f32_bf16 v243, s69, v181
v_dot2c_f32_bf16 v244, s68, v182
v_dot2c_f32_bf16 v245, s69, v182
v_dot2c_f32_bf16 v246, s68, v183
v_dot2c_f32_bf16 v247, s69, v183
s_waitcnt vmcnt(1)
v_dot2c_f32_bf16 v240, s68, v184
v_dot2c_f32_bf16 v241, s69, v184
v_dot2c_f32_bf16 v242, s68, v185
v_dot2c_f32_bf16 v243, s69, v185
v_dot2c_f32_bf16 v244, s68, v186
v_dot2c_f32_bf16 v245, s69, v186
v_dot2c_f32_bf16 v246, s68, v187
v_dot2c_f32_bf16 v247, s69, v187
s_waitcnt vmcnt(0)
v_dot2c_f32_bf16 v240, s68, v188
v_dot2c_f32_bf16 v241, s69, v188
v_dot2c_f32_bf16 v242, s68, v189
v_dot2c_f32_bf16 v243, s69, v189
v_dot2c_f32_bf16 v244, s68, v190
v_dot2c_f32_bf16 v245, s69, v190
v_dot2c_f32_bf16 v246, s68, v191
v_dot2c_f32_bf16 v247, s69, v191
s_lshr_b32 s72, s91, 3
s_lshl_b32 s72, s72, 7
s_bfe_u32 s73, s91, 0x10002
s_lshl_b32 s73, s73, 6
s_add_u32 s72, s72, s73
s_and_b32 s73, s91, 1
s_lshl_b32 s73, s73, 5
s_add_u32 s72, s72, s73
s_bfe_u32 s73, s91, 0x10001
s_mul_i32 s73, s73, 40960
s_add_u32 s72, s72, s73
v_cvt_pk_bf16_f32 v40, v240, v241
v_cvt_pk_bf16_f32 v41, v242, v243
v_cvt_pk_bf16_f32 v42, v244, v245
v_cvt_pk_bf16_f32 v43, v246, v247
s_nop 0
v_permlane32_swap_b32 v40, v42
v_permlane32_swap_b32 v41, v43
v_and_b32 v36, 31, v0
v_mul_u32_u24 v36, 1280, v36
v_bfe_u32 v37, v0, 5, 1
v_lshlrev_b32 v37, 4, v37
v_add_u32 v36, v36, v37
buffer_store_dwordx4 v[40:43], v36, s[48:51], s72 offen
L_fin:
L_end:
s_endpgm
L_codeend:
.section .rodata,"a"
.p2align 6
.amdhsa_kernel standalone__gqa_block_cached__near_ridge_kernel
  .amdhsa_next_free_vgpr 512
  .amdhsa_next_free_sgpr 100
  .amdhsa_accum_offset 256
  .amdhsa_group_segment_fixed_size 0
  .amdhsa_kernarg_size 64
  .amdhsa_user_sgpr_count 2
  .amdhsa_user_sgpr_kernarg_segment_ptr 1
  .amdhsa_system_sgpr_workgroup_id_x 1
.end_amdhsa_kernel
```
